```python
import torch

def _softmax(x, axis=-1):
    return torch.softmax(x, dim=axis)

def _gelu(x):
    return torch.nn.functional.gelu(x, approximate='tanh')

def _silu(x):
    return torch.nn.functional.silu(x)

def _sigmoid(x):
    return torch.sigmoid(x)

def _layernorm(x, axis=-1, eps=1e-05):
    m = x.mean(dim=axis, keepdim=True)
    v = x.var(dim=axis, keepdim=True, unbiased=False)
    return (x - m) / torch.sqrt(v + eps)

def _scatter_add(tgt, idx, src, axis=0):
    return tgt.clone().index_add_(axis, idx, src)

def _segment_sum(src, seg, n):
    out = torch.zeros((n,) + src.shape[1:], dtype=src.dtype)
    return out.index_add_(0, seg, src)

def _pad(x, pw):
    flat = tuple((v for pair in reversed(pw) for v in pair))
    return torch.nn.functional.pad(x, flat)
kernel_name = 'gated_mix__memory_aug_recurrent_mem_tr__grouped_kv_mqa__prompt'

def setup_inputs():

    _w = lambda a: (lambda t: t.to(torch.bfloat16) if t.is_floating_point() else t)(torch.as_tensor(a))

    def _A_setup():
        B, S, Dm = (1, 2048, 1024)
        H, Dh = (32, 128)
        M, seg = (8, 32)
        seg = min(seg, S)
        S = S // seg * seg
        return {'x': _w((lambda *s: torch.randn(*s, dtype=torch.bfloat16) * 0.05)(B, S, Dm)), 'mem0': _w((lambda *s: torch.randn(*s, dtype=torch.bfloat16) * 0.4)(B, M, Dm)), 'Wq': _w((lambda *s: torch.randn(*s, dtype=torch.bfloat16) * 6.4)(Dm, H, Dh) * Dm ** (-0.5)), 'Wk': _w((lambda *s: torch.randn(*s, dtype=torch.bfloat16) * 6.4)(Dm, H, Dh) * Dm ** (-0.5)), 'Wv': _w((lambda *s: torch.randn(*s, dtype=torch.bfloat16) * 0.4)(Dm, H, Dh) * Dm ** (-0.5)), 'Wo': _w((lambda *s: torch.randn(*s, dtype=torch.bfloat16) * 0.4)(H, Dh, Dm) * (H * Dh) ** (-0.5)), 'seg_len': seg}
    _A_in = _A_setup()

    def _B_setup():
        B, S, D, H = (1, 2048, 1024, 32)
        Dh = D // H
        return {'x': _w((lambda *s: torch.randn(*s, dtype=torch.bfloat16) * 0.05)(B, S, D)), 'wq': _w((lambda *s: torch.randn(*s, dtype=torch.bfloat16) * 0.8)(D, H * Dh)), 'wk': _w((lambda *s: torch.randn(*s, dtype=torch.bfloat16) * 0.8)(D, Dh)), 'wv': _w((lambda *s: torch.randn(*s, dtype=torch.bfloat16) * 0.05)(D, Dh)), 'wo': _w((lambda *s: torch.randn(*s, dtype=torch.bfloat16) * 0.05)(H * Dh, D))}
    _B_in = _B_setup()
    return {'A_x': _A_in['x'], 'A_mem0': _A_in['mem0'], 'A_Wq': _A_in['Wq'], 'A_Wk': _A_in['Wk'], 'A_Wv': _A_in['Wv'], 'A_Wo': _A_in['Wo'], 'A_seg_len': _A_in['seg_len'], 'B_x': _B_in['x'], 'B_wq': _B_in['wq'], 'B_wk': _B_in['wk'], 'B_wv': _B_in['wv'], 'B_wo': _B_in['wo'], 'gate_w': _w((lambda *s: torch.randn(*s, dtype=torch.bfloat16) * 0.05)(1024) * 16.0)}

def reference(A_x, A_mem0, A_Wq, A_Wk, A_Wv, A_Wo, A_seg_len, B_x, B_wq, B_wk, B_wv, B_wo, gate_w):

    def _A_ref(x, mem0, Wq, Wk, Wv, Wo, seg_len):
        B, S, Dm = x.shape
        H, Dh = (Wq.shape[1], Wq.shape[2])
        M = mem0.shape[1]
        scale = Dh ** (-0.5)
        n_seg = S // seg_len
        L = M + seg_len
        idx = torch.arange(L)
        mask = (idx[:, None] < M) | (idx[:, None] >= idx[None, :])
        mem = mem0
        outs = []
        for s in range(n_seg):
            xs = x[:, s * seg_len:(s + 1) * seg_len, :].clone()
            h = torch.concatenate([mem, xs], axis=1)
            q = torch.einsum('btd,dhe->bhte', h, Wq)
            k = torch.einsum('btd,dhe->bhte', h, Wk)
            v = torch.einsum('btd,dhe->bhte', h, Wv)
            scores = torch.einsum('bhqe,bhke->bhqk', q, k) * scale
            scores = torch.where(mask[None, None], scores, -1000000000.0)
            p = _softmax(scores, axis=-1)
            o = torch.einsum('bhqk,bhke->bhqe', p, v)
            o = torch.einsum('bhte,hed->btd', o, Wo)
            mem = o[:, :M, :].clone()
            outs.append(o[:, M:, :])
        return torch.concatenate(outs, axis=1)

    def _B_ref(x, wq, wk, wv, wo):
        B, S, D = x.shape
        H = 32
        Dh = D // H
        q = (lambda x, *d: x.permute(*d))((x @ wq).reshape(B, S, H, Dh), 0, 2, 1, 3)
        k = x @ wk
        v = x @ wv
        scores = torch.einsum('bhqd,bkd->bhqk', q, k) * Dh ** (-0.5)
        p = _softmax(scores, axis=-1)
        o = torch.einsum('bhqk,bkd->bhqd', p, v)
        return (lambda x, *d: x.permute(*d))(o, 0, 2, 1, 3).reshape(B, S, H * Dh) @ wo
    x = A_x
    g = _sigmoid((x * gate_w).sum(-1, keepdims=True))
    a = _A_ref(x, A_mem0, A_Wq, A_Wk, A_Wv, A_Wo, A_seg_len)
    b = _B_ref(x, B_wq, B_wk, B_wv, B_wo)
    return g * a + (1 - g) * b
```

```asm
; @launch grid=(256,1,1) block=(512,1,1) lds=133120
.amdgcn_target "amdgcn-amd-amdhsa--gfx950"
.text
.globl gated_mix__memory_aug_recurrent_mem_tr__grouped_kv_mqa__prompt_kernel
.p2align 8
.type gated_mix__memory_aug_recurrent_mem_tr__grouped_kv_mqa__prompt_kernel,@function
gated_mix__memory_aug_recurrent_mem_tr__grouped_kv_mqa__prompt_kernel:
  s_cmp_ge_u32 s2, 256
  s_cbranch_scc1 L_END
  s_load_dwordx8 s[4:11], s[0:1], 0
  s_load_dwordx4 s[12:15], s[0:1], 32
  s_load_dwordx8 s[16:23], s[0:1], 64
  s_load_dwordx8 s[24:31], s[0:1], 96
  s_getreg_b32 s35, hwreg(HW_REG_XCC_ID, 0, 3)
  v_lshrrev_b32 v1, 6, v0
  v_and_b32 v0, 63, v0
  v_readfirstlane_b32 s34, v1
  s_lshl_b32 s39, s35, 2
  v_mov_b32 v2, s39
  v_mov_b32 v3, 1
  v_mov_b32 v4, 32
  v_mov_b32 v8, 0
  s_waitcnt lgkmcnt(0)
  s_cmp_lg_u32 s34, 0
  s_cbranch_scc1 L_S1
  s_mov_b64 exec, 1
  global_atomic_add v6, v2, v3, s[28:29] sc0 sc1
  s_mov_b64 exec, -1
  s_waitcnt vmcnt(0)
  v_readfirstlane_b32 s36, v6
  s_lshl_b32 s40, s35, 5
  s_add_u32 s40, s40, s36
  s_cmp_lt_u32 s36, 32
  s_cbranch_scc1 L_S0
  v_and_b32 v2, 7, v0
  v_lshlrev_b32 v2, 2, v2
  s_mov_b32 s38, 524288
L_SO:
  s_sub_u32 s38, s38, 1
  s_cbranch_scc1 L_END
  global_load_dword v3, v2, s[28:29] sc1
  s_waitcnt vmcnt(0)
  s_mov_b32 s39, 0
  s_sub_u32 s41, s36, 32
  v_readlane_b32 s44, v3, 0
  s_add_u32 s39, s39, s44
  s_max_u32 s42, s44, 32
  s_sub_u32 s42, s42, 32
  s_cmp_gt_u32 s35, 0
  s_cselect_b32 s42, s42, 0
  s_add_u32 s41, s41, s42
  v_readlane_b32 s45, v3, 1
  s_add_u32 s39, s39, s45
  s_max_u32 s42, s45, 32
  s_sub_u32 s42, s42, 32
  s_cmp_gt_u32 s35, 1
  s_cselect_b32 s42, s42, 0
  s_add_u32 s41, s41, s42
  v_readlane_b32 s46, v3, 2
  s_add_u32 s39, s39, s46
  s_max_u32 s42, s46, 32
  s_sub_u32 s42, s42, 32
  s_cmp_gt_u32 s35, 2
  s_cselect_b32 s42, s42, 0
  s_add_u32 s41, s41, s42
  v_readlane_b32 s47, v3, 3
  s_add_u32 s39, s39, s47
  s_max_u32 s42, s47, 32
  s_sub_u32 s42, s42, 32
  s_cmp_gt_u32 s35, 3
  s_cselect_b32 s42, s42, 0
  s_add_u32 s41, s41, s42
  v_readlane_b32 s48, v3, 4
  s_add_u32 s39, s39, s48
  s_max_u32 s42, s48, 32
  s_sub_u32 s42, s42, 32
  s_cmp_gt_u32 s35, 4
  s_cselect_b32 s42, s42, 0
  s_add_u32 s41, s41, s42
  v_readlane_b32 s49, v3, 5
  s_add_u32 s39, s39, s49
  s_max_u32 s42, s49, 32
  s_sub_u32 s42, s42, 32
  s_cmp_gt_u32 s35, 5
  s_cselect_b32 s42, s42, 0
  s_add_u32 s41, s41, s42
  v_readlane_b32 s50, v3, 6
  s_add_u32 s39, s39, s50
  s_max_u32 s42, s50, 32
  s_sub_u32 s42, s42, 32
  s_cmp_gt_u32 s35, 6
  s_cselect_b32 s42, s42, 0
  s_add_u32 s41, s41, s42
  v_readlane_b32 s51, v3, 7
  s_add_u32 s39, s39, s51
  s_max_u32 s42, s51, 32
  s_sub_u32 s42, s42, 32
  s_cmp_gt_u32 s35, 7
  s_cselect_b32 s42, s42, 0
  s_add_u32 s41, s41, s42
  s_cmp_lt_u32 s39, 256
  s_cbranch_scc1 L_SO
  s_min_u32 s42, s44, 32
  s_add_u32 s40, s42, s41
  s_sub_u32 s42, 32, s42
  s_add_u32 s40, s40, 0
  s_cmp_lt_u32 s41, s42
  s_cbranch_scc1 L_S0
  s_sub_u32 s41, s41, s42
  s_min_u32 s42, s45, 32
  s_add_u32 s40, s42, s41
  s_sub_u32 s42, 32, s42
  s_add_u32 s40, s40, 32
  s_cmp_lt_u32 s41, s42
  s_cbranch_scc1 L_S0
  s_sub_u32 s41, s41, s42
  s_min_u32 s42, s46, 32
  s_add_u32 s40, s42, s41
  s_sub_u32 s42, 32, s42
  s_add_u32 s40, s40, 64
  s_cmp_lt_u32 s41, s42
  s_cbranch_scc1 L_S0
  s_sub_u32 s41, s41, s42
  s_min_u32 s42, s47, 32
  s_add_u32 s40, s42, s41
  s_sub_u32 s42, 32, s42
  s_add_u32 s40, s40, 96
  s_cmp_lt_u32 s41, s42
  s_cbranch_scc1 L_S0
  s_sub_u32 s41, s41, s42
  s_min_u32 s42, s48, 32
  s_add_u32 s40, s42, s41
  s_sub_u32 s42, 32, s42
  s_add_u32 s40, s40, 128
  s_cmp_lt_u32 s41, s42
  s_cbranch_scc1 L_S0
  s_sub_u32 s41, s41, s42
  s_min_u32 s42, s49, 32
  s_add_u32 s40, s42, s41
  s_sub_u32 s42, 32, s42
  s_add_u32 s40, s40, 160
  s_cmp_lt_u32 s41, s42
  s_cbranch_scc1 L_S0
  s_sub_u32 s41, s41, s42
  s_min_u32 s42, s50, 32
  s_add_u32 s40, s42, s41
  s_sub_u32 s42, 32, s42
  s_add_u32 s40, s40, 192
  s_cmp_lt_u32 s41, s42
  s_cbranch_scc1 L_S0
  s_sub_u32 s41, s41, s42
  s_min_u32 s42, s51, 32
  s_add_u32 s40, s42, s41
  s_sub_u32 s42, 32, s42
  s_add_u32 s40, s40, 224
  s_cmp_lt_u32 s41, s42
  s_cbranch_scc1 L_S0
  s_sub_u32 s41, s41, s42
  s_and_b32 s40, s36, 31
  s_lshl_b32 s39, s35, 5
  s_add_u32 s40, s40, s39
L_S0:
  v_mov_b32 v3, s40
  ds_write_b32 v8, v3
  s_waitcnt lgkmcnt(0)
L_S1:
  s_barrier
  ds_read_b32 v4, v8
  s_waitcnt lgkmcnt(0)
  v_readfirstlane_b32 s40, v4
  s_barrier
  s_and_b32 s40, s40, 255
  s_and_b32 s33, s40, 127
  s_cmp_lt_u32 s40, 128
  s_cbranch_scc1 L_CHAIN
  s_lshr_b32 s50, s33, 5
  s_and_b32 s51, s33, 31
  s_lshr_b32 s53, s33, 1
  s_and_b32 s54, s33, 1
  s_cmp_eq_u32 s54, 1
  s_cselect_b64 s[58:59], s[20:21], s[18:19]
  s_lshl_b32 s39, s34, 13
  s_add_u32 s58, s58, s39
  s_addc_u32 s59, s59, 0
  s_lshl_b32 s55, s34, 13
  v_lshrrev_b32 v2, 2, v0
  v_and_b32 v3, 3, v0
  v_lshlrev_b32 v3, 4, v3
  s_mov_b32 s39, 64
  v_mul_lo_u32 v2, v2, s39
  v_add_u32 v2, v2, v3
  v_add_u32 v3, 0, v2
  v_add_u32 v4, 0, v2
  v_add_u32 v5, 0, v2
  s_mov_b64 s[94:95], s[58:59]
  s_mov_b32 m0, s55
  s_nop 0
  global_load_lds_dwordx4 v2, s[94:95] offset:0
  global_load_lds_dwordx4 v3, s[94:95] offset:1024
  global_load_lds_dwordx4 v4, s[94:95] offset:2048
  global_load_lds_dwordx4 v5, s[94:95] offset:3072
  s_add_u32 s94, s94, 4096
  s_addc_u32 s95, s95, 0
  s_add_u32 m0, m0, 4096
  s_nop 0
  global_load_lds_dwordx4 v2, s[94:95] offset:0
  global_load_lds_dwordx4 v3, s[94:95] offset:1024
  global_load_lds_dwordx4 v4, s[94:95] offset:2048
  global_load_lds_dwordx4 v5, s[94:95] offset:3072
  s_lshl_b32 s39, s53, 16
  s_lshl_b32 s43, s34, 8
  s_add_u32 s39, s39, s43
  s_add_u32 s56, s4, s39
  s_addc_u32 s57, s5, 0
  v_and_b32 v6, 31, v0
  v_lshrrev_b32 v7, 5, v0
  v_lshlrev_b32 v7, 4, v7
  v_lshl_add_u32 v6, v6, 11, v7
  global_load_dwordx4 v[32:35], v6, s[56:57] offset:0
  global_load_dwordx4 v[36:39], v6, s[56:57] offset:32
  global_load_dwordx4 v[40:43], v6, s[56:57] offset:64
  global_load_dwordx4 v[44:47], v6, s[56:57] offset:96
  global_load_dwordx4 v[48:51], v6, s[56:57] offset:128
  global_load_dwordx4 v[52:55], v6, s[56:57] offset:160
  global_load_dwordx4 v[56:59], v6, s[56:57] offset:192
  global_load_dwordx4 v[60:63], v6, s[56:57] offset:224
  s_lshl_b32 s39, s33, 15
  s_lshl_b32 s43, s34, 12
  s_add_u32 s39, s39, s43
  s_add_u32 s56, s4, s39
  s_addc_u32 s57, s5, 0
  v_lshlrev_b32 v8, 6, v0
  v_and_b32 v9, 0x7ff, v8
  global_load_dwordx4 v[64:67], v8, s[56:57] offset:0
  global_load_dwordx4 v[80:83], v9, s[24:25] offset:0
  global_load_dwordx4 v[68:71], v8, s[56:57] offset:16
  global_load_dwordx4 v[84:87], v9, s[24:25] offset:16
  global_load_dwordx4 v[72:75], v8, s[56:57] offset:32
  global_load_dwordx4 v[88:91], v9, s[24:25] offset:32
  global_load_dwordx4 v[76:79], v8, s[56:57] offset:48
  global_load_dwordx4 v[92:95], v9, s[24:25] offset:48
  v_bfe_u32 v10, v0, 2, 2
  v_lshrrev_b32 v11, 5, v0
  v_lshl_add_u32 v10, v11, 3, v10
  v_lshlrev_b32 v10, 6, v10
  v_bfe_u32 v11, v0, 4, 1
  v_lshl_add_u32 v10, v11, 5, v10
  v_and_b32 v11, 3, v0
  v_lshl_add_u32 v10, v11, 3, v10
  v_add_u32 v10, s55, v10
  s_waitcnt vmcnt(8)
  ds_read_b64_tr_b16 a[0:1], v10 offset:0
  ds_read_b64_tr_b16 a[2:3], v10 offset:256
  ds_read_b64_tr_b16 a[4:5], v10 offset:1024
  ds_read_b64_tr_b16 a[6:7], v10 offset:1280
  ds_read_b64_tr_b16 a[8:9], v10 offset:2048
  ds_read_b64_tr_b16 a[10:11], v10 offset:2304
  ds_read_b64_tr_b16 a[12:13], v10 offset:3072
  ds_read_b64_tr_b16 a[14:15], v10 offset:3328
  ds_read_b64_tr_b16 a[16:17], v10 offset:4096
  ds_read_b64_tr_b16 a[18:19], v10 offset:4352
  ds_read_b64_tr_b16 a[20:21], v10 offset:5120
  ds_read_b64_tr_b16 a[22:23], v10 offset:5376
  ds_read_b64_tr_b16 a[24:25], v10 offset:6144
  ds_read_b64_tr_b16 a[26:27], v10 offset:6400
  ds_read_b64_tr_b16 a[28:29], v10 offset:7168
  ds_read_b64_tr_b16 a[30:31], v10 offset:7424
  s_waitcnt lgkmcnt(0)
  s_cmp_eq_u32 s54, 1
  s_cbranch_scc1 L_KVB_V
  v_mfma_f32_32x32x16_bf16 v[16:31], a[0:3], v[32:35], 0
  v_mfma_f32_32x32x16_bf16 v[16:31], a[4:7], v[36:39], v[16:31]
  v_mfma_f32_32x32x16_bf16 v[16:31], a[8:11], v[40:43], v[16:31]
  v_mfma_f32_32x32x16_bf16 v[16:31], a[12:15], v[44:47], v[16:31]
  v_mfma_f32_32x32x16_bf16 v[16:31], a[16:19], v[48:51], v[16:31]
  v_mfma_f32_32x32x16_bf16 v[16:31], a[20:23], v[52:55], v[16:31]
  v_mfma_f32_32x32x16_bf16 v[16:31], a[24:27], v[56:59], v[16:31]
  v_mfma_f32_32x32x16_bf16 v[16:31], a[28:31], v[60:63], v[16:31]
  s_branch L_KVB_E
L_KVB_V:
  v_mfma_f32_32x32x16_bf16 v[16:31], v[32:35], a[0:3], 0
  v_mfma_f32_32x32x16_bf16 v[16:31], v[36:39], a[4:7], v[16:31]
  v_mfma_f32_32x32x16_bf16 v[16:31], v[40:43], a[8:11], v[16:31]
  v_mfma_f32_32x32x16_bf16 v[16:31], v[44:47], a[12:15], v[16:31]
  v_mfma_f32_32x32x16_bf16 v[16:31], v[48:51], a[16:19], v[16:31]
  v_mfma_f32_32x32x16_bf16 v[16:31], v[52:55], a[20:23], v[16:31]
  v_mfma_f32_32x32x16_bf16 v[16:31], v[56:59], a[24:27], v[16:31]
  v_mfma_f32_32x32x16_bf16 v[16:31], v[60:63], a[28:31], v[16:31]
L_KVB_E:
  s_waitcnt vmcnt(0)
  v_mov_b32 v12, 0
  v_lshlrev_b32 v13, 16, v64
  v_lshlrev_b32 v14, 16, v80
  v_fmac_f32 v12, v13, v14
  v_and_b32 v13, 0xffff0000, v64
  v_and_b32 v14, 0xffff0000, v80
  v_fmac_f32 v12, v13, v14
  v_lshlrev_b32 v13, 16, v65
  v_lshlrev_b32 v14, 16, v81
  v_fmac_f32 v12, v13, v14
  v_and_b32 v13, 0xffff0000, v65
  v_and_b32 v14, 0xffff0000, v81
  v_fmac_f32 v12, v13, v14
  v_lshlrev_b32 v13, 16, v66
  v_lshlrev_b32 v14, 16, v82
  v_fmac_f32 v12, v13, v14
  v_and_b32 v13, 0xffff0000, v66
  v_and_b32 v14, 0xffff0000, v82
  v_fmac_f32 v12, v13, v14
  v_lshlrev_b32 v13, 16, v67
  v_lshlrev_b32 v14, 16, v83
  v_fmac_f32 v12, v13, v14
  v_and_b32 v13, 0xffff0000, v67
  v_and_b32 v14, 0xffff0000, v83
  v_fmac_f32 v12, v13, v14
  v_lshlrev_b32 v13, 16, v68
  v_lshlrev_b32 v14, 16, v84
  v_fmac_f32 v12, v13, v14
  v_and_b32 v13, 0xffff0000, v68
  v_and_b32 v14, 0xffff0000, v84
  v_fmac_f32 v12, v13, v14
  v_lshlrev_b32 v13, 16, v69
  v_lshlrev_b32 v14, 16, v85
  v_fmac_f32 v12, v13, v14
  v_and_b32 v13, 0xffff0000, v69
  v_and_b32 v14, 0xffff0000, v85
  v_fmac_f32 v12, v13, v14
  v_lshlrev_b32 v13, 16, v70
  v_lshlrev_b32 v14, 16, v86
  v_fmac_f32 v12, v13, v14
  v_and_b32 v13, 0xffff0000, v70
  v_and_b32 v14, 0xffff0000, v86
  v_fmac_f32 v12, v13, v14
  v_lshlrev_b32 v13, 16, v71
  v_lshlrev_b32 v14, 16, v87
  v_fmac_f32 v12, v13, v14
  v_and_b32 v13, 0xffff0000, v71
  v_and_b32 v14, 0xffff0000, v87
  v_fmac_f32 v12, v13, v14
  v_lshlrev_b32 v13, 16, v72
  v_lshlrev_b32 v14, 16, v88
  v_fmac_f32 v12, v13, v14
  v_and_b32 v13, 0xffff0000, v72
  v_and_b32 v14, 0xffff0000, v88
  v_fmac_f32 v12, v13, v14
  v_lshlrev_b32 v13, 16, v73
  v_lshlrev_b32 v14, 16, v89
  v_fmac_f32 v12, v13, v14
  v_and_b32 v13, 0xffff0000, v73
  v_and_b32 v14, 0xffff0000, v89
  v_fmac_f32 v12, v13, v14
  v_lshlrev_b32 v13, 16, v74
  v_lshlrev_b32 v14, 16, v90
  v_fmac_f32 v12, v13, v14
  v_and_b32 v13, 0xffff0000, v74
  v_and_b32 v14, 0xffff0000, v90
  v_fmac_f32 v12, v13, v14
  v_lshlrev_b32 v13, 16, v75
  v_lshlrev_b32 v14, 16, v91
  v_fmac_f32 v12, v13, v14
  v_and_b32 v13, 0xffff0000, v75
  v_and_b32 v14, 0xffff0000, v91
  v_fmac_f32 v12, v13, v14
  v_lshlrev_b32 v13, 16, v76
  v_lshlrev_b32 v14, 16, v92
  v_fmac_f32 v12, v13, v14
  v_and_b32 v13, 0xffff0000, v76
  v_and_b32 v14, 0xffff0000, v92
  v_fmac_f32 v12, v13, v14
  v_lshlrev_b32 v13, 16, v77
  v_lshlrev_b32 v14, 16, v93
  v_fmac_f32 v12, v13, v14
  v_and_b32 v13, 0xffff0000, v77
  v_and_b32 v14, 0xffff0000, v93
  v_fmac_f32 v12, v13, v14
  v_lshlrev_b32 v13, 16, v78
  v_lshlrev_b32 v14, 16, v94
  v_fmac_f32 v12, v13, v14
  v_and_b32 v13, 0xffff0000, v78
  v_and_b32 v14, 0xffff0000, v94
  v_fmac_f32 v12, v13, v14
  v_lshlrev_b32 v13, 16, v79
  v_lshlrev_b32 v14, 16, v95
  v_fmac_f32 v12, v13, v14
  v_and_b32 v13, 0xffff0000, v79
  v_and_b32 v14, 0xffff0000, v95
  v_fmac_f32 v12, v13, v14
  ds_swizzle_b32 v13, v12 offset:1055
  s_waitcnt lgkmcnt(0)
  v_add_f32 v12, v12, v13
  ds_swizzle_b32 v13, v12 offset:2079
  s_waitcnt lgkmcnt(0)
  v_add_f32 v12, v12, v13
  ds_swizzle_b32 v13, v12 offset:4127
  s_waitcnt lgkmcnt(0)
  v_add_f32 v12, v12, v13
  ds_swizzle_b32 v13, v12 offset:8223
  s_waitcnt lgkmcnt(0)
  v_add_f32 v12, v12, v13
  ds_swizzle_b32 v13, v12 offset:16415
  s_waitcnt lgkmcnt(0)
  v_add_f32 v12, v12, v13
  v_mul_f32 v12, 0xbfb8aa3b, v12
  v_exp_f32 v12, v12
  s_nop 0
  v_add_f32 v12, 1.0, v12
  v_rcp_f32 v12, v12
  s_lshl_b32 s39, s33, 6
  s_lshl_b32 s43, s34, 3
  s_add_u32 s39, s39, s43
  s_add_u32 s39, s39, 71565312
  v_lshrrev_b32 v13, 5, v0
  v_lshl_add_u32 v13, v13, 2, s39
  s_mov_b32 exec_lo, 1
  s_mov_b32 exec_hi, 1
  global_store_dword v13, v12, s[30:31] sc1
  s_mov_b64 exec, -1
  s_lshl_b32 s39, s34, 12
  v_lshl_add_u32 v11, v0, 4, s39
  v_add_u32 v11, 0x10000, v11
  ds_write_b128 v11, v[16:19] offset:0
  ds_write_b128 v11, v[20:23] offset:1024
  ds_write_b128 v11, v[24:27] offset:2048
  ds_write_b128 v11, v[28:31] offset:3072
  s_waitcnt lgkmcnt(0)
  s_barrier
  s_cmp_ge_u32 s34, 2
  s_cbranch_scc1 L_KVB_D
  s_lshl_b32 s39, s34, 11
  v_lshl_add_u32 v11, v0, 4, s39
  v_add_u32 v11, 0x10000, v11
  ds_read_b128 v[32:35], v11 offset:0
  ds_read_b128 v[36:39], v11 offset:1024
  ds_read_b128 v[40:43], v11 offset:4096
  ds_read_b128 v[44:47], v11 offset:5120
  ds_read_b128 v[48:51], v11 offset:8192
  ds_read_b128 v[52:55], v11 offset:9216
  ds_read_b128 v[56:59], v11 offset:12288
  ds_read_b128 v[60:63], v11 offset:13312
  ds_read_b128 v[64:67], v11 offset:16384
  ds_read_b128 v[68:71], v11 offset:17408
  ds_read_b128 v[72:75], v11 offset:20480
  ds_read_b128 v[76:79], v11 offset:21504
  ds_read_b128 v[80:83], v11 offset:24576
  ds_read_b128 v[84:87], v11 offset:25600
  ds_read_b128 v[88:91], v11 offset:28672
  ds_read_b128 v[92:95], v11 offset:29696
  s_waitcnt lgkmcnt(0)
  v_add_f32 v32, v32, v40
  v_add_f32 v33, v33, v41
  v_add_f32 v34, v34, v42
  v_add_f32 v35, v35, v43
  v_add_f32 v36, v36, v44
  v_add_f32 v37, v37, v45
  v_add_f32 v38, v38, v46
  v_add_f32 v39, v39, v47
  v_add_f32 v32, v32, v48
  v_add_f32 v33, v33, v49
  v_add_f32 v34, v34, v50
  v_add_f32 v35, v35, v51
  v_add_f32 v36, v36, v52
  v_add_f32 v37, v37, v53
  v_add_f32 v38, v38, v54
  v_add_f32 v39, v39, v55
  v_add_f32 v32, v32, v56
  v_add_f32 v33, v33, v57
  v_add_f32 v34, v34, v58
  v_add_f32 v35, v35, v59
  v_add_f32 v36, v36, v60
  v_add_f32 v37, v37, v61
  v_add_f32 v38, v38, v62
  v_add_f32 v39, v39, v63
  v_add_f32 v32, v32, v64
  v_add_f32 v33, v33, v65
  v_add_f32 v34, v34, v66
  v_add_f32 v35, v35, v67
  v_add_f32 v36, v36, v68
  v_add_f32 v37, v37, v69
  v_add_f32 v38, v38, v70
  v_add_f32 v39, v39, v71
  v_add_f32 v32, v32, v72
  v_add_f32 v33, v33, v73
  v_add_f32 v34, v34, v74
  v_add_f32 v35, v35, v75
  v_add_f32 v36, v36, v76
  v_add_f32 v37, v37, v77
  v_add_f32 v38, v38, v78
  v_add_f32 v39, v39, v79
  v_add_f32 v32, v32, v80
  v_add_f32 v33, v33, v81
  v_add_f32 v34, v34, v82
  v_add_f32 v35, v35, v83
  v_add_f32 v36, v36, v84
  v_add_f32 v37, v37, v85
  v_add_f32 v38, v38, v86
  v_add_f32 v39, v39, v87
  v_add_f32 v32, v32, v88
  v_add_f32 v33, v33, v89
  v_add_f32 v34, v34, v90
  v_add_f32 v35, v35, v91
  v_add_f32 v36, v36, v92
  v_add_f32 v37, v37, v93
  v_add_f32 v38, v38, v94
  v_add_f32 v39, v39, v95
  v_cvt_pk_bf16_f32 v16, v32, v33
  v_cvt_pk_bf16_f32 v17, v34, v35
  v_cvt_pk_bf16_f32 v18, v36, v37
  v_cvt_pk_bf16_f32 v19, v38, v39
  s_lshl_b32 s39, s54, 17
  s_lshl_b32 s43, s53, 11
  s_add_u32 s39, s39, s43
  s_lshl_b32 s43, s34, 10
  s_add_u32 s39, s39, s43
  s_add_u32 s39, s39, 71303168
  v_lshl_add_u32 v11, v0, 4, s39
  global_store_dwordx4 v11, v[16:19], s[30:31] sc1
L_KVB_D:
  s_waitcnt vmcnt(0)
  s_barrier
  s_cmp_lg_u32 s34, 0
  s_cbranch_scc1 S1
  v_mov_b32 v2, 40
  v_mov_b32 v3, 1
  s_mov_b64 exec, 1
  global_atomic_add v2, v3, s[28:29] sc1
  s_mov_b64 exec, -1
S1:
  s_mov_b32 s52, 0
L_G1:
  s_mov_b32 s63, 8192
  s_mov_b32 s64, 18
  s_mov_b32 s61, 0
  s_cmp_eq_u32 s52, 2
  s_cbranch_scc1 L_G1Q
  s_lshr_b32 s53, s51, 3
  s_lshl_b32 s39, s52, 2
  s_add_u32 s53, s53, s39
  s_add_u32 s53, s53, 1
  s_cmp_eq_u32 s53, 8
  s_cbranch_scc1 L_G1B
  s_and_b32 s54, s51, 7
  s_lshl_b32 s39, s50, 3
  s_add_u32 s54, s54, s39
  s_and_b32 s55, s54, 15
  s_mov_b32 s60, 16777216
  s_cmp_ge_u32 s54, 16
  s_cselect_b64 s[58:59], s[12:13], s[10:11]
  s_cselect_b32 s60, 33554432, s60
  s_cselect_b32 s61, 1, 0
  s_lshl_b32 s62, s53, 2
  s_add_u32 s62, s62, 64
  s_mov_b32 s65, 4
  s_branch L_G1C
L_G1B:
  s_and_b32 s53, s51, 7
  s_mov_b32 s55, s50
  s_mov_b64 s[58:59], s[16:17]
  s_mov_b32 s60, 92274688
  s_mov_b32 s61, 2
  s_mov_b32 s62, 40
  s_mov_b32 s63, 2048
  s_mov_b32 s64, 16
  s_mov_b32 s65, 1
  s_branch L_G1C
L_G1Q:
  s_lshr_b32 s53, s51, 2
  s_and_b32 s55, s51, 3
  s_lshl_b32 s39, s50, 2
  s_add_u32 s55, s55, s39
  s_mov_b64 s[58:59], s[8:9]
  s_mov_b32 s60, 0
  s_lshl_b32 s62, s53, 2
  s_add_u32 s62, s62, 96
  s_mov_b32 s65, 1
L_G1C:
  s_lshl_b32 s39, s55, 9
  s_add_u32 s58, s58, s39
  s_addc_u32 s59, s59, 0
  s_lshl_b32 s39, s53, 19
  s_add_u32 s56, s4, s39
  s_addc_u32 s57, s5, 0
  s_and_b32 s41, s34, 1
  s_lshr_b32 s42, s34, 1
  v_lshrrev_b32 v16, 3, v0
  s_mul_i32 s43, s34, 32
  v_add_u32 v16, s43, v16
  v_and_b32 v17, 7, v0
  v_add_u32 v18, 0, v16
  v_bfe_u32 v19, v18, 1, 3
  v_xor_b32 v19, v19, v17
  v_lshlrev_b32 v19, 4, v19
  v_lshl_add_u32 v2, v18, 11, v19
  v_add_u32 v18, 8, v16
  v_bfe_u32 v19, v18, 1, 3
  v_xor_b32 v19, v19, v17
  v_lshlrev_b32 v19, 4, v19
  v_lshl_add_u32 v3, v18, 11, v19
  v_subrev_u32 v3, 1024, v3
  v_add_u32 v18, 16, v16
  v_bfe_u32 v19, v18, 1, 3
  v_xor_b32 v19, v19, v17
  v_lshlrev_b32 v19, 4, v19
  v_lshl_add_u32 v4, v18, 11, v19
  v_subrev_u32 v4, 2048, v4
  v_add_u32 v18, 24, v16
  v_bfe_u32 v19, v18, 1, 3
  v_xor_b32 v19, v19, v17
  v_lshlrev_b32 v19, 4, v19
  v_lshl_add_u32 v5, v18, 11, v19
  v_subrev_u32 v5, 3072, v5
  v_lshrrev_b32 v16, 5, v0
  s_add_u32 s43, s34, s34
  s_lshl_b32 s43, s43, 2
  v_add_u32 v16, s43, v16
  v_and_b32 v17, 31, v0
  s_mov_b32 s44, s63
  s_lshl_b32 s48, s44, 6
  v_add_u32 v18, 0, v16
  v_and_b32 v19, 3, v18
  v_lshlrev_b32 v19, 2, v19
  v_xor_b32 v19, v19, v17
  v_bfe_u32 v20, v18, 3, 1
  v_lshlrev_b32 v20, 1, v20
  v_xor_b32 v19, v19, v20
  v_lshlrev_b32 v19, 4, v19
  v_mul_lo_u32 v18, v18, s44
  v_add_u32 v6, v18, v19
  v_add_u32 v18, 2, v16
  v_and_b32 v19, 3, v18
  v_lshlrev_b32 v19, 2, v19
  v_xor_b32 v19, v19, v17
  v_bfe_u32 v20, v18, 3, 1
  v_lshlrev_b32 v20, 1, v20
  v_xor_b32 v19, v19, v20
  v_lshlrev_b32 v19, 4, v19
  v_mul_lo_u32 v18, v18, s44
  v_add_u32 v7, v18, v19
  v_subrev_u32 v7, 1024, v7
  v_add_u32 v18, 4, v16
  v_and_b32 v19, 3, v18
  v_lshlrev_b32 v19, 2, v19
  v_xor_b32 v19, v19, v17
  v_bfe_u32 v20, v18, 3, 1
  v_lshlrev_b32 v20, 1, v20
  v_xor_b32 v19, v19, v20
  v_lshlrev_b32 v19, 4, v19
  v_mul_lo_u32 v18, v18, s44
  v_add_u32 v8, v18, v19
  v_subrev_u32 v8, 2048, v8
  v_add_u32 v18, 6, v16
  v_and_b32 v19, 3, v18
  v_lshlrev_b32 v19, 2, v19
  v_xor_b32 v19, v19, v17
  v_bfe_u32 v20, v18, 3, 1
  v_lshlrev_b32 v20, 1, v20
  v_xor_b32 v19, v19, v20
  v_lshlrev_b32 v19, 4, v19
  v_mul_lo_u32 v18, v18, s44
  v_add_u32 v9, v18, v19
  v_subrev_u32 v9, 3072, v9
  v_and_b32 v16, 31, v0
  v_lshrrev_b32 v17, 5, v0
  v_bfe_u32 v18, v16, 1, 3
  s_mul_i32 s43, s41, 16384
  v_lshl_add_u32 v16, v16, 7, s43
  v_add_u32 v19, 0, v17
  v_xor_b32 v19, v19, v18
  v_lshl_add_u32 v10, v19, 4, v16
  v_add_u32 v19, 2, v17
  v_xor_b32 v19, v19, v18
  v_lshl_add_u32 v11, v19, 4, v16
  v_add_u32 v19, 4, v17
  v_xor_b32 v19, v19, v18
  v_lshl_add_u32 v12, v19, 4, v16
  v_add_u32 v19, 6, v17
  v_xor_b32 v19, v19, v18
  v_lshl_add_u32 v13, v19, 4, v16
  v_bfe_u32 v16, v0, 2, 2
  v_lshrrev_b32 v17, 5, v0
  v_lshl_add_u32 v17, v17, 3, v16
  v_mul_u32_u24 v17, 512, v17
  v_bfe_u32 v18, v0, 4, 1
  v_lshlrev_b32 v18, 5, v18
  v_and_b32 v19, 3, v0
  v_lshl_add_u32 v18, v19, 3, v18
  v_add_u32 v17, v17, v18
  v_add_u32 v17, 32768, v17
  s_mul_i32 s43, s42, 2
  s_add_u32 s43, s43, 0
  v_xor_b32 v19, s43, v16
  v_lshl_add_u32 v14, v19, 6, v17
  s_mul_i32 s43, s42, 2
  s_add_u32 s43, s43, 1
  v_xor_b32 v19, s43, v16
  v_lshl_add_u32 v15, v19, 6, v17
  v_and_b32 v16, 15, v0
  v_lshrrev_b32 v17, 4, v0
  v_bfe_u32 v18, v16, 1, 3
  s_mul_i32 s43, s41, 16384
  v_lshl_add_u32 v16, v16, 7, s43
  v_add_u32 v19, 0, v17
  v_xor_b32 v19, v19, v18
  v_lshl_add_u32 v10, v19, 4, v16
  v_add_u32 v19, 4, v17
  v_xor_b32 v19, v19, v18
  v_lshl_add_u32 v11, v19, 4, v16
  v_bfe_u32 v16, v0, 2, 2
  v_lshl_add_u32 v18, v17, 3, v16
  v_mul_u32_u24 v18, 512, v18
  v_and_b32 v17, 1, v17
  v_lshlrev_b32 v17, 5, v17
  v_and_b32 v19, 3, v0
  v_lshl_add_u32 v17, v19, 3, v17
  v_add_u32 v17, v17, v18
  v_add_u32 v17, 32768, v17
  s_mul_i32 s43, s42, 2
  s_add_u32 s43, s43, 0
  v_xor_b32 v19, s43, v16
  v_lshl_add_u32 v14, v19, 6, v17
  v_xor_b32 v12, 32, v14
  s_mul_i32 s43, s42, 2
  s_add_u32 s43, s43, 1
  v_xor_b32 v19, s43, v16
  v_lshl_add_u32 v15, v19, 6, v17
  v_xor_b32 v13, 32, v15
  s_mul_i32 s45, s34, 4096
  s_mul_i32 s46, s34, 4096
  s_add_u32 s46, s46, 32768
  s_barrier
  s_mov_b32 m0, s45
  s_nop 0
  global_load_lds_dwordx4 v2, s[56:57] offset:0
  global_load_lds_dwordx4 v3, s[56:57] offset:1024
  global_load_lds_dwordx4 v4, s[56:57] offset:2048
  global_load_lds_dwordx4 v5, s[56:57] offset:3072
  s_mov_b32 m0, s46
  s_nop 0
  global_load_lds_dwordx4 v6, s[58:59] offset:0
  global_load_lds_dwordx4 v7, s[58:59] offset:1024
  global_load_lds_dwordx4 v8, s[58:59] offset:2048
  global_load_lds_dwordx4 v9, s[58:59] offset:3072
  s_add_u32 s56, s56, 128
  s_addc_u32 s57, s57, 0
  s_add_u32 s58, s58, s48
  s_addc_u32 s59, s59, 0
  s_xor_b32 s45, s45, 0x10000
  s_xor_b32 s46, s46, 0x10000
  s_mov_b32 m0, s45
  s_nop 0
  global_load_lds_dwordx4 v2, s[56:57] offset:0
  global_load_lds_dwordx4 v3, s[56:57] offset:1024
  global_load_lds_dwordx4 v4, s[56:57] offset:2048
  global_load_lds_dwordx4 v5, s[56:57] offset:3072
  s_mov_b32 m0, s46
  s_nop 0
  global_load_lds_dwordx4 v6, s[58:59] offset:0
  global_load_lds_dwordx4 v7, s[58:59] offset:1024
  global_load_lds_dwordx4 v8, s[58:59] offset:2048
  global_load_lds_dwordx4 v9, s[58:59] offset:3072
  s_add_u32 s56, s56, 128
  s_addc_u32 s57, s57, 0
  s_add_u32 s58, s58, s48
  s_addc_u32 s59, s59, 0
  s_xor_b32 s45, s45, 0x10000
  s_xor_b32 s46, s46, 0x10000
  s_cmp_lg_u32 s52, 0
  s_cbranch_scc1 L_G1P
  s_waitcnt vmcnt(8)
  s_branch L_G1M
L_G1P:
  s_cmp_eq_u32 s70, 2
  s_cbranch_scc1 L_G1S0
  s_cmp_eq_u32 s70, 1
  s_cbranch_scc1 L_G1T0
  v_bfe_u32 v80, v0, 4, 1
  v_and_b32 v82, 15, v0
  v_lshl_add_u32 v80, v80, 5, v82
  v_lshrrev_b32 v82, 5, v0
  v_lshlrev_b32 v82, 3, v82
  v_lshl_add_u32 v80, v80, 4, v82
  v_accvgpr_read_b32 v84, a0
  v_accvgpr_read_b32 v85, a1
  v_accvgpr_read_b32 v86, a2
  v_accvgpr_read_b32 v87, a3
  v_cvt_pk_bf16_f32 v92, v84, v85
  v_cvt_pk_bf16_f32 v93, v86, v87
  global_store_dwordx2 v80, v[92:93], s[66:67] offset:0 sc1
  v_accvgpr_read_b32 v88, a4
  v_accvgpr_read_b32 v89, a5
  v_accvgpr_read_b32 v90, a6
  v_accvgpr_read_b32 v91, a7
  v_cvt_pk_bf16_f32 v94, v88, v89
  v_cvt_pk_bf16_f32 v95, v90, v91
  global_store_dwordx2 v80, v[94:95], s[66:67] offset:1024 sc1
  v_accvgpr_read_b32 v84, a8
  v_accvgpr_read_b32 v85, a9
  v_accvgpr_read_b32 v86, a10
  v_accvgpr_read_b32 v87, a11
  v_cvt_pk_bf16_f32 v96, v84, v85
  v_cvt_pk_bf16_f32 v97, v86, v87
  global_store_dwordx2 v80, v[96:97], s[66:67] offset:2048 sc1
  v_accvgpr_read_b32 v88, a12
  v_accvgpr_read_b32 v89, a13
  v_accvgpr_read_b32 v90, a14
  v_accvgpr_read_b32 v91, a15
  v_cvt_pk_bf16_f32 v98, v88, v89
  v_cvt_pk_bf16_f32 v99, v90, v91
  global_store_dwordx2 v80, v[98:99], s[66:67] offset:3072 sc1
  v_accvgpr_read_b32 v84, a16
  v_accvgpr_read_b32 v85, a17
  v_accvgpr_read_b32 v86, a18
  v_accvgpr_read_b32 v87, a19
  v_cvt_pk_bf16_f32 v100, v84, v85
  v_cvt_pk_bf16_f32 v101, v86, v87
  global_store_dwordx2 v80, v[100:101], s[66:67] offset:256 sc1
  v_accvgpr_read_b32 v88, a20
  v_accvgpr_read_b32 v89, a21
  v_accvgpr_read_b32 v90, a22
  v_accvgpr_read_b32 v91, a23
  v_cvt_pk_bf16_f32 v102, v88, v89
  v_cvt_pk_bf16_f32 v103, v90, v91
  global_store_dwordx2 v80, v[102:103], s[66:67] offset:1280 sc1
  v_accvgpr_read_b32 v84, a24
  v_accvgpr_read_b32 v85, a25
  v_accvgpr_read_b32 v86, a26
  v_accvgpr_read_b32 v87, a27
  v_cvt_pk_bf16_f32 v104, v84, v85
  v_cvt_pk_bf16_f32 v105, v86, v87
  global_store_dwordx2 v80, v[104:105], s[66:67] offset:2304 sc1
  v_accvgpr_read_b32 v88, a28
  v_accvgpr_read_b32 v89, a29
  v_accvgpr_read_b32 v90, a30
  v_accvgpr_read_b32 v91, a31
  v_cvt_pk_bf16_f32 v106, v88, v89
  v_cvt_pk_bf16_f32 v107, v90, v91
  global_store_dwordx2 v80, v[106:107], s[66:67] offset:3328 sc1
  s_add_u32 s66, s66, 262144
  s_addc_u32 s67, s67, 0
  v_accvgpr_read_b32 v84, a32
  v_accvgpr_read_b32 v85, a33
  v_accvgpr_read_b32 v86, a34
  v_accvgpr_read_b32 v87, a35
  v_cvt_pk_bf16_f32 v92, v84, v85
  v_cvt_pk_bf16_f32 v93, v86, v87
  global_store_dwordx2 v80, v[92:93], s[66:67] offset:0 sc1
  v_accvgpr_read_b32 v88, a36
  v_accvgpr_read_b32 v89, a37
  v_accvgpr_read_b32 v90, a38
  v_accvgpr_read_b32 v91, a39
  v_cvt_pk_bf16_f32 v94, v88, v89
  v_cvt_pk_bf16_f32 v95, v90, v91
  global_store_dwordx2 v80, v[94:95], s[66:67] offset:1024 sc1
  v_accvgpr_read_b32 v84, a40
  v_accvgpr_read_b32 v85, a41
  v_accvgpr_read_b32 v86, a42
  v_accvgpr_read_b32 v87, a43
  v_cvt_pk_bf16_f32 v96, v84, v85
  v_cvt_pk_bf16_f32 v97, v86, v87
  global_store_dwordx2 v80, v[96:97], s[66:67] offset:2048 sc1
  v_accvgpr_read_b32 v88, a44
  v_accvgpr_read_b32 v89, a45
  v_accvgpr_read_b32 v90, a46
  v_accvgpr_read_b32 v91, a47
  v_cvt_pk_bf16_f32 v98, v88, v89
  v_cvt_pk_bf16_f32 v99, v90, v91
  global_store_dwordx2 v80, v[98:99], s[66:67] offset:3072 sc1
  v_accvgpr_read_b32 v84, a48
  v_accvgpr_read_b32 v85, a49
  v_accvgpr_read_b32 v86, a50
  v_accvgpr_read_b32 v87, a51
  v_cvt_pk_bf16_f32 v100, v84, v85
  v_cvt_pk_bf16_f32 v101, v86, v87
  global_store_dwordx2 v80, v[100:101], s[66:67] offset:256 sc1
  v_accvgpr_read_b32 v88, a52
  v_accvgpr_read_b32 v89, a53
  v_accvgpr_read_b32 v90, a54
  v_accvgpr_read_b32 v91, a55
  v_cvt_pk_bf16_f32 v102, v88, v89
  v_cvt_pk_bf16_f32 v103, v90, v91
  global_store_dwordx2 v80, v[102:103], s[66:67] offset:1280 sc1
  v_accvgpr_read_b32 v84, a56
  v_accvgpr_read_b32 v85, a57
  v_accvgpr_read_b32 v86, a58
  v_accvgpr_read_b32 v87, a59
  v_cvt_pk_bf16_f32 v104, v84, v85
  v_cvt_pk_bf16_f32 v105, v86, v87
  global_store_dwordx2 v80, v[104:105], s[66:67] offset:2304 sc1
  v_accvgpr_read_b32 v88, a60
  v_accvgpr_read_b32 v89, a61
  v_accvgpr_read_b32 v90, a62
  v_accvgpr_read_b32 v91, a63
  v_cvt_pk_bf16_f32 v106, v88, v89
  v_cvt_pk_bf16_f32 v107, v90, v91
  global_store_dwordx2 v80, v[106:107], s[66:67] offset:3328 sc1
  s_add_u32 s66, s66, 262144
  s_addc_u32 s67, s67, 0
  v_accvgpr_read_b32 v84, a64
  v_accvgpr_read_b32 v85, a65
  v_accvgpr_read_b32 v86, a66
  v_accvgpr_read_b32 v87, a67
  v_cvt_pk_bf16_f32 v92, v84, v85
  v_cvt_pk_bf16_f32 v93, v86, v87
  global_store_dwordx2 v80, v[92:93], s[66:67] offset:0 sc1
  v_accvgpr_read_b32 v88, a68
  v_accvgpr_read_b32 v89, a69
  v_accvgpr_read_b32 v90, a70
  v_accvgpr_read_b32 v91, a71
  v_cvt_pk_bf16_f32 v94, v88, v89
  v_cvt_pk_bf16_f32 v95, v90, v91
  global_store_dwordx2 v80, v[94:95], s[66:67] offset:1024 sc1
  v_accvgpr_read_b32 v84, a72
  v_accvgpr_read_b32 v85, a73
  v_accvgpr_read_b32 v86, a74
  v_accvgpr_read_b32 v87, a75
  v_cvt_pk_bf16_f32 v96, v84, v85
  v_cvt_pk_bf16_f32 v97, v86, v87
  global_store_dwordx2 v80, v[96:97], s[66:67] offset:2048 sc1
  v_accvgpr_read_b32 v88, a76
  v_accvgpr_read_b32 v89, a77
  v_accvgpr_read_b32 v90, a78
  v_accvgpr_read_b32 v91, a79
  v_cvt_pk_bf16_f32 v98, v88, v89
  v_cvt_pk_bf16_f32 v99, v90, v91
  global_store_dwordx2 v80, v[98:99], s[66:67] offset:3072 sc1
  v_accvgpr_read_b32 v84, a80
  v_accvgpr_read_b32 v85, a81
  v_accvgpr_read_b32 v86, a82
  v_accvgpr_read_b32 v87, a83
  v_cvt_pk_bf16_f32 v100, v84, v85
  v_cvt_pk_bf16_f32 v101, v86, v87
  global_store_dwordx2 v80, v[100:101], s[66:67] offset:256 sc1
  v_accvgpr_read_b32 v88, a84
  v_accvgpr_read_b32 v89, a85
  v_accvgpr_read_b32 v90, a86
  v_accvgpr_read_b32 v91, a87
  v_cvt_pk_bf16_f32 v102, v88, v89
  v_cvt_pk_bf16_f32 v103, v90, v91
  global_store_dwordx2 v80, v[102:103], s[66:67] offset:1280 sc1
  v_accvgpr_read_b32 v84, a88
  v_accvgpr_read_b32 v85, a89
  v_accvgpr_read_b32 v86, a90
  v_accvgpr_read_b32 v87, a91
  v_cvt_pk_bf16_f32 v104, v84, v85
  v_cvt_pk_bf16_f32 v105, v86, v87
  global_store_dwordx2 v80, v[104:105], s[66:67] offset:2304 sc1
  v_accvgpr_read_b32 v88, a92
  v_accvgpr_read_b32 v89, a93
  v_accvgpr_read_b32 v90, a94
  v_accvgpr_read_b32 v91, a95
  v_cvt_pk_bf16_f32 v106, v88, v89
  v_cvt_pk_bf16_f32 v107, v90, v91
  global_store_dwordx2 v80, v[106:107], s[66:67] offset:3328 sc1
  s_add_u32 s66, s66, 262144
  s_addc_u32 s67, s67, 0
  v_accvgpr_read_b32 v84, a96
  v_accvgpr_read_b32 v85, a97
  v_accvgpr_read_b32 v86, a98
  v_accvgpr_read_b32 v87, a99
  v_cvt_pk_bf16_f32 v92, v84, v85
  v_cvt_pk_bf16_f32 v93, v86, v87
  global_store_dwordx2 v80, v[92:93], s[66:67] offset:0 sc1
  v_accvgpr_read_b32 v88, a100
  v_accvgpr_read_b32 v89, a101
  v_accvgpr_read_b32 v90, a102
  v_accvgpr_read_b32 v91, a103
  v_cvt_pk_bf16_f32 v94, v88, v89
  v_cvt_pk_bf16_f32 v95, v90, v91
  global_store_dwordx2 v80, v[94:95], s[66:67] offset:1024 sc1
  v_accvgpr_read_b32 v84, a104
  v_accvgpr_read_b32 v85, a105
  v_accvgpr_read_b32 v86, a106
  v_accvgpr_read_b32 v87, a107
  v_cvt_pk_bf16_f32 v96, v84, v85
  v_cvt_pk_bf16_f32 v97, v86, v87
  global_store_dwordx2 v80, v[96:97], s[66:67] offset:2048 sc1
  v_accvgpr_read_b32 v88, a108
  v_accvgpr_read_b32 v89, a109
  v_accvgpr_read_b32 v90, a110
  v_accvgpr_read_b32 v91, a111
  v_cvt_pk_bf16_f32 v98, v88, v89
  v_cvt_pk_bf16_f32 v99, v90, v91
  global_store_dwordx2 v80, v[98:99], s[66:67] offset:3072 sc1
  v_accvgpr_read_b32 v84, a112
  v_accvgpr_read_b32 v85, a113
  v_accvgpr_read_b32 v86, a114
  v_accvgpr_read_b32 v87, a115
  v_cvt_pk_bf16_f32 v100, v84, v85
  v_cvt_pk_bf16_f32 v101, v86, v87
  global_store_dwordx2 v80, v[100:101], s[66:67] offset:256 sc1
  v_accvgpr_read_b32 v88, a116
  v_accvgpr_read_b32 v89, a117
  v_accvgpr_read_b32 v90, a118
  v_accvgpr_read_b32 v91, a119
  v_cvt_pk_bf16_f32 v102, v88, v89
  v_cvt_pk_bf16_f32 v103, v90, v91
  global_store_dwordx2 v80, v[102:103], s[66:67] offset:1280 sc1
  v_accvgpr_read_b32 v84, a120
  v_accvgpr_read_b32 v85, a121
  v_accvgpr_read_b32 v86, a122
  v_accvgpr_read_b32 v87, a123
  v_cvt_pk_bf16_f32 v104, v84, v85
  v_cvt_pk_bf16_f32 v105, v86, v87
  global_store_dwordx2 v80, v[104:105], s[66:67] offset:2304 sc1
  v_accvgpr_read_b32 v88, a124
  v_accvgpr_read_b32 v89, a125
  v_accvgpr_read_b32 v90, a126
  v_accvgpr_read_b32 v91, a127
  v_cvt_pk_bf16_f32 v106, v88, v89
  v_cvt_pk_bf16_f32 v107, v90, v91
  global_store_dwordx2 v80, v[106:107], s[66:67] offset:3328 sc1
  s_branch L_G1F0
L_G1T0:
  v_bfe_u32 v80, v0, 4, 1
  v_and_b32 v82, 15, v0
  v_lshl_add_u32 v80, v80, 5, v82
  v_lshrrev_b32 v82, 5, v0
  v_lshlrev_b32 v82, 3, v82
  v_lshl_add_u32 v80, v80, 4, v82
  v_accvgpr_read_b32 v84, a0
  v_accvgpr_read_b32 v85, a1
  v_accvgpr_read_b32 v86, a2
  v_accvgpr_read_b32 v87, a3
  v_cvt_pk_bf16_f32 v92, v84, v85
  v_cvt_pk_bf16_f32 v93, v86, v87
  global_store_dwordx2 v80, v[92:93], s[66:67] offset:0 sc1
  v_accvgpr_read_b32 v88, a4
  v_accvgpr_read_b32 v89, a5
  v_accvgpr_read_b32 v90, a6
  v_accvgpr_read_b32 v91, a7
  v_cvt_pk_bf16_f32 v94, v88, v89
  v_cvt_pk_bf16_f32 v95, v90, v91
  global_store_dwordx2 v80, v[94:95], s[66:67] offset:256 sc1
  v_accvgpr_read_b32 v84, a8
  v_accvgpr_read_b32 v85, a9
  v_accvgpr_read_b32 v86, a10
  v_accvgpr_read_b32 v87, a11
  v_cvt_pk_bf16_f32 v96, v84, v85
  v_cvt_pk_bf16_f32 v97, v86, v87
  global_store_dwordx2 v80, v[96:97], s[66:67] offset:2048 sc1
  v_accvgpr_read_b32 v88, a12
  v_accvgpr_read_b32 v89, a13
  v_accvgpr_read_b32 v90, a14
  v_accvgpr_read_b32 v91, a15
  v_cvt_pk_bf16_f32 v98, v88, v89
  v_cvt_pk_bf16_f32 v99, v90, v91
  global_store_dwordx2 v80, v[98:99], s[66:67] offset:2304 sc1
  v_accvgpr_read_b32 v84, a16
  v_accvgpr_read_b32 v85, a17
  v_accvgpr_read_b32 v86, a18
  v_accvgpr_read_b32 v87, a19
  v_cvt_pk_bf16_f32 v100, v84, v85
  v_cvt_pk_bf16_f32 v101, v86, v87
  global_store_dwordx2 v80, v[100:101], s[66:67] offset:1024 sc1
  v_accvgpr_read_b32 v88, a20
  v_accvgpr_read_b32 v89, a21
  v_accvgpr_read_b32 v90, a22
  v_accvgpr_read_b32 v91, a23
  v_cvt_pk_bf16_f32 v102, v88, v89
  v_cvt_pk_bf16_f32 v103, v90, v91
  global_store_dwordx2 v80, v[102:103], s[66:67] offset:1280 sc1
  v_accvgpr_read_b32 v84, a24
  v_accvgpr_read_b32 v85, a25
  v_accvgpr_read_b32 v86, a26
  v_accvgpr_read_b32 v87, a27
  v_cvt_pk_bf16_f32 v104, v84, v85
  v_cvt_pk_bf16_f32 v105, v86, v87
  global_store_dwordx2 v80, v[104:105], s[66:67] offset:3072 sc1
  v_accvgpr_read_b32 v88, a28
  v_accvgpr_read_b32 v89, a29
  v_accvgpr_read_b32 v90, a30
  v_accvgpr_read_b32 v91, a31
  v_cvt_pk_bf16_f32 v106, v88, v89
  v_cvt_pk_bf16_f32 v107, v90, v91
  global_store_dwordx2 v80, v[106:107], s[66:67] offset:3328 sc1
  s_add_u32 s66, s66, 262144
  s_addc_u32 s67, s67, 0
  v_accvgpr_read_b32 v84, a32
  v_accvgpr_read_b32 v85, a33
  v_accvgpr_read_b32 v86, a34
  v_accvgpr_read_b32 v87, a35
  v_cvt_pk_bf16_f32 v92, v84, v85
  v_cvt_pk_bf16_f32 v93, v86, v87
  global_store_dwordx2 v80, v[92:93], s[66:67] offset:0 sc1
  v_accvgpr_read_b32 v88, a36
  v_accvgpr_read_b32 v89, a37
  v_accvgpr_read_b32 v90, a38
  v_accvgpr_read_b32 v91, a39
  v_cvt_pk_bf16_f32 v94, v88, v89
  v_cvt_pk_bf16_f32 v95, v90, v91
  global_store_dwordx2 v80, v[94:95], s[66:67] offset:256 sc1
  v_accvgpr_read_b32 v84, a40
  v_accvgpr_read_b32 v85, a41
  v_accvgpr_read_b32 v86, a42
  v_accvgpr_read_b32 v87, a43
  v_cvt_pk_bf16_f32 v96, v84, v85
  v_cvt_pk_bf16_f32 v97, v86, v87
  global_store_dwordx2 v80, v[96:97], s[66:67] offset:2048 sc1
  v_accvgpr_read_b32 v88, a44
  v_accvgpr_read_b32 v89, a45
  v_accvgpr_read_b32 v90, a46
  v_accvgpr_read_b32 v91, a47
  v_cvt_pk_bf16_f32 v98, v88, v89
  v_cvt_pk_bf16_f32 v99, v90, v91
  global_store_dwordx2 v80, v[98:99], s[66:67] offset:2304 sc1
  v_accvgpr_read_b32 v84, a48
  v_accvgpr_read_b32 v85, a49
  v_accvgpr_read_b32 v86, a50
  v_accvgpr_read_b32 v87, a51
  v_cvt_pk_bf16_f32 v100, v84, v85
  v_cvt_pk_bf16_f32 v101, v86, v87
  global_store_dwordx2 v80, v[100:101], s[66:67] offset:1024 sc1
  v_accvgpr_read_b32 v88, a52
  v_accvgpr_read_b32 v89, a53
  v_accvgpr_read_b32 v90, a54
  v_accvgpr_read_b32 v91, a55
  v_cvt_pk_bf16_f32 v102, v88, v89
  v_cvt_pk_bf16_f32 v103, v90, v91
  global_store_dwordx2 v80, v[102:103], s[66:67] offset:1280 sc1
  v_accvgpr_read_b32 v84, a56
  v_accvgpr_read_b32 v85, a57
  v_accvgpr_read_b32 v86, a58
  v_accvgpr_read_b32 v87, a59
  v_cvt_pk_bf16_f32 v104, v84, v85
  v_cvt_pk_bf16_f32 v105, v86, v87
  global_store_dwordx2 v80, v[104:105], s[66:67] offset:3072 sc1
  v_accvgpr_read_b32 v88, a60
  v_accvgpr_read_b32 v89, a61
  v_accvgpr_read_b32 v90, a62
  v_accvgpr_read_b32 v91, a63
  v_cvt_pk_bf16_f32 v106, v88, v89
  v_cvt_pk_bf16_f32 v107, v90, v91
  global_store_dwordx2 v80, v[106:107], s[66:67] offset:3328 sc1
  s_add_u32 s66, s66, 262144
  s_addc_u32 s67, s67, 0
  v_accvgpr_read_b32 v84, a64
  v_accvgpr_read_b32 v85, a65
  v_accvgpr_read_b32 v86, a66
  v_accvgpr_read_b32 v87, a67
  v_cvt_pk_bf16_f32 v92, v84, v85
  v_cvt_pk_bf16_f32 v93, v86, v87
  global_store_dwordx2 v80, v[92:93], s[66:67] offset:0 sc1
  v_accvgpr_read_b32 v88, a68
  v_accvgpr_read_b32 v89, a69
  v_accvgpr_read_b32 v90, a70
  v_accvgpr_read_b32 v91, a71
  v_cvt_pk_bf16_f32 v94, v88, v89
  v_cvt_pk_bf16_f32 v95, v90, v91
  global_store_dwordx2 v80, v[94:95], s[66:67] offset:256 sc1
  v_accvgpr_read_b32 v84, a72
  v_accvgpr_read_b32 v85, a73
  v_accvgpr_read_b32 v86, a74
  v_accvgpr_read_b32 v87, a75
  v_cvt_pk_bf16_f32 v96, v84, v85
  v_cvt_pk_bf16_f32 v97, v86, v87
  global_store_dwordx2 v80, v[96:97], s[66:67] offset:2048 sc1
  v_accvgpr_read_b32 v88, a76
  v_accvgpr_read_b32 v89, a77
  v_accvgpr_read_b32 v90, a78
  v_accvgpr_read_b32 v91, a79
  v_cvt_pk_bf16_f32 v98, v88, v89
  v_cvt_pk_bf16_f32 v99, v90, v91
  global_store_dwordx2 v80, v[98:99], s[66:67] offset:2304 sc1
  v_accvgpr_read_b32 v84, a80
  v_accvgpr_read_b32 v85, a81
  v_accvgpr_read_b32 v86, a82
  v_accvgpr_read_b32 v87, a83
  v_cvt_pk_bf16_f32 v100, v84, v85
  v_cvt_pk_bf16_f32 v101, v86, v87
  global_store_dwordx2 v80, v[100:101], s[66:67] offset:1024 sc1
  v_accvgpr_read_b32 v88, a84
  v_accvgpr_read_b32 v89, a85
  v_accvgpr_read_b32 v90, a86
  v_accvgpr_read_b32 v91, a87
  v_cvt_pk_bf16_f32 v102, v88, v89
  v_cvt_pk_bf16_f32 v103, v90, v91
  global_store_dwordx2 v80, v[102:103], s[66:67] offset:1280 sc1
  v_accvgpr_read_b32 v84, a88
  v_accvgpr_read_b32 v85, a89
  v_accvgpr_read_b32 v86, a90
  v_accvgpr_read_b32 v87, a91
  v_cvt_pk_bf16_f32 v104, v84, v85
  v_cvt_pk_bf16_f32 v105, v86, v87
  global_store_dwordx2 v80, v[104:105], s[66:67] offset:3072 sc1
  v_accvgpr_read_b32 v88, a92
  v_accvgpr_read_b32 v89, a93
  v_accvgpr_read_b32 v90, a94
  v_accvgpr_read_b32 v91, a95
  v_cvt_pk_bf16_f32 v106, v88, v89
  v_cvt_pk_bf16_f32 v107, v90, v91
  global_store_dwordx2 v80, v[106:107], s[66:67] offset:3328 sc1
  s_add_u32 s66, s66, 262144
  s_addc_u32 s67, s67, 0
  v_accvgpr_read_b32 v84, a96
  v_accvgpr_read_b32 v85, a97
  v_accvgpr_read_b32 v86, a98
  v_accvgpr_read_b32 v87, a99
  v_cvt_pk_bf16_f32 v92, v84, v85
  v_cvt_pk_bf16_f32 v93, v86, v87
  global_store_dwordx2 v80, v[92:93], s[66:67] offset:0 sc1
  v_accvgpr_read_b32 v88, a100
  v_accvgpr_read_b32 v89, a101
  v_accvgpr_read_b32 v90, a102
  v_accvgpr_read_b32 v91, a103
  v_cvt_pk_bf16_f32 v94, v88, v89
  v_cvt_pk_bf16_f32 v95, v90, v91
  global_store_dwordx2 v80, v[94:95], s[66:67] offset:256 sc1
  v_accvgpr_read_b32 v84, a104
  v_accvgpr_read_b32 v85, a105
  v_accvgpr_read_b32 v86, a106
  v_accvgpr_read_b32 v87, a107
  v_cvt_pk_bf16_f32 v96, v84, v85
  v_cvt_pk_bf16_f32 v97, v86, v87
  global_store_dwordx2 v80, v[96:97], s[66:67] offset:2048 sc1
  v_accvgpr_read_b32 v88, a108
  v_accvgpr_read_b32 v89, a109
  v_accvgpr_read_b32 v90, a110
  v_accvgpr_read_b32 v91, a111
  v_cvt_pk_bf16_f32 v98, v88, v89
  v_cvt_pk_bf16_f32 v99, v90, v91
  global_store_dwordx2 v80, v[98:99], s[66:67] offset:2304 sc1
  v_accvgpr_read_b32 v84, a112
  v_accvgpr_read_b32 v85, a113
  v_accvgpr_read_b32 v86, a114
  v_accvgpr_read_b32 v87, a115
  v_cvt_pk_bf16_f32 v100, v84, v85
  v_cvt_pk_bf16_f32 v101, v86, v87
  global_store_dwordx2 v80, v[100:101], s[66:67] offset:1024 sc1
  v_accvgpr_read_b32 v88, a116
  v_accvgpr_read_b32 v89, a117
  v_accvgpr_read_b32 v90, a118
  v_accvgpr_read_b32 v91, a119
  v_cvt_pk_bf16_f32 v102, v88, v89
  v_cvt_pk_bf16_f32 v103, v90, v91
  global_store_dwordx2 v80, v[102:103], s[66:67] offset:1280 sc1
  v_accvgpr_read_b32 v84, a120
  v_accvgpr_read_b32 v85, a121
  v_accvgpr_read_b32 v86, a122
  v_accvgpr_read_b32 v87, a123
  v_cvt_pk_bf16_f32 v104, v84, v85
  v_cvt_pk_bf16_f32 v105, v86, v87
  global_store_dwordx2 v80, v[104:105], s[66:67] offset:3072 sc1
  v_accvgpr_read_b32 v88, a124
  v_accvgpr_read_b32 v89, a125
  v_accvgpr_read_b32 v90, a126
  v_accvgpr_read_b32 v91, a127
  v_cvt_pk_bf16_f32 v106, v88, v89
  v_cvt_pk_bf16_f32 v107, v90, v91
  global_store_dwordx2 v80, v[106:107], s[66:67] offset:3328 sc1
  s_branch L_G1F0
L_G1S0:
  v_mov_b32 v81, 0x3e8293ee
  v_bfe_u32 v80, v0, 4, 1
  v_and_b32 v82, 15, v0
  v_lshl_add_u32 v80, v80, 5, v82
  v_lshrrev_b32 v82, 5, v0
  v_lshlrev_b32 v82, 3, v82
  v_lshl_add_u32 v80, v80, 4, v82
  v_accvgpr_read_b32 v84, a0
  v_accvgpr_read_b32 v85, a1
  v_accvgpr_read_b32 v86, a2
  v_accvgpr_read_b32 v87, a3
  v_mul_f32 v84, v81, v84
  v_mul_f32 v85, v81, v85
  v_mul_f32 v86, v81, v86
  v_mul_f32 v87, v81, v87
  v_cvt_pk_bf16_f32 v92, v84, v85
  v_cvt_pk_bf16_f32 v93, v86, v87
  global_store_dwordx2 v80, v[92:93], s[66:67] offset:0 sc1
  v_accvgpr_read_b32 v88, a4
  v_accvgpr_read_b32 v89, a5
  v_accvgpr_read_b32 v90, a6
  v_accvgpr_read_b32 v91, a7
  v_mul_f32 v88, v81, v88
  v_mul_f32 v89, v81, v89
  v_mul_f32 v90, v81, v90
  v_mul_f32 v91, v81, v91
  v_cvt_pk_bf16_f32 v94, v88, v89
  v_cvt_pk_bf16_f32 v95, v90, v91
  global_store_dwordx2 v80, v[94:95], s[66:67] offset:1024 sc1
  v_accvgpr_read_b32 v84, a8
  v_accvgpr_read_b32 v85, a9
  v_accvgpr_read_b32 v86, a10
  v_accvgpr_read_b32 v87, a11
  v_mul_f32 v84, v81, v84
  v_mul_f32 v85, v81, v85
  v_mul_f32 v86, v81, v86
  v_mul_f32 v87, v81, v87
  v_cvt_pk_bf16_f32 v96, v84, v85
  v_cvt_pk_bf16_f32 v97, v86, v87
  global_store_dwordx2 v80, v[96:97], s[66:67] offset:2048 sc1
  v_accvgpr_read_b32 v88, a12
  v_accvgpr_read_b32 v89, a13
  v_accvgpr_read_b32 v90, a14
  v_accvgpr_read_b32 v91, a15
  v_mul_f32 v88, v81, v88
  v_mul_f32 v89, v81, v89
  v_mul_f32 v90, v81, v90
  v_mul_f32 v91, v81, v91
  v_cvt_pk_bf16_f32 v98, v88, v89
  v_cvt_pk_bf16_f32 v99, v90, v91
  global_store_dwordx2 v80, v[98:99], s[66:67] offset:3072 sc1
  v_accvgpr_read_b32 v84, a16
  v_accvgpr_read_b32 v85, a17
  v_accvgpr_read_b32 v86, a18
  v_accvgpr_read_b32 v87, a19
  v_mul_f32 v84, v81, v84
  v_mul_f32 v85, v81, v85
  v_mul_f32 v86, v81, v86
  v_mul_f32 v87, v81, v87
  v_cvt_pk_bf16_f32 v100, v84, v85
  v_cvt_pk_bf16_f32 v101, v86, v87
  global_store_dwordx2 v80, v[100:101], s[66:67] offset:256 sc1
  v_accvgpr_read_b32 v88, a20
  v_accvgpr_read_b32 v89, a21
  v_accvgpr_read_b32 v90, a22
  v_accvgpr_read_b32 v91, a23
  v_mul_f32 v88, v81, v88
  v_mul_f32 v89, v81, v89
  v_mul_f32 v90, v81, v90
  v_mul_f32 v91, v81, v91
  v_cvt_pk_bf16_f32 v102, v88, v89
  v_cvt_pk_bf16_f32 v103, v90, v91
  global_store_dwordx2 v80, v[102:103], s[66:67] offset:1280 sc1
  v_accvgpr_read_b32 v84, a24
  v_accvgpr_read_b32 v85, a25
  v_accvgpr_read_b32 v86, a26
  v_accvgpr_read_b32 v87, a27
  v_mul_f32 v84, v81, v84
  v_mul_f32 v85, v81, v85
  v_mul_f32 v86, v81, v86
  v_mul_f32 v87, v81, v87
  v_cvt_pk_bf16_f32 v104, v84, v85
  v_cvt_pk_bf16_f32 v105, v86, v87
  global_store_dwordx2 v80, v[104:105], s[66:67] offset:2304 sc1
  v_accvgpr_read_b32 v88, a28
  v_accvgpr_read_b32 v89, a29
  v_accvgpr_read_b32 v90, a30
  v_accvgpr_read_b32 v91, a31
  v_mul_f32 v88, v81, v88
  v_mul_f32 v89, v81, v89
  v_mul_f32 v90, v81, v90
  v_mul_f32 v91, v81, v91
  v_cvt_pk_bf16_f32 v106, v88, v89
  v_cvt_pk_bf16_f32 v107, v90, v91
  global_store_dwordx2 v80, v[106:107], s[66:67] offset:3328 sc1
  s_add_u32 s66, s66, 65536
  s_addc_u32 s67, s67, 0
  v_accvgpr_read_b32 v84, a32
  v_accvgpr_read_b32 v85, a33
  v_accvgpr_read_b32 v86, a34
  v_accvgpr_read_b32 v87, a35
  v_mul_f32 v84, v81, v84
  v_mul_f32 v85, v81, v85
  v_mul_f32 v86, v81, v86
  v_mul_f32 v87, v81, v87
  v_cvt_pk_bf16_f32 v92, v84, v85
  v_cvt_pk_bf16_f32 v93, v86, v87
  global_store_dwordx2 v80, v[92:93], s[66:67] offset:0 sc1
  v_accvgpr_read_b32 v88, a36
  v_accvgpr_read_b32 v89, a37
  v_accvgpr_read_b32 v90, a38
  v_accvgpr_read_b32 v91, a39
  v_mul_f32 v88, v81, v88
  v_mul_f32 v89, v81, v89
  v_mul_f32 v90, v81, v90
  v_mul_f32 v91, v81, v91
  v_cvt_pk_bf16_f32 v94, v88, v89
  v_cvt_pk_bf16_f32 v95, v90, v91
  global_store_dwordx2 v80, v[94:95], s[66:67] offset:1024 sc1
  v_accvgpr_read_b32 v84, a40
  v_accvgpr_read_b32 v85, a41
  v_accvgpr_read_b32 v86, a42
  v_accvgpr_read_b32 v87, a43
  v_mul_f32 v84, v81, v84
  v_mul_f32 v85, v81, v85
  v_mul_f32 v86, v81, v86
  v_mul_f32 v87, v81, v87
  v_cvt_pk_bf16_f32 v96, v84, v85
  v_cvt_pk_bf16_f32 v97, v86, v87
  global_store_dwordx2 v80, v[96:97], s[66:67] offset:2048 sc1
  v_accvgpr_read_b32 v88, a44
  v_accvgpr_read_b32 v89, a45
  v_accvgpr_read_b32 v90, a46
  v_accvgpr_read_b32 v91, a47
  v_mul_f32 v88, v81, v88
  v_mul_f32 v89, v81, v89
  v_mul_f32 v90, v81, v90
  v_mul_f32 v91, v81, v91
  v_cvt_pk_bf16_f32 v98, v88, v89
  v_cvt_pk_bf16_f32 v99, v90, v91
  global_store_dwordx2 v80, v[98:99], s[66:67] offset:3072 sc1
  v_accvgpr_read_b32 v84, a48
  v_accvgpr_read_b32 v85, a49
  v_accvgpr_read_b32 v86, a50
  v_accvgpr_read_b32 v87, a51
  v_mul_f32 v84, v81, v84
  v_mul_f32 v85, v81, v85
  v_mul_f32 v86, v81, v86
  v_mul_f32 v87, v81, v87
  v_cvt_pk_bf16_f32 v100, v84, v85
  v_cvt_pk_bf16_f32 v101, v86, v87
  global_store_dwordx2 v80, v[100:101], s[66:67] offset:256 sc1
  v_accvgpr_read_b32 v88, a52
  v_accvgpr_read_b32 v89, a53
  v_accvgpr_read_b32 v90, a54
  v_accvgpr_read_b32 v91, a55
  v_mul_f32 v88, v81, v88
  v_mul_f32 v89, v81, v89
  v_mul_f32 v90, v81, v90
  v_mul_f32 v91, v81, v91
  v_cvt_pk_bf16_f32 v102, v88, v89
  v_cvt_pk_bf16_f32 v103, v90, v91
  global_store_dwordx2 v80, v[102:103], s[66:67] offset:1280 sc1
  v_accvgpr_read_b32 v84, a56
  v_accvgpr_read_b32 v85, a57
  v_accvgpr_read_b32 v86, a58
  v_accvgpr_read_b32 v87, a59
  v_mul_f32 v84, v81, v84
  v_mul_f32 v85, v81, v85
  v_mul_f32 v86, v81, v86
  v_mul_f32 v87, v81, v87
  v_cvt_pk_bf16_f32 v104, v84, v85
  v_cvt_pk_bf16_f32 v105, v86, v87
  global_store_dwordx2 v80, v[104:105], s[66:67] offset:2304 sc1
  v_accvgpr_read_b32 v88, a60
  v_accvgpr_read_b32 v89, a61
  v_accvgpr_read_b32 v90, a62
  v_accvgpr_read_b32 v91, a63
  v_mul_f32 v88, v81, v88
  v_mul_f32 v89, v81, v89
  v_mul_f32 v90, v81, v90
  v_mul_f32 v91, v81, v91
  v_cvt_pk_bf16_f32 v106, v88, v89
  v_cvt_pk_bf16_f32 v107, v90, v91
  global_store_dwordx2 v80, v[106:107], s[66:67] offset:3328 sc1
  s_add_u32 s66, s66, 65536
  s_addc_u32 s67, s67, 0
  v_accvgpr_read_b32 v84, a64
  v_accvgpr_read_b32 v85, a65
  v_accvgpr_read_b32 v86, a66
  v_accvgpr_read_b32 v87, a67
  v_mul_f32 v84, v81, v84
  v_mul_f32 v85, v81, v85
  v_mul_f32 v86, v81, v86
  v_mul_f32 v87, v81, v87
  v_cvt_pk_bf16_f32 v92, v84, v85
  v_cvt_pk_bf16_f32 v93, v86, v87
  global_store_dwordx2 v80, v[92:93], s[66:67] offset:0 sc1
  v_accvgpr_read_b32 v88, a68
  v_accvgpr_read_b32 v89, a69
  v_accvgpr_read_b32 v90, a70
  v_accvgpr_read_b32 v91, a71
  v_mul_f32 v88, v81, v88
  v_mul_f32 v89, v81, v89
  v_mul_f32 v90, v81, v90
  v_mul_f32 v91, v81, v91
  v_cvt_pk_bf16_f32 v94, v88, v89
  v_cvt_pk_bf16_f32 v95, v90, v91
  global_store_dwordx2 v80, v[94:95], s[66:67] offset:1024 sc1
  v_accvgpr_read_b32 v84, a72
  v_accvgpr_read_b32 v85, a73
  v_accvgpr_read_b32 v86, a74
  v_accvgpr_read_b32 v87, a75
  v_mul_f32 v84, v81, v84
  v_mul_f32 v85, v81, v85
  v_mul_f32 v86, v81, v86
  v_mul_f32 v87, v81, v87
  v_cvt_pk_bf16_f32 v96, v84, v85
  v_cvt_pk_bf16_f32 v97, v86, v87
  global_store_dwordx2 v80, v[96:97], s[66:67] offset:2048 sc1
  v_accvgpr_read_b32 v88, a76
  v_accvgpr_read_b32 v89, a77
  v_accvgpr_read_b32 v90, a78
  v_accvgpr_read_b32 v91, a79
  v_mul_f32 v88, v81, v88
  v_mul_f32 v89, v81, v89
  v_mul_f32 v90, v81, v90
  v_mul_f32 v91, v81, v91
  v_cvt_pk_bf16_f32 v98, v88, v89
  v_cvt_pk_bf16_f32 v99, v90, v91
  global_store_dwordx2 v80, v[98:99], s[66:67] offset:3072 sc1
  v_accvgpr_read_b32 v84, a80
  v_accvgpr_read_b32 v85, a81
  v_accvgpr_read_b32 v86, a82
  v_accvgpr_read_b32 v87, a83
  v_mul_f32 v84, v81, v84
  v_mul_f32 v85, v81, v85
  v_mul_f32 v86, v81, v86
  v_mul_f32 v87, v81, v87
  v_cvt_pk_bf16_f32 v100, v84, v85
  v_cvt_pk_bf16_f32 v101, v86, v87
  global_store_dwordx2 v80, v[100:101], s[66:67] offset:256 sc1
  v_accvgpr_read_b32 v88, a84
  v_accvgpr_read_b32 v89, a85
  v_accvgpr_read_b32 v90, a86
  v_accvgpr_read_b32 v91, a87
  v_mul_f32 v88, v81, v88
  v_mul_f32 v89, v81, v89
  v_mul_f32 v90, v81, v90
  v_mul_f32 v91, v81, v91
  v_cvt_pk_bf16_f32 v102, v88, v89
  v_cvt_pk_bf16_f32 v103, v90, v91
  global_store_dwordx2 v80, v[102:103], s[66:67] offset:1280 sc1
  v_accvgpr_read_b32 v84, a88
  v_accvgpr_read_b32 v85, a89
  v_accvgpr_read_b32 v86, a90
  v_accvgpr_read_b32 v87, a91
  v_mul_f32 v84, v81, v84
  v_mul_f32 v85, v81, v85
  v_mul_f32 v86, v81, v86
  v_mul_f32 v87, v81, v87
  v_cvt_pk_bf16_f32 v104, v84, v85
  v_cvt_pk_bf16_f32 v105, v86, v87
  global_store_dwordx2 v80, v[104:105], s[66:67] offset:2304 sc1
  v_accvgpr_read_b32 v88, a92
  v_accvgpr_read_b32 v89, a93
  v_accvgpr_read_b32 v90, a94
  v_accvgpr_read_b32 v91, a95
  v_mul_f32 v88, v81, v88
  v_mul_f32 v89, v81, v89
  v_mul_f32 v90, v81, v90
  v_mul_f32 v91, v81, v91
  v_cvt_pk_bf16_f32 v106, v88, v89
  v_cvt_pk_bf16_f32 v107, v90, v91
  global_store_dwordx2 v80, v[106:107], s[66:67] offset:3328 sc1
  s_add_u32 s66, s66, 65536
  s_addc_u32 s67, s67, 0
  v_accvgpr_read_b32 v84, a96
  v_accvgpr_read_b32 v85, a97
  v_accvgpr_read_b32 v86, a98
  v_accvgpr_read_b32 v87, a99
  v_mul_f32 v84, v81, v84
  v_mul_f32 v85, v81, v85
  v_mul_f32 v86, v81, v86
  v_mul_f32 v87, v81, v87
  v_cvt_pk_bf16_f32 v92, v84, v85
  v_cvt_pk_bf16_f32 v93, v86, v87
  global_store_dwordx2 v80, v[92:93], s[66:67] offset:0 sc1
  v_accvgpr_read_b32 v88, a100
  v_accvgpr_read_b32 v89, a101
  v_accvgpr_read_b32 v90, a102
  v_accvgpr_read_b32 v91, a103
  v_mul_f32 v88, v81, v88
  v_mul_f32 v89, v81, v89
  v_mul_f32 v90, v81, v90
  v_mul_f32 v91, v81, v91
  v_cvt_pk_bf16_f32 v94, v88, v89
  v_cvt_pk_bf16_f32 v95, v90, v91
  global_store_dwordx2 v80, v[94:95], s[66:67] offset:1024 sc1
  v_accvgpr_read_b32 v84, a104
  v_accvgpr_read_b32 v85, a105
  v_accvgpr_read_b32 v86, a106
  v_accvgpr_read_b32 v87, a107
  v_mul_f32 v84, v81, v84
  v_mul_f32 v85, v81, v85
  v_mul_f32 v86, v81, v86
  v_mul_f32 v87, v81, v87
  v_cvt_pk_bf16_f32 v96, v84, v85
  v_cvt_pk_bf16_f32 v97, v86, v87
  global_store_dwordx2 v80, v[96:97], s[66:67] offset:2048 sc1
  v_accvgpr_read_b32 v88, a108
  v_accvgpr_read_b32 v89, a109
  v_accvgpr_read_b32 v90, a110
  v_accvgpr_read_b32 v91, a111
  v_mul_f32 v88, v81, v88
  v_mul_f32 v89, v81, v89
  v_mul_f32 v90, v81, v90
  v_mul_f32 v91, v81, v91
  v_cvt_pk_bf16_f32 v98, v88, v89
  v_cvt_pk_bf16_f32 v99, v90, v91
  global_store_dwordx2 v80, v[98:99], s[66:67] offset:3072 sc1
  v_accvgpr_read_b32 v84, a112
  v_accvgpr_read_b32 v85, a113
  v_accvgpr_read_b32 v86, a114
  v_accvgpr_read_b32 v87, a115
  v_mul_f32 v84, v81, v84
  v_mul_f32 v85, v81, v85
  v_mul_f32 v86, v81, v86
  v_mul_f32 v87, v81, v87
  v_cvt_pk_bf16_f32 v100, v84, v85
  v_cvt_pk_bf16_f32 v101, v86, v87
  global_store_dwordx2 v80, v[100:101], s[66:67] offset:256 sc1
  v_accvgpr_read_b32 v88, a116
  v_accvgpr_read_b32 v89, a117
  v_accvgpr_read_b32 v90, a118
  v_accvgpr_read_b32 v91, a119
  v_mul_f32 v88, v81, v88
  v_mul_f32 v89, v81, v89
  v_mul_f32 v90, v81, v90
  v_mul_f32 v91, v81, v91
  v_cvt_pk_bf16_f32 v102, v88, v89
  v_cvt_pk_bf16_f32 v103, v90, v91
  global_store_dwordx2 v80, v[102:103], s[66:67] offset:1280 sc1
  v_accvgpr_read_b32 v84, a120
  v_accvgpr_read_b32 v85, a121
  v_accvgpr_read_b32 v86, a122
  v_accvgpr_read_b32 v87, a123
  v_mul_f32 v84, v81, v84
  v_mul_f32 v85, v81, v85
  v_mul_f32 v86, v81, v86
  v_mul_f32 v87, v81, v87
  v_cvt_pk_bf16_f32 v104, v84, v85
  v_cvt_pk_bf16_f32 v105, v86, v87
  global_store_dwordx2 v80, v[104:105], s[66:67] offset:2304 sc1
  v_accvgpr_read_b32 v88, a124
  v_accvgpr_read_b32 v89, a125
  v_accvgpr_read_b32 v90, a126
  v_accvgpr_read_b32 v91, a127
  v_mul_f32 v88, v81, v88
  v_mul_f32 v89, v81, v89
  v_mul_f32 v90, v81, v90
  v_mul_f32 v91, v81, v91
  v_cvt_pk_bf16_f32 v106, v88, v89
  v_cvt_pk_bf16_f32 v107, v90, v91
  global_store_dwordx2 v80, v[106:107], s[66:67] offset:3328 sc1
L_G1F0:
  s_waitcnt vmcnt(40)
L_G1M:
  s_cmp_eq_u32 s61, 1
  s_cbranch_scc1 L_G1V
  s_barrier
  ds_read_b64_tr_b16 v[64:65], v14 offset:0
  ds_read_b64_tr_b16 v[66:67], v14 offset:2048
  ds_read_b64_tr_b16 v[68:69], v12 offset:0
  ds_read_b64_tr_b16 v[70:71], v12 offset:2048
  ds_read_b64_tr_b16 v[72:73], v15 offset:0
  ds_read_b64_tr_b16 v[74:75], v15 offset:2048
  ds_read_b64_tr_b16 v[76:77], v13 offset:0
  ds_read_b64_tr_b16 v[78:79], v13 offset:2048
  ds_read_b128 v[32:35], v10 offset:0
  ds_read_b128 v[36:39], v10 offset:2048
  ds_read_b128 v[40:43], v10 offset:4096
  ds_read_b128 v[44:47], v10 offset:6144
  ds_read_b128 v[48:51], v10 offset:8192
  ds_read_b128 v[52:55], v10 offset:10240
  ds_read_b128 v[56:59], v10 offset:12288
  ds_read_b128 v[60:63], v10 offset:14336
  s_waitcnt lgkmcnt(0)
  v_mfma_f32_16x16x32_bf16 a[0:3], v[64:67], v[32:35], 0
  ds_read_b64_tr_b16 v[112:113], v14 offset:16384
  v_mfma_f32_16x16x32_bf16 a[4:7], v[68:71], v[32:35], 0
  v_mfma_f32_16x16x32_bf16 a[8:11], v[72:75], v[32:35], 0
  ds_read_b64_tr_b16 v[114:115], v14 offset:18432
  v_mfma_f32_16x16x32_bf16 a[12:15], v[76:79], v[32:35], 0
  v_mfma_f32_16x16x32_bf16 a[16:19], v[64:67], v[36:39], 0
  ds_read_b64_tr_b16 v[116:117], v12 offset:16384
  v_mfma_f32_16x16x32_bf16 a[20:23], v[68:71], v[36:39], 0
  v_mfma_f32_16x16x32_bf16 a[24:27], v[72:75], v[36:39], 0
  ds_read_b64_tr_b16 v[118:119], v12 offset:18432
  v_mfma_f32_16x16x32_bf16 a[28:31], v[76:79], v[36:39], 0
  v_mfma_f32_16x16x32_bf16 a[32:35], v[64:67], v[40:43], 0
  ds_read_b64_tr_b16 v[120:121], v15 offset:16384
  v_mfma_f32_16x16x32_bf16 a[36:39], v[68:71], v[40:43], 0
  v_mfma_f32_16x16x32_bf16 a[40:43], v[72:75], v[40:43], 0
  ds_read_b64_tr_b16 v[122:123], v15 offset:18432
  v_mfma_f32_16x16x32_bf16 a[44:47], v[76:79], v[40:43], 0
  v_mfma_f32_16x16x32_bf16 a[48:51], v[64:67], v[44:47], 0
  ds_read_b64_tr_b16 v[124:125], v13 offset:16384
  v_mfma_f32_16x16x32_bf16 a[52:55], v[68:71], v[44:47], 0
  v_mfma_f32_16x16x32_bf16 a[56:59], v[72:75], v[44:47], 0
  ds_read_b64_tr_b16 v[126:127], v13 offset:18432
  v_mfma_f32_16x16x32_bf16 a[60:63], v[76:79], v[44:47], 0
  v_mfma_f32_16x16x32_bf16 a[64:67], v[64:67], v[48:51], 0
  ds_read_b128 v[80:83], v11 offset:0
  v_mfma_f32_16x16x32_bf16 a[68:71], v[68:71], v[48:51], 0
  v_mfma_f32_16x16x32_bf16 a[72:75], v[72:75], v[48:51], 0
  ds_read_b128 v[84:87], v11 offset:2048
  v_mfma_f32_16x16x32_bf16 a[76:79], v[76:79], v[48:51], 0
  v_mfma_f32_16x16x32_bf16 a[80:83], v[64:67], v[52:55], 0
  ds_read_b128 v[88:91], v11 offset:4096
  v_mfma_f32_16x16x32_bf16 a[84:87], v[68:71], v[52:55], 0
  v_mfma_f32_16x16x32_bf16 a[88:91], v[72:75], v[52:55], 0
  ds_read_b128 v[92:95], v11 offset:6144
  v_mfma_f32_16x16x32_bf16 a[92:95], v[76:79], v[52:55], 0
  v_mfma_f32_16x16x32_bf16 a[96:99], v[64:67], v[56:59], 0
  ds_read_b128 v[96:99], v11 offset:8192
  v_mfma_f32_16x16x32_bf16 a[100:103], v[68:71], v[56:59], 0
  v_mfma_f32_16x16x32_bf16 a[104:107], v[72:75], v[56:59], 0
  ds_read_b128 v[100:103], v11 offset:10240
  v_mfma_f32_16x16x32_bf16 a[108:111], v[76:79], v[56:59], 0
  v_mfma_f32_16x16x32_bf16 a[112:115], v[64:67], v[60:63], 0
  ds_read_b128 v[104:107], v11 offset:12288
  v_mfma_f32_16x16x32_bf16 a[116:119], v[68:71], v[60:63], 0
  v_mfma_f32_16x16x32_bf16 a[120:123], v[72:75], v[60:63], 0
  ds_read_b128 v[108:111], v11 offset:14336
  v_mfma_f32_16x16x32_bf16 a[124:127], v[76:79], v[60:63], 0
  s_waitcnt lgkmcnt(0)
  s_waitcnt vmcnt(0)
  s_barrier
  v_xor_b32 v10, 0x10000, v10
  v_xor_b32 v11, 0x10000, v11
  v_xor_b32 v12, 0x10000, v12
  v_xor_b32 v13, 0x10000, v13
  v_xor_b32 v14, 0x10000, v14
  v_xor_b32 v15, 0x10000, v15
  s_cmp_eq_u32 s52, 0
  s_cbranch_scc1 H2
  s_cmp_lg_u32 s34, 0
  s_cbranch_scc1 H2
  s_add_u32 s39, s68, 0
  v_mov_b32 v16, s39
  v_mov_b32 v17, s69
  s_mov_b64 exec, 1
  global_atomic_add v16, v17, s[28:29] sc1
  s_mov_b64 exec, -1
H2:
  v_mfma_f32_16x16x32_bf16 a[0:3], v[112:115], v[80:83], a[0:3]
  ds_read_b64_tr_b16 v[64:65], v14 offset:0
  ds_read_b64_tr_b16 v[66:67], v14 offset:2048
  v_mfma_f32_16x16x32_bf16 a[4:7], v[116:119], v[80:83], a[4:7]
  ds_read_b64_tr_b16 v[68:69], v12 offset:0
  v_mfma_f32_16x16x32_bf16 a[8:11], v[120:123], v[80:83], a[8:11]
  ds_read_b64_tr_b16 v[70:71], v12 offset:2048
  v_mfma_f32_16x16x32_bf16 a[12:15], v[124:127], v[80:83], a[12:15]
  ds_read_b64_tr_b16 v[72:73], v15 offset:0
  v_mfma_f32_16x16x32_bf16 a[16:19], v[112:115], v[84:87], a[16:19]
  ds_read_b64_tr_b16 v[74:75], v15 offset:2048
  v_mfma_f32_16x16x32_bf16 a[20:23], v[116:119], v[84:87], a[20:23]
  ds_read_b64_tr_b16 v[76:77], v13 offset:0
  v_mfma_f32_16x16x32_bf16 a[24:27], v[120:123], v[84:87], a[24:27]
  ds_read_b64_tr_b16 v[78:79], v13 offset:2048
  v_mfma_f32_16x16x32_bf16 a[28:31], v[124:127], v[84:87], a[28:31]
  ds_read_b128 v[32:35], v10 offset:0
  v_mfma_f32_16x16x32_bf16 a[32:35], v[112:115], v[88:91], a[32:35]
  ds_read_b128 v[36:39], v10 offset:2048
  v_mfma_f32_16x16x32_bf16 a[36:39], v[116:119], v[88:91], a[36:39]
  ds_read_b128 v[40:43], v10 offset:4096
  v_mfma_f32_16x16x32_bf16 a[40:43], v[120:123], v[88:91], a[40:43]
  ds_read_b128 v[44:47], v10 offset:6144
  v_mfma_f32_16x16x32_bf16 a[44:47], v[124:127], v[88:91], a[44:47]
  ds_read_b128 v[48:51], v10 offset:8192
  v_mfma_f32_16x16x32_bf16 a[48:51], v[112:115], v[92:95], a[48:51]
  ds_read_b128 v[52:55], v10 offset:10240
  v_mfma_f32_16x16x32_bf16 a[52:55], v[116:119], v[92:95], a[52:55]
  ds_read_b128 v[56:59], v10 offset:12288
  v_mfma_f32_16x16x32_bf16 a[56:59], v[120:123], v[92:95], a[56:59]
  ds_read_b128 v[60:63], v10 offset:14336
  v_mfma_f32_16x16x32_bf16 a[60:63], v[124:127], v[92:95], a[60:63]
  s_mov_b32 m0, s45
  v_mfma_f32_16x16x32_bf16 a[64:67], v[112:115], v[96:99], a[64:67]
  s_nop 0
  global_load_lds_dwordx4 v2, s[56:57] offset:0
  v_mfma_f32_16x16x32_bf16 a[68:71], v[116:119], v[96:99], a[68:71]
  global_load_lds_dwordx4 v3, s[56:57] offset:1024
  v_mfma_f32_16x16x32_bf16 a[72:75], v[120:123], v[96:99], a[72:75]
  global_load_lds_dwordx4 v4, s[56:57] offset:2048
  v_mfma_f32_16x16x32_bf16 a[76:79], v[124:127], v[96:99], a[76:79]
  global_load_lds_dwordx4 v5, s[56:57] offset:3072
  v_mfma_f32_16x16x32_bf16 a[80:83], v[112:115], v[100:103], a[80:83]
  s_mov_b32 m0, s46
  v_mfma_f32_16x16x32_bf16 a[84:87], v[116:119], v[100:103], a[84:87]
  s_nop 0
  v_mfma_f32_16x16x32_bf16 a[88:91], v[120:123], v[100:103], a[88:91]
  global_load_lds_dwordx4 v6, s[58:59] offset:0
  v_mfma_f32_16x16x32_bf16 a[92:95], v[124:127], v[100:103], a[92:95]
  global_load_lds_dwordx4 v7, s[58:59] offset:1024
  v_mfma_f32_16x16x32_bf16 a[96:99], v[112:115], v[104:107], a[96:99]
  global_load_lds_dwordx4 v8, s[58:59] offset:2048
  v_mfma_f32_16x16x32_bf16 a[100:103], v[116:119], v[104:107], a[100:103]
  global_load_lds_dwordx4 v9, s[58:59] offset:3072
  v_mfma_f32_16x16x32_bf16 a[104:107], v[120:123], v[104:107], a[104:107]
  s_add_u32 s56, s56, 128
  v_mfma_f32_16x16x32_bf16 a[108:111], v[124:127], v[104:107], a[108:111]
  s_addc_u32 s57, s57, 0
  v_mfma_f32_16x16x32_bf16 a[112:115], v[112:115], v[108:111], a[112:115]
  s_add_u32 s58, s58, s48
  v_mfma_f32_16x16x32_bf16 a[116:119], v[116:119], v[108:111], a[116:119]
  s_addc_u32 s59, s59, 0
  v_mfma_f32_16x16x32_bf16 a[120:123], v[120:123], v[108:111], a[120:123]
  s_xor_b32 s45, s45, 0x10000
  v_mfma_f32_16x16x32_bf16 a[124:127], v[124:127], v[108:111], a[124:127]
  s_xor_b32 s46, s46, 0x10000
  s_mov_b32 s47, 13
G3:
  s_waitcnt lgkmcnt(0)
  v_mfma_f32_16x16x32_bf16 a[0:3], v[64:67], v[32:35], a[0:3]
  ds_read_b64_tr_b16 v[112:113], v14 offset:16384
  v_mfma_f32_16x16x32_bf16 a[4:7], v[68:71], v[32:35], a[4:7]
  v_mfma_f32_16x16x32_bf16 a[8:11], v[72:75], v[32:35], a[8:11]
  ds_read_b64_tr_b16 v[114:115], v14 offset:18432
  v_mfma_f32_16x16x32_bf16 a[12:15], v[76:79], v[32:35], a[12:15]
  v_mfma_f32_16x16x32_bf16 a[16:19], v[64:67], v[36:39], a[16:19]
  ds_read_b64_tr_b16 v[116:117], v12 offset:16384
  v_mfma_f32_16x16x32_bf16 a[20:23], v[68:71], v[36:39], a[20:23]
  v_mfma_f32_16x16x32_bf16 a[24:27], v[72:75], v[36:39], a[24:27]
  ds_read_b64_tr_b16 v[118:119], v12 offset:18432
  v_mfma_f32_16x16x32_bf16 a[28:31], v[76:79], v[36:39], a[28:31]
  v_mfma_f32_16x16x32_bf16 a[32:35], v[64:67], v[40:43], a[32:35]
  ds_read_b64_tr_b16 v[120:121], v15 offset:16384
  v_mfma_f32_16x16x32_bf16 a[36:39], v[68:71], v[40:43], a[36:39]
  v_mfma_f32_16x16x32_bf16 a[40:43], v[72:75], v[40:43], a[40:43]
  ds_read_b64_tr_b16 v[122:123], v15 offset:18432
  v_mfma_f32_16x16x32_bf16 a[44:47], v[76:79], v[40:43], a[44:47]
  v_mfma_f32_16x16x32_bf16 a[48:51], v[64:67], v[44:47], a[48:51]
  ds_read_b64_tr_b16 v[124:125], v13 offset:16384
  v_mfma_f32_16x16x32_bf16 a[52:55], v[68:71], v[44:47], a[52:55]
  v_mfma_f32_16x16x32_bf16 a[56:59], v[72:75], v[44:47], a[56:59]
  ds_read_b64_tr_b16 v[126:127], v13 offset:18432
  v_mfma_f32_16x16x32_bf16 a[60:63], v[76:79], v[44:47], a[60:63]
  v_mfma_f32_16x16x32_bf16 a[64:67], v[64:67], v[48:51], a[64:67]
  ds_read_b128 v[80:83], v11 offset:0
  v_mfma_f32_16x16x32_bf16 a[68:71], v[68:71], v[48:51], a[68:71]
  v_mfma_f32_16x16x32_bf16 a[72:75], v[72:75], v[48:51], a[72:75]
  ds_read_b128 v[84:87], v11 offset:2048
  v_mfma_f32_16x16x32_bf16 a[76:79], v[76:79], v[48:51], a[76:79]
  v_mfma_f32_16x16x32_bf16 a[80:83], v[64:67], v[52:55], a[80:83]
  ds_read_b128 v[88:91], v11 offset:4096
  v_mfma_f32_16x16x32_bf16 a[84:87], v[68:71], v[52:55], a[84:87]
  v_mfma_f32_16x16x32_bf16 a[88:91], v[72:75], v[52:55], a[88:91]
  ds_read_b128 v[92:95], v11 offset:6144
  v_mfma_f32_16x16x32_bf16 a[92:95], v[76:79], v[52:55], a[92:95]
  v_mfma_f32_16x16x32_bf16 a[96:99], v[64:67], v[56:59], a[96:99]
  ds_read_b128 v[96:99], v11 offset:8192
  v_mfma_f32_16x16x32_bf16 a[100:103], v[68:71], v[56:59], a[100:103]
  v_mfma_f32_16x16x32_bf16 a[104:107], v[72:75], v[56:59], a[104:107]
  ds_read_b128 v[100:103], v11 offset:10240
  v_mfma_f32_16x16x32_bf16 a[108:111], v[76:79], v[56:59], a[108:111]
  v_mfma_f32_16x16x32_bf16 a[112:115], v[64:67], v[60:63], a[112:115]
  ds_read_b128 v[104:107], v11 offset:12288
  v_mfma_f32_16x16x32_bf16 a[116:119], v[68:71], v[60:63], a[116:119]
  v_mfma_f32_16x16x32_bf16 a[120:123], v[72:75], v[60:63], a[120:123]
  ds_read_b128 v[108:111], v11 offset:14336
  v_mfma_f32_16x16x32_bf16 a[124:127], v[76:79], v[60:63], a[124:127]
  s_waitcnt lgkmcnt(0)
  s_waitcnt vmcnt(0)
  s_barrier
  v_xor_b32 v10, 0x10000, v10
  v_xor_b32 v11, 0x10000, v11
  v_xor_b32 v12, 0x10000, v12
  v_xor_b32 v13, 0x10000, v13
  v_xor_b32 v14, 0x10000, v14
  v_xor_b32 v15, 0x10000, v15
  v_mfma_f32_16x16x32_bf16 a[0:3], v[112:115], v[80:83], a[0:3]
  ds_read_b64_tr_b16 v[64:65], v14 offset:0
  ds_read_b64_tr_b16 v[66:67], v14 offset:2048
  v_mfma_f32_16x16x32_bf16 a[4:7], v[116:119], v[80:83], a[4:7]
  ds_read_b64_tr_b16 v[68:69], v12 offset:0
  v_mfma_f32_16x16x32_bf16 a[8:11], v[120:123], v[80:83], a[8:11]
  ds_read_b64_tr_b16 v[70:71], v12 offset:2048
  v_mfma_f32_16x16x32_bf16 a[12:15], v[124:127], v[80:83], a[12:15]
  ds_read_b64_tr_b16 v[72:73], v15 offset:0
  v_mfma_f32_16x16x32_bf16 a[16:19], v[112:115], v[84:87], a[16:19]
  ds_read_b64_tr_b16 v[74:75], v15 offset:2048
  v_mfma_f32_16x16x32_bf16 a[20:23], v[116:119], v[84:87], a[20:23]
  ds_read_b64_tr_b16 v[76:77], v13 offset:0
  v_mfma_f32_16x16x32_bf16 a[24:27], v[120:123], v[84:87], a[24:27]
  ds_read_b64_tr_b16 v[78:79], v13 offset:2048
  v_mfma_f32_16x16x32_bf16 a[28:31], v[124:127], v[84:87], a[28:31]
  ds_read_b128 v[32:35], v10 offset:0
  v_mfma_f32_16x16x32_bf16 a[32:35], v[112:115], v[88:91], a[32:35]
  ds_read_b128 v[36:39], v10 offset:2048
  v_mfma_f32_16x16x32_bf16 a[36:39], v[116:119], v[88:91], a[36:39]
  ds_read_b128 v[40:43], v10 offset:4096
  v_mfma_f32_16x16x32_bf16 a[40:43], v[120:123], v[88:91], a[40:43]
  ds_read_b128 v[44:47], v10 offset:6144
  v_mfma_f32_16x16x32_bf16 a[44:47], v[124:127], v[88:91], a[44:47]
  ds_read_b128 v[48:51], v10 offset:8192
  v_mfma_f32_16x16x32_bf16 a[48:51], v[112:115], v[92:95], a[48:51]
  ds_read_b128 v[52:55], v10 offset:10240
  v_mfma_f32_16x16x32_bf16 a[52:55], v[116:119], v[92:95], a[52:55]
  ds_read_b128 v[56:59], v10 offset:12288
  v_mfma_f32_16x16x32_bf16 a[56:59], v[120:123], v[92:95], a[56:59]
  ds_read_b128 v[60:63], v10 offset:14336
  v_mfma_f32_16x16x32_bf16 a[60:63], v[124:127], v[92:95], a[60:63]
  s_mov_b32 m0, s45
  v_mfma_f32_16x16x32_bf16 a[64:67], v[112:115], v[96:99], a[64:67]
  s_nop 0
  global_load_lds_dwordx4 v2, s[56:57] offset:0
  v_mfma_f32_16x16x32_bf16 a[68:71], v[116:119], v[96:99], a[68:71]
  global_load_lds_dwordx4 v3, s[56:57] offset:1024
  v_mfma_f32_16x16x32_bf16 a[72:75], v[120:123], v[96:99], a[72:75]
  global_load_lds_dwordx4 v4, s[56:57] offset:2048
  v_mfma_f32_16x16x32_bf16 a[76:79], v[124:127], v[96:99], a[76:79]
  global_load_lds_dwordx4 v5, s[56:57] offset:3072
  v_mfma_f32_16x16x32_bf16 a[80:83], v[112:115], v[100:103], a[80:83]
  s_mov_b32 m0, s46
  v_mfma_f32_16x16x32_bf16 a[84:87], v[116:119], v[100:103], a[84:87]
  s_nop 0
  v_mfma_f32_16x16x32_bf16 a[88:91], v[120:123], v[100:103], a[88:91]
  global_load_lds_dwordx4 v6, s[58:59] offset:0
  v_mfma_f32_16x16x32_bf16 a[92:95], v[124:127], v[100:103], a[92:95]
  global_load_lds_dwordx4 v7, s[58:59] offset:1024
  v_mfma_f32_16x16x32_bf16 a[96:99], v[112:115], v[104:107], a[96:99]
  global_load_lds_dwordx4 v8, s[58:59] offset:2048
  v_mfma_f32_16x16x32_bf16 a[100:103], v[116:119], v[104:107], a[100:103]
  global_load_lds_dwordx4 v9, s[58:59] offset:3072
  v_mfma_f32_16x16x32_bf16 a[104:107], v[120:123], v[104:107], a[104:107]
  s_add_u32 s56, s56, 128
  v_mfma_f32_16x16x32_bf16 a[108:111], v[124:127], v[104:107], a[108:111]
  s_addc_u32 s57, s57, 0
  v_mfma_f32_16x16x32_bf16 a[112:115], v[112:115], v[108:111], a[112:115]
  s_add_u32 s58, s58, s48
  v_mfma_f32_16x16x32_bf16 a[116:119], v[116:119], v[108:111], a[116:119]
  s_addc_u32 s59, s59, 0
  v_mfma_f32_16x16x32_bf16 a[120:123], v[120:123], v[108:111], a[120:123]
  s_xor_b32 s45, s45, 0x10000
  v_mfma_f32_16x16x32_bf16 a[124:127], v[124:127], v[108:111], a[124:127]
  s_xor_b32 s46, s46, 0x10000
  s_sub_u32 s47, s47, 1
  s_cmp_lg_u32 s47, 0
  s_cbranch_scc1 G3
  s_waitcnt lgkmcnt(0)
  v_mfma_f32_16x16x32_bf16 a[0:3], v[64:67], v[32:35], a[0:3]
  ds_read_b64_tr_b16 v[112:113], v14 offset:16384
  v_mfma_f32_16x16x32_bf16 a[4:7], v[68:71], v[32:35], a[4:7]
  v_mfma_f32_16x16x32_bf16 a[8:11], v[72:75], v[32:35], a[8:11]
  ds_read_b64_tr_b16 v[114:115], v14 offset:18432
  v_mfma_f32_16x16x32_bf16 a[12:15], v[76:79], v[32:35], a[12:15]
  v_mfma_f32_16x16x32_bf16 a[16:19], v[64:67], v[36:39], a[16:19]
  ds_read_b64_tr_b16 v[116:117], v12 offset:16384
  v_mfma_f32_16x16x32_bf16 a[20:23], v[68:71], v[36:39], a[20:23]
  v_mfma_f32_16x16x32_bf16 a[24:27], v[72:75], v[36:39], a[24:27]
  ds_read_b64_tr_b16 v[118:119], v12 offset:18432
  v_mfma_f32_16x16x32_bf16 a[28:31], v[76:79], v[36:39], a[28:31]
  v_mfma_f32_16x16x32_bf16 a[32:35], v[64:67], v[40:43], a[32:35]
  ds_read_b64_tr_b16 v[120:121], v15 offset:16384
  v_mfma_f32_16x16x32_bf16 a[36:39], v[68:71], v[40:43], a[36:39]
  v_mfma_f32_16x16x32_bf16 a[40:43], v[72:75], v[40:43], a[40:43]
  ds_read_b64_tr_b16 v[122:123], v15 offset:18432
  v_mfma_f32_16x16x32_bf16 a[44:47], v[76:79], v[40:43], a[44:47]
  v_mfma_f32_16x16x32_bf16 a[48:51], v[64:67], v[44:47], a[48:51]
  ds_read_b64_tr_b16 v[124:125], v13 offset:16384
  v_mfma_f32_16x16x32_bf16 a[52:55], v[68:71], v[44:47], a[52:55]
  v_mfma_f32_16x16x32_bf16 a[56:59], v[72:75], v[44:47], a[56:59]
  ds_read_b64_tr_b16 v[126:127], v13 offset:18432
  v_mfma_f32_16x16x32_bf16 a[60:63], v[76:79], v[44:47], a[60:63]
  v_mfma_f32_16x16x32_bf16 a[64:67], v[64:67], v[48:51], a[64:67]
  ds_read_b128 v[80:83], v11 offset:0
  v_mfma_f32_16x16x32_bf16 a[68:71], v[68:71], v[48:51], a[68:71]
  v_mfma_f32_16x16x32_bf16 a[72:75], v[72:75], v[48:51], a[72:75]
  ds_read_b128 v[84:87], v11 offset:2048
  v_mfma_f32_16x16x32_bf16 a[76:79], v[76:79], v[48:51], a[76:79]
  v_mfma_f32_16x16x32_bf16 a[80:83], v[64:67], v[52:55], a[80:83]
  ds_read_b128 v[88:91], v11 offset:4096
  v_mfma_f32_16x16x32_bf16 a[84:87], v[68:71], v[52:55], a[84:87]
  v_mfma_f32_16x16x32_bf16 a[88:91], v[72:75], v[52:55], a[88:91]
  ds_read_b128 v[92:95], v11 offset:6144
  v_mfma_f32_16x16x32_bf16 a[92:95], v[76:79], v[52:55], a[92:95]
  v_mfma_f32_16x16x32_bf16 a[96:99], v[64:67], v[56:59], a[96:99]
  ds_read_b128 v[96:99], v11 offset:8192
  v_mfma_f32_16x16x32_bf16 a[100:103], v[68:71], v[56:59], a[100:103]
  v_mfma_f32_16x16x32_bf16 a[104:107], v[72:75], v[56:59], a[104:107]
  ds_read_b128 v[100:103], v11 offset:10240
  v_mfma_f32_16x16x32_bf16 a[108:111], v[76:79], v[56:59], a[108:111]
  v_mfma_f32_16x16x32_bf16 a[112:115], v[64:67], v[60:63], a[112:115]
  ds_read_b128 v[104:107], v11 offset:12288
  v_mfma_f32_16x16x32_bf16 a[116:119], v[68:71], v[60:63], a[116:119]
  v_mfma_f32_16x16x32_bf16 a[120:123], v[72:75], v[60:63], a[120:123]
  ds_read_b128 v[108:111], v11 offset:14336
  v_mfma_f32_16x16x32_bf16 a[124:127], v[76:79], v[60:63], a[124:127]
  s_waitcnt lgkmcnt(0)
  s_waitcnt vmcnt(0)
  s_barrier
  v_xor_b32 v10, 0x10000, v10
  v_xor_b32 v11, 0x10000, v11
  v_xor_b32 v12, 0x10000, v12
  v_xor_b32 v13, 0x10000, v13
  v_xor_b32 v14, 0x10000, v14
  v_xor_b32 v15, 0x10000, v15
  v_mfma_f32_16x16x32_bf16 a[0:3], v[112:115], v[80:83], a[0:3]
  ds_read_b64_tr_b16 v[64:65], v14 offset:0
  v_mfma_f32_16x16x32_bf16 a[4:7], v[116:119], v[80:83], a[4:7]
  v_mfma_f32_16x16x32_bf16 a[8:11], v[120:123], v[80:83], a[8:11]
  ds_read_b64_tr_b16 v[66:67], v14 offset:2048
  v_mfma_f32_16x16x32_bf16 a[12:15], v[124:127], v[80:83], a[12:15]
  v_mfma_f32_16x16x32_bf16 a[16:19], v[112:115], v[84:87], a[16:19]
  ds_read_b64_tr_b16 v[68:69], v12 offset:0
  v_mfma_f32_16x16x32_bf16 a[20:23], v[116:119], v[84:87], a[20:23]
  v_mfma_f32_16x16x32_bf16 a[24:27], v[120:123], v[84:87], a[24:27]
  ds_read_b64_tr_b16 v[70:71], v12 offset:2048
  v_mfma_f32_16x16x32_bf16 a[28:31], v[124:127], v[84:87], a[28:31]
  v_mfma_f32_16x16x32_bf16 a[32:35], v[112:115], v[88:91], a[32:35]
  ds_read_b64_tr_b16 v[72:73], v15 offset:0
  v_mfma_f32_16x16x32_bf16 a[36:39], v[116:119], v[88:91], a[36:39]
  v_mfma_f32_16x16x32_bf16 a[40:43], v[120:123], v[88:91], a[40:43]
  ds_read_b64_tr_b16 v[74:75], v15 offset:2048
  v_mfma_f32_16x16x32_bf16 a[44:47], v[124:127], v[88:91], a[44:47]
  v_mfma_f32_16x16x32_bf16 a[48:51], v[112:115], v[92:95], a[48:51]
  ds_read_b64_tr_b16 v[76:77], v13 offset:0
  v_mfma_f32_16x16x32_bf16 a[52:55], v[116:119], v[92:95], a[52:55]
  v_mfma_f32_16x16x32_bf16 a[56:59], v[120:123], v[92:95], a[56:59]
  ds_read_b64_tr_b16 v[78:79], v13 offset:2048
  v_mfma_f32_16x16x32_bf16 a[60:63], v[124:127], v[92:95], a[60:63]
  v_mfma_f32_16x16x32_bf16 a[64:67], v[112:115], v[96:99], a[64:67]
  ds_read_b128 v[32:35], v10 offset:0
  v_mfma_f32_16x16x32_bf16 a[68:71], v[116:119], v[96:99], a[68:71]
  v_mfma_f32_16x16x32_bf16 a[72:75], v[120:123], v[96:99], a[72:75]
  ds_read_b128 v[36:39], v10 offset:2048
  v_mfma_f32_16x16x32_bf16 a[76:79], v[124:127], v[96:99], a[76:79]
  v_mfma_f32_16x16x32_bf16 a[80:83], v[112:115], v[100:103], a[80:83]
  ds_read_b128 v[40:43], v10 offset:4096
  v_mfma_f32_16x16x32_bf16 a[84:87], v[116:119], v[100:103], a[84:87]
  v_mfma_f32_16x16x32_bf16 a[88:91], v[120:123], v[100:103], a[88:91]
  ds_read_b128 v[44:47], v10 offset:6144
  v_mfma_f32_16x16x32_bf16 a[92:95], v[124:127], v[100:103], a[92:95]
  v_mfma_f32_16x16x32_bf16 a[96:99], v[112:115], v[104:107], a[96:99]
  ds_read_b128 v[48:51], v10 offset:8192
  v_mfma_f32_16x16x32_bf16 a[100:103], v[116:119], v[104:107], a[100:103]
  v_mfma_f32_16x16x32_bf16 a[104:107], v[120:123], v[104:107], a[104:107]
  ds_read_b128 v[52:55], v10 offset:10240
  v_mfma_f32_16x16x32_bf16 a[108:111], v[124:127], v[104:107], a[108:111]
  v_mfma_f32_16x16x32_bf16 a[112:115], v[112:115], v[108:111], a[112:115]
  ds_read_b128 v[56:59], v10 offset:12288
  v_mfma_f32_16x16x32_bf16 a[116:119], v[116:119], v[108:111], a[116:119]
  v_mfma_f32_16x16x32_bf16 a[120:123], v[120:123], v[108:111], a[120:123]
  ds_read_b128 v[60:63], v10 offset:14336
  v_mfma_f32_16x16x32_bf16 a[124:127], v[124:127], v[108:111], a[124:127]
  s_waitcnt lgkmcnt(0)
  v_mfma_f32_16x16x32_bf16 a[0:3], v[64:67], v[32:35], a[0:3]
  ds_read_b64_tr_b16 v[112:113], v14 offset:16384
  v_mfma_f32_16x16x32_bf16 a[4:7], v[68:71], v[32:35], a[4:7]
  v_mfma_f32_16x16x32_bf16 a[8:11], v[72:75], v[32:35], a[8:11]
  ds_read_b64_tr_b16 v[114:115], v14 offset:18432
  v_mfma_f32_16x16x32_bf16 a[12:15], v[76:79], v[32:35], a[12:15]
  v_mfma_f32_16x16x32_bf16 a[16:19], v[64:67], v[36:39], a[16:19]
  ds_read_b64_tr_b16 v[116:117], v12 offset:16384
  v_mfma_f32_16x16x32_bf16 a[20:23], v[68:71], v[36:39], a[20:23]
  v_mfma_f32_16x16x32_bf16 a[24:27], v[72:75], v[36:39], a[24:27]
  ds_read_b64_tr_b16 v[118:119], v12 offset:18432
  v_mfma_f32_16x16x32_bf16 a[28:31], v[76:79], v[36:39], a[28:31]
  v_mfma_f32_16x16x32_bf16 a[32:35], v[64:67], v[40:43], a[32:35]
  ds_read_b64_tr_b16 v[120:121], v15 offset:16384
  v_mfma_f32_16x16x32_bf16 a[36:39], v[68:71], v[40:43], a[36:39]
  v_mfma_f32_16x16x32_bf16 a[40:43], v[72:75], v[40:43], a[40:43]
  ds_read_b64_tr_b16 v[122:123], v15 offset:18432
  v_mfma_f32_16x16x32_bf16 a[44:47], v[76:79], v[40:43], a[44:47]
  v_mfma_f32_16x16x32_bf16 a[48:51], v[64:67], v[44:47], a[48:51]
  ds_read_b64_tr_b16 v[124:125], v13 offset:16384
  v_mfma_f32_16x16x32_bf16 a[52:55], v[68:71], v[44:47], a[52:55]
  v_mfma_f32_16x16x32_bf16 a[56:59], v[72:75], v[44:47], a[56:59]
  ds_read_b64_tr_b16 v[126:127], v13 offset:18432
  v_mfma_f32_16x16x32_bf16 a[60:63], v[76:79], v[44:47], a[60:63]
  v_mfma_f32_16x16x32_bf16 a[64:67], v[64:67], v[48:51], a[64:67]
  ds_read_b128 v[80:83], v11 offset:0
  v_mfma_f32_16x16x32_bf16 a[68:71], v[68:71], v[48:51], a[68:71]
  v_mfma_f32_16x16x32_bf16 a[72:75], v[72:75], v[48:51], a[72:75]
  ds_read_b128 v[84:87], v11 offset:2048
  v_mfma_f32_16x16x32_bf16 a[76:79], v[76:79], v[48:51], a[76:79]
  v_mfma_f32_16x16x32_bf16 a[80:83], v[64:67], v[52:55], a[80:83]
  ds_read_b128 v[88:91], v11 offset:4096
  v_mfma_f32_16x16x32_bf16 a[84:87], v[68:71], v[52:55], a[84:87]
  v_mfma_f32_16x16x32_bf16 a[88:91], v[72:75], v[52:55], a[88:91]
  ds_read_b128 v[92:95], v11 offset:6144
  v_mfma_f32_16x16x32_bf16 a[92:95], v[76:79], v[52:55], a[92:95]
  v_mfma_f32_16x16x32_bf16 a[96:99], v[64:67], v[56:59], a[96:99]
  ds_read_b128 v[96:99], v11 offset:8192
  v_mfma_f32_16x16x32_bf16 a[100:103], v[68:71], v[56:59], a[100:103]
  v_mfma_f32_16x16x32_bf16 a[104:107], v[72:75], v[56:59], a[104:107]
  ds_read_b128 v[100:103], v11 offset:10240
  v_mfma_f32_16x16x32_bf16 a[108:111], v[76:79], v[56:59], a[108:111]
  v_mfma_f32_16x16x32_bf16 a[112:115], v[64:67], v[60:63], a[112:115]
  ds_read_b128 v[104:107], v11 offset:12288
  v_mfma_f32_16x16x32_bf16 a[116:119], v[68:71], v[60:63], a[116:119]
  v_mfma_f32_16x16x32_bf16 a[120:123], v[72:75], v[60:63], a[120:123]
  ds_read_b128 v[108:111], v11 offset:14336
  v_mfma_f32_16x16x32_bf16 a[124:127], v[76:79], v[60:63], a[124:127]
  s_waitcnt lgkmcnt(0)
  v_mfma_f32_16x16x32_bf16 a[0:3], v[112:115], v[80:83], a[0:3]
  v_mfma_f32_16x16x32_bf16 a[4:7], v[116:119], v[80:83], a[4:7]
  v_mfma_f32_16x16x32_bf16 a[8:11], v[120:123], v[80:83], a[8:11]
  v_mfma_f32_16x16x32_bf16 a[12:15], v[124:127], v[80:83], a[12:15]
  v_mfma_f32_16x16x32_bf16 a[16:19], v[112:115], v[84:87], a[16:19]
  v_mfma_f32_16x16x32_bf16 a[20:23], v[116:119], v[84:87], a[20:23]
  v_mfma_f32_16x16x32_bf16 a[24:27], v[120:123], v[84:87], a[24:27]
  v_mfma_f32_16x16x32_bf16 a[28:31], v[124:127], v[84:87], a[28:31]
  v_mfma_f32_16x16x32_bf16 a[32:35], v[112:115], v[88:91], a[32:35]
  v_mfma_f32_16x16x32_bf16 a[36:39], v[116:119], v[88:91], a[36:39]
  v_mfma_f32_16x16x32_bf16 a[40:43], v[120:123], v[88:91], a[40:43]
  v_mfma_f32_16x16x32_bf16 a[44:47], v[124:127], v[88:91], a[44:47]
  v_mfma_f32_16x16x32_bf16 a[48:51], v[112:115], v[92:95], a[48:51]
  v_mfma_f32_16x16x32_bf16 a[52:55], v[116:119], v[92:95], a[52:55]
  v_mfma_f32_16x16x32_bf16 a[56:59], v[120:123], v[92:95], a[56:59]
  v_mfma_f32_16x16x32_bf16 a[60:63], v[124:127], v[92:95], a[60:63]
  v_mfma_f32_16x16x32_bf16 a[64:67], v[112:115], v[96:99], a[64:67]
  v_mfma_f32_16x16x32_bf16 a[68:71], v[116:119], v[96:99], a[68:71]
  v_mfma_f32_16x16x32_bf16 a[72:75], v[120:123], v[96:99], a[72:75]
  v_mfma_f32_16x16x32_bf16 a[76:79], v[124:127], v[96:99], a[76:79]
  v_mfma_f32_16x16x32_bf16 a[80:83], v[112:115], v[100:103], a[80:83]
  v_mfma_f32_16x16x32_bf16 a[84:87], v[116:119], v[100:103], a[84:87]
  v_mfma_f32_16x16x32_bf16 a[88:91], v[120:123], v[100:103], a[88:91]
  v_mfma_f32_16x16x32_bf16 a[92:95], v[124:127], v[100:103], a[92:95]
  v_mfma_f32_16x16x32_bf16 a[96:99], v[112:115], v[104:107], a[96:99]
  v_mfma_f32_16x16x32_bf16 a[100:103], v[116:119], v[104:107], a[100:103]
  v_mfma_f32_16x16x32_bf16 a[104:107], v[120:123], v[104:107], a[104:107]
  v_mfma_f32_16x16x32_bf16 a[108:111], v[124:127], v[104:107], a[108:111]
  v_mfma_f32_16x16x32_bf16 a[112:115], v[112:115], v[108:111], a[112:115]
  v_mfma_f32_16x16x32_bf16 a[116:119], v[116:119], v[108:111], a[116:119]
  v_mfma_f32_16x16x32_bf16 a[120:123], v[120:123], v[108:111], a[120:123]
  v_mfma_f32_16x16x32_bf16 a[124:127], v[124:127], v[108:111], a[124:127]
  s_nop 11
  s_branch L_G1E
L_G1V:
  s_barrier
  ds_read_b64_tr_b16 v[64:65], v14 offset:0
  ds_read_b64_tr_b16 v[66:67], v14 offset:2048
  ds_read_b64_tr_b16 v[68:69], v12 offset:0
  ds_read_b64_tr_b16 v[70:71], v12 offset:2048
  ds_read_b64_tr_b16 v[72:73], v15 offset:0
  ds_read_b64_tr_b16 v[74:75], v15 offset:2048
  ds_read_b64_tr_b16 v[76:77], v13 offset:0
  ds_read_b64_tr_b16 v[78:79], v13 offset:2048
  ds_read_b128 v[32:35], v10 offset:0
  ds_read_b128 v[36:39], v10 offset:2048
  ds_read_b128 v[40:43], v10 offset:4096
  ds_read_b128 v[44:47], v10 offset:6144
  ds_read_b128 v[48:51], v10 offset:8192
  ds_read_b128 v[52:55], v10 offset:10240
  ds_read_b128 v[56:59], v10 offset:12288
  ds_read_b128 v[60:63], v10 offset:14336
  s_waitcnt lgkmcnt(0)
  v_mfma_f32_16x16x32_bf16 a[0:3], v[32:35], v[64:67], 0
  ds_read_b64_tr_b16 v[112:113], v14 offset:16384
  v_mfma_f32_16x16x32_bf16 a[4:7], v[32:35], v[68:71], 0
  v_mfma_f32_16x16x32_bf16 a[8:11], v[32:35], v[72:75], 0
  ds_read_b64_tr_b16 v[114:115], v14 offset:18432
  v_mfma_f32_16x16x32_bf16 a[12:15], v[32:35], v[76:79], 0
  v_mfma_f32_16x16x32_bf16 a[16:19], v[36:39], v[64:67], 0
  ds_read_b64_tr_b16 v[116:117], v12 offset:16384
  v_mfma_f32_16x16x32_bf16 a[20:23], v[36:39], v[68:71], 0
  v_mfma_f32_16x16x32_bf16 a[24:27], v[36:39], v[72:75], 0
  ds_read_b64_tr_b16 v[118:119], v12 offset:18432
  v_mfma_f32_16x16x32_bf16 a[28:31], v[36:39], v[76:79], 0
  v_mfma_f32_16x16x32_bf16 a[32:35], v[40:43], v[64:67], 0
  ds_read_b64_tr_b16 v[120:121], v15 offset:16384
  v_mfma_f32_16x16x32_bf16 a[36:39], v[40:43], v[68:71], 0
  v_mfma_f32_16x16x32_bf16 a[40:43], v[40:43], v[72:75], 0
  ds_read_b64_tr_b16 v[122:123], v15 offset:18432
  v_mfma_f32_16x16x32_bf16 a[44:47], v[40:43], v[76:79], 0
  v_mfma_f32_16x16x32_bf16 a[48:51], v[44:47], v[64:67], 0
  ds_read_b64_tr_b16 v[124:125], v13 offset:16384
  v_mfma_f32_16x16x32_bf16 a[52:55], v[44:47], v[68:71], 0
  v_mfma_f32_16x16x32_bf16 a[56:59], v[44:47], v[72:75], 0
  ds_read_b64_tr_b16 v[126:127], v13 offset:18432
  v_mfma_f32_16x16x32_bf16 a[60:63], v[44:47], v[76:79], 0
  v_mfma_f32_16x16x32_bf16 a[64:67], v[48:51], v[64:67], 0
  ds_read_b128 v[80:83], v11 offset:0
  v_mfma_f32_16x16x32_bf16 a[68:71], v[48:51], v[68:71], 0
  v_mfma_f32_16x16x32_bf16 a[72:75], v[48:51], v[72:75], 0
  ds_read_b128 v[84:87], v11 offset:2048
  v_mfma_f32_16x16x32_bf16 a[76:79], v[48:51], v[76:79], 0
  v_mfma_f32_16x16x32_bf16 a[80:83], v[52:55], v[64:67], 0
  ds_read_b128 v[88:91], v11 offset:4096
  v_mfma_f32_16x16x32_bf16 a[84:87], v[52:55], v[68:71], 0
  v_mfma_f32_16x16x32_bf16 a[88:91], v[52:55], v[72:75], 0
  ds_read_b128 v[92:95], v11 offset:6144
  v_mfma_f32_16x16x32_bf16 a[92:95], v[52:55], v[76:79], 0
  v_mfma_f32_16x16x32_bf16 a[96:99], v[56:59], v[64:67], 0
  ds_read_b128 v[96:99], v11 offset:8192
  v_mfma_f32_16x16x32_bf16 a[100:103], v[56:59], v[68:71], 0
  v_mfma_f32_16x16x32_bf16 a[104:107], v[56:59], v[72:75], 0
  ds_read_b128 v[100:103], v11 offset:10240
  v_mfma_f32_16x16x32_bf16 a[108:111], v[56:59], v[76:79], 0
  v_mfma_f32_16x16x32_bf16 a[112:115], v[60:63], v[64:67], 0
  ds_read_b128 v[104:107], v11 offset:12288
  v_mfma_f32_16x16x32_bf16 a[116:119], v[60:63], v[68:71], 0
  v_mfma_f32_16x16x32_bf16 a[120:123], v[60:63], v[72:75], 0
  ds_read_b128 v[108:111], v11 offset:14336
  v_mfma_f32_16x16x32_bf16 a[124:127], v[60:63], v[76:79], 0
  s_waitcnt lgkmcnt(0)
  s_waitcnt vmcnt(0)
  s_barrier
  v_xor_b32 v10, 0x10000, v10
  v_xor_b32 v11, 0x10000, v11
  v_xor_b32 v12, 0x10000, v12
  v_xor_b32 v13, 0x10000, v13
  v_xor_b32 v14, 0x10000, v14
  v_xor_b32 v15, 0x10000, v15
  s_cmp_eq_u32 s52, 0
  s_cbranch_scc1 H4
  s_cmp_lg_u32 s34, 0
  s_cbranch_scc1 H4
  s_add_u32 s39, s68, 0
  v_mov_b32 v16, s39
  v_mov_b32 v17, s69
  s_mov_b64 exec, 1
  global_atomic_add v16, v17, s[28:29] sc1
  s_mov_b64 exec, -1
H4:
  v_mfma_f32_16x16x32_bf16 a[0:3], v[80:83], v[112:115], a[0:3]
  ds_read_b64_tr_b16 v[64:65], v14 offset:0
  ds_read_b64_tr_b16 v[66:67], v14 offset:2048
  v_mfma_f32_16x16x32_bf16 a[4:7], v[80:83], v[116:119], a[4:7]
  ds_read_b64_tr_b16 v[68:69], v12 offset:0
  v_mfma_f32_16x16x32_bf16 a[8:11], v[80:83], v[120:123], a[8:11]
  ds_read_b64_tr_b16 v[70:71], v12 offset:2048
  v_mfma_f32_16x16x32_bf16 a[12:15], v[80:83], v[124:127], a[12:15]
  ds_read_b64_tr_b16 v[72:73], v15 offset:0
  v_mfma_f32_16x16x32_bf16 a[16:19], v[84:87], v[112:115], a[16:19]
  ds_read_b64_tr_b16 v[74:75], v15 offset:2048
  v_mfma_f32_16x16x32_bf16 a[20:23], v[84:87], v[116:119], a[20:23]
  ds_read_b64_tr_b16 v[76:77], v13 offset:0
  v_mfma_f32_16x16x32_bf16 a[24:27], v[84:87], v[120:123], a[24:27]
  ds_read_b64_tr_b16 v[78:79], v13 offset:2048
  v_mfma_f32_16x16x32_bf16 a[28:31], v[84:87], v[124:127], a[28:31]
  ds_read_b128 v[32:35], v10 offset:0
  v_mfma_f32_16x16x32_bf16 a[32:35], v[88:91], v[112:115], a[32:35]
  ds_read_b128 v[36:39], v10 offset:2048
  v_mfma_f32_16x16x32_bf16 a[36:39], v[88:91], v[116:119], a[36:39]
  ds_read_b128 v[40:43], v10 offset:4096
  v_mfma_f32_16x16x32_bf16 a[40:43], v[88:91], v[120:123], a[40:43]
  ds_read_b128 v[44:47], v10 offset:6144
  v_mfma_f32_16x16x32_bf16 a[44:47], v[88:91], v[124:127], a[44:47]
  ds_read_b128 v[48:51], v10 offset:8192
  v_mfma_f32_16x16x32_bf16 a[48:51], v[92:95], v[112:115], a[48:51]
  ds_read_b128 v[52:55], v10 offset:10240
  v_mfma_f32_16x16x32_bf16 a[52:55], v[92:95], v[116:119], a[52:55]
  ds_read_b128 v[56:59], v10 offset:12288
  v_mfma_f32_16x16x32_bf16 a[56:59], v[92:95], v[120:123], a[56:59]
  ds_read_b128 v[60:63], v10 offset:14336
  v_mfma_f32_16x16x32_bf16 a[60:63], v[92:95], v[124:127], a[60:63]
  s_mov_b32 m0, s45
  v_mfma_f32_16x16x32_bf16 a[64:67], v[96:99], v[112:115], a[64:67]
  s_nop 0
  global_load_lds_dwordx4 v2, s[56:57] offset:0
  v_mfma_f32_16x16x32_bf16 a[68:71], v[96:99], v[116:119], a[68:71]
  global_load_lds_dwordx4 v3, s[56:57] offset:1024
  v_mfma_f32_16x16x32_bf16 a[72:75], v[96:99], v[120:123], a[72:75]
  global_load_lds_dwordx4 v4, s[56:57] offset:2048
  v_mfma_f32_16x16x32_bf16 a[76:79], v[96:99], v[124:127], a[76:79]
  global_load_lds_dwordx4 v5, s[56:57] offset:3072
  v_mfma_f32_16x16x32_bf16 a[80:83], v[100:103], v[112:115], a[80:83]
  s_mov_b32 m0, s46
  v_mfma_f32_16x16x32_bf16 a[84:87], v[100:103], v[116:119], a[84:87]
  s_nop 0
  v_mfma_f32_16x16x32_bf16 a[88:91], v[100:103], v[120:123], a[88:91]
  global_load_lds_dwordx4 v6, s[58:59] offset:0
  v_mfma_f32_16x16x32_bf16 a[92:95], v[100:103], v[124:127], a[92:95]
  global_load_lds_dwordx4 v7, s[58:59] offset:1024
  v_mfma_f32_16x16x32_bf16 a[96:99], v[104:107], v[112:115], a[96:99]
  global_load_lds_dwordx4 v8, s[58:59] offset:2048
  v_mfma_f32_16x16x32_bf16 a[100:103], v[104:107], v[116:119], a[100:103]
  global_load_lds_dwordx4 v9, s[58:59] offset:3072
  v_mfma_f32_16x16x32_bf16 a[104:107], v[104:107], v[120:123], a[104:107]
  s_add_u32 s56, s56, 128
  v_mfma_f32_16x16x32_bf16 a[108:111], v[104:107], v[124:127], a[108:111]
  s_addc_u32 s57, s57, 0
  v_mfma_f32_16x16x32_bf16 a[112:115], v[108:111], v[112:115], a[112:115]
  s_add_u32 s58, s58, s48
  v_mfma_f32_16x16x32_bf16 a[116:119], v[108:111], v[116:119], a[116:119]
  s_addc_u32 s59, s59, 0
  v_mfma_f32_16x16x32_bf16 a[120:123], v[108:111], v[120:123], a[120:123]
  s_xor_b32 s45, s45, 0x10000
  v_mfma_f32_16x16x32_bf16 a[124:127], v[108:111], v[124:127], a[124:127]
  s_xor_b32 s46, s46, 0x10000
  s_mov_b32 s47, 13
G5:
  s_waitcnt lgkmcnt(0)
  v_mfma_f32_16x16x32_bf16 a[0:3], v[32:35], v[64:67], a[0:3]
  ds_read_b64_tr_b16 v[112:113], v14 offset:16384
  v_mfma_f32_16x16x32_bf16 a[4:7], v[32:35], v[68:71], a[4:7]
  v_mfma_f32_16x16x32_bf16 a[8:11], v[32:35], v[72:75], a[8:11]
  ds_read_b64_tr_b16 v[114:115], v14 offset:18432
  v_mfma_f32_16x16x32_bf16 a[12:15], v[32:35], v[76:79], a[12:15]
  v_mfma_f32_16x16x32_bf16 a[16:19], v[36:39], v[64:67], a[16:19]
  ds_read_b64_tr_b16 v[116:117], v12 offset:16384
  v_mfma_f32_16x16x32_bf16 a[20:23], v[36:39], v[68:71], a[20:23]
  v_mfma_f32_16x16x32_bf16 a[24:27], v[36:39], v[72:75], a[24:27]
  ds_read_b64_tr_b16 v[118:119], v12 offset:18432
  v_mfma_f32_16x16x32_bf16 a[28:31], v[36:39], v[76:79], a[28:31]
  v_mfma_f32_16x16x32_bf16 a[32:35], v[40:43], v[64:67], a[32:35]
  ds_read_b64_tr_b16 v[120:121], v15 offset:16384
  v_mfma_f32_16x16x32_bf16 a[36:39], v[40:43], v[68:71], a[36:39]
  v_mfma_f32_16x16x32_bf16 a[40:43], v[40:43], v[72:75], a[40:43]
  ds_read_b64_tr_b16 v[122:123], v15 offset:18432
  v_mfma_f32_16x16x32_bf16 a[44:47], v[40:43], v[76:79], a[44:47]
  v_mfma_f32_16x16x32_bf16 a[48:51], v[44:47], v[64:67], a[48:51]
  ds_read_b64_tr_b16 v[124:125], v13 offset:16384
  v_mfma_f32_16x16x32_bf16 a[52:55], v[44:47], v[68:71], a[52:55]
  v_mfma_f32_16x16x32_bf16 a[56:59], v[44:47], v[72:75], a[56:59]
  ds_read_b64_tr_b16 v[126:127], v13 offset:18432
  v_mfma_f32_16x16x32_bf16 a[60:63], v[44:47], v[76:79], a[60:63]
  v_mfma_f32_16x16x32_bf16 a[64:67], v[48:51], v[64:67], a[64:67]
  ds_read_b128 v[80:83], v11 offset:0
  v_mfma_f32_16x16x32_bf16 a[68:71], v[48:51], v[68:71], a[68:71]
  v_mfma_f32_16x16x32_bf16 a[72:75], v[48:51], v[72:75], a[72:75]
  ds_read_b128 v[84:87], v11 offset:2048
  v_mfma_f32_16x16x32_bf16 a[76:79], v[48:51], v[76:79], a[76:79]
  v_mfma_f32_16x16x32_bf16 a[80:83], v[52:55], v[64:67], a[80:83]
  ds_read_b128 v[88:91], v11 offset:4096
  v_mfma_f32_16x16x32_bf16 a[84:87], v[52:55], v[68:71], a[84:87]
  v_mfma_f32_16x16x32_bf16 a[88:91], v[52:55], v[72:75], a[88:91]
  ds_read_b128 v[92:95], v11 offset:6144
  v_mfma_f32_16x16x32_bf16 a[92:95], v[52:55], v[76:79], a[92:95]
  v_mfma_f32_16x16x32_bf16 a[96:99], v[56:59], v[64:67], a[96:99]
  ds_read_b128 v[96:99], v11 offset:8192
  v_mfma_f32_16x16x32_bf16 a[100:103], v[56:59], v[68:71], a[100:103]
  v_mfma_f32_16x16x32_bf16 a[104:107], v[56:59], v[72:75], a[104:107]
  ds_read_b128 v[100:103], v11 offset:10240
  v_mfma_f32_16x16x32_bf16 a[108:111], v[56:59], v[76:79], a[108:111]
  v_mfma_f32_16x16x32_bf16 a[112:115], v[60:63], v[64:67], a[112:115]
  ds_read_b128 v[104:107], v11 offset:12288
  v_mfma_f32_16x16x32_bf16 a[116:119], v[60:63], v[68:71], a[116:119]
  v_mfma_f32_16x16x32_bf16 a[120:123], v[60:63], v[72:75], a[120:123]
  ds_read_b128 v[108:111], v11 offset:14336
  v_mfma_f32_16x16x32_bf16 a[124:127], v[60:63], v[76:79], a[124:127]
  s_waitcnt lgkmcnt(0)
  s_waitcnt vmcnt(0)
  s_barrier
  v_xor_b32 v10, 0x10000, v10
  v_xor_b32 v11, 0x10000, v11
  v_xor_b32 v12, 0x10000, v12
  v_xor_b32 v13, 0x10000, v13
  v_xor_b32 v14, 0x10000, v14
  v_xor_b32 v15, 0x10000, v15
  v_mfma_f32_16x16x32_bf16 a[0:3], v[80:83], v[112:115], a[0:3]
  ds_read_b64_tr_b16 v[64:65], v14 offset:0
  ds_read_b64_tr_b16 v[66:67], v14 offset:2048
  v_mfma_f32_16x16x32_bf16 a[4:7], v[80:83], v[116:119], a[4:7]
  ds_read_b64_tr_b16 v[68:69], v12 offset:0
  v_mfma_f32_16x16x32_bf16 a[8:11], v[80:83], v[120:123], a[8:11]
  ds_read_b64_tr_b16 v[70:71], v12 offset:2048
  v_mfma_f32_16x16x32_bf16 a[12:15], v[80:83], v[124:127], a[12:15]
  ds_read_b64_tr_b16 v[72:73], v15 offset:0
  v_mfma_f32_16x16x32_bf16 a[16:19], v[84:87], v[112:115], a[16:19]
  ds_read_b64_tr_b16 v[74:75], v15 offset:2048
  v_mfma_f32_16x16x32_bf16 a[20:23], v[84:87], v[116:119], a[20:23]
  ds_read_b64_tr_b16 v[76:77], v13 offset:0
  v_mfma_f32_16x16x32_bf16 a[24:27], v[84:87], v[120:123], a[24:27]
  ds_read_b64_tr_b16 v[78:79], v13 offset:2048
  v_mfma_f32_16x16x32_bf16 a[28:31], v[84:87], v[124:127], a[28:31]
  ds_read_b128 v[32:35], v10 offset:0
  v_mfma_f32_16x16x32_bf16 a[32:35], v[88:91], v[112:115], a[32:35]
  ds_read_b128 v[36:39], v10 offset:2048
  v_mfma_f32_16x16x32_bf16 a[36:39], v[88:91], v[116:119], a[36:39]
  ds_read_b128 v[40:43], v10 offset:4096
  v_mfma_f32_16x16x32_bf16 a[40:43], v[88:91], v[120:123], a[40:43]
  ds_read_b128 v[44:47], v10 offset:6144
  v_mfma_f32_16x16x32_bf16 a[44:47], v[88:91], v[124:127], a[44:47]
  ds_read_b128 v[48:51], v10 offset:8192
  v_mfma_f32_16x16x32_bf16 a[48:51], v[92:95], v[112:115], a[48:51]
  ds_read_b128 v[52:55], v10 offset:10240
  v_mfma_f32_16x16x32_bf16 a[52:55], v[92:95], v[116:119], a[52:55]
  ds_read_b128 v[56:59], v10 offset:12288
  v_mfma_f32_16x16x32_bf16 a[56:59], v[92:95], v[120:123], a[56:59]
  ds_read_b128 v[60:63], v10 offset:14336
  v_mfma_f32_16x16x32_bf16 a[60:63], v[92:95], v[124:127], a[60:63]
  s_mov_b32 m0, s45
  v_mfma_f32_16x16x32_bf16 a[64:67], v[96:99], v[112:115], a[64:67]
  s_nop 0
  global_load_lds_dwordx4 v2, s[56:57] offset:0
  v_mfma_f32_16x16x32_bf16 a[68:71], v[96:99], v[116:119], a[68:71]
  global_load_lds_dwordx4 v3, s[56:57] offset:1024
  v_mfma_f32_16x16x32_bf16 a[72:75], v[96:99], v[120:123], a[72:75]
  global_load_lds_dwordx4 v4, s[56:57] offset:2048
  v_mfma_f32_16x16x32_bf16 a[76:79], v[96:99], v[124:127], a[76:79]
  global_load_lds_dwordx4 v5, s[56:57] offset:3072
  v_mfma_f32_16x16x32_bf16 a[80:83], v[100:103], v[112:115], a[80:83]
  s_mov_b32 m0, s46
  v_mfma_f32_16x16x32_bf16 a[84:87], v[100:103], v[116:119], a[84:87]
  s_nop 0
  v_mfma_f32_16x16x32_bf16 a[88:91], v[100:103], v[120:123], a[88:91]
  global_load_lds_dwordx4 v6, s[58:59] offset:0
  v_mfma_f32_16x16x32_bf16 a[92:95], v[100:103], v[124:127], a[92:95]
  global_load_lds_dwordx4 v7, s[58:59] offset:1024
  v_mfma_f32_16x16x32_bf16 a[96:99], v[104:107], v[112:115], a[96:99]
  global_load_lds_dwordx4 v8, s[58:59] offset:2048
  v_mfma_f32_16x16x32_bf16 a[100:103], v[104:107], v[116:119], a[100:103]
  global_load_lds_dwordx4 v9, s[58:59] offset:3072
  v_mfma_f32_16x16x32_bf16 a[104:107], v[104:107], v[120:123], a[104:107]
  s_add_u32 s56, s56, 128
  v_mfma_f32_16x16x32_bf16 a[108:111], v[104:107], v[124:127], a[108:111]
  s_addc_u32 s57, s57, 0
  v_mfma_f32_16x16x32_bf16 a[112:115], v[108:111], v[112:115], a[112:115]
  s_add_u32 s58, s58, s48
  v_mfma_f32_16x16x32_bf16 a[116:119], v[108:111], v[116:119], a[116:119]
  s_addc_u32 s59, s59, 0
  v_mfma_f32_16x16x32_bf16 a[120:123], v[108:111], v[120:123], a[120:123]
  s_xor_b32 s45, s45, 0x10000
  v_mfma_f32_16x16x32_bf16 a[124:127], v[108:111], v[124:127], a[124:127]
  s_xor_b32 s46, s46, 0x10000
  s_sub_u32 s47, s47, 1
  s_cmp_lg_u32 s47, 0
  s_cbranch_scc1 G5
  s_waitcnt lgkmcnt(0)
  v_mfma_f32_16x16x32_bf16 a[0:3], v[32:35], v[64:67], a[0:3]
  ds_read_b64_tr_b16 v[112:113], v14 offset:16384
  v_mfma_f32_16x16x32_bf16 a[4:7], v[32:35], v[68:71], a[4:7]
  v_mfma_f32_16x16x32_bf16 a[8:11], v[32:35], v[72:75], a[8:11]
  ds_read_b64_tr_b16 v[114:115], v14 offset:18432
  v_mfma_f32_16x16x32_bf16 a[12:15], v[32:35], v[76:79], a[12:15]
  v_mfma_f32_16x16x32_bf16 a[16:19], v[36:39], v[64:67], a[16:19]
  ds_read_b64_tr_b16 v[116:117], v12 offset:16384
  v_mfma_f32_16x16x32_bf16 a[20:23], v[36:39], v[68:71], a[20:23]
  v_mfma_f32_16x16x32_bf16 a[24:27], v[36:39], v[72:75], a[24:27]
  ds_read_b64_tr_b16 v[118:119], v12 offset:18432
  v_mfma_f32_16x16x32_bf16 a[28:31], v[36:39], v[76:79], a[28:31]
  v_mfma_f32_16x16x32_bf16 a[32:35], v[40:43], v[64:67], a[32:35]
  ds_read_b64_tr_b16 v[120:121], v15 offset:16384
  v_mfma_f32_16x16x32_bf16 a[36:39], v[40:43], v[68:71], a[36:39]
  v_mfma_f32_16x16x32_bf16 a[40:43], v[40:43], v[72:75], a[40:43]
  ds_read_b64_tr_b16 v[122:123], v15 offset:18432
  v_mfma_f32_16x16x32_bf16 a[44:47], v[40:43], v[76:79], a[44:47]
  v_mfma_f32_16x16x32_bf16 a[48:51], v[44:47], v[64:67], a[48:51]
  ds_read_b64_tr_b16 v[124:125], v13 offset:16384
  v_mfma_f32_16x16x32_bf16 a[52:55], v[44:47], v[68:71], a[52:55]
  v_mfma_f32_16x16x32_bf16 a[56:59], v[44:47], v[72:75], a[56:59]
  ds_read_b64_tr_b16 v[126:127], v13 offset:18432
  v_mfma_f32_16x16x32_bf16 a[60:63], v[44:47], v[76:79], a[60:63]
  v_mfma_f32_16x16x32_bf16 a[64:67], v[48:51], v[64:67], a[64:67]
  ds_read_b128 v[80:83], v11 offset:0
  v_mfma_f32_16x16x32_bf16 a[68:71], v[48:51], v[68:71], a[68:71]
  v_mfma_f32_16x16x32_bf16 a[72:75], v[48:51], v[72:75], a[72:75]
  ds_read_b128 v[84:87], v11 offset:2048
  v_mfma_f32_16x16x32_bf16 a[76:79], v[48:51], v[76:79], a[76:79]
  v_mfma_f32_16x16x32_bf16 a[80:83], v[52:55], v[64:67], a[80:83]
  ds_read_b128 v[88:91], v11 offset:4096
  v_mfma_f32_16x16x32_bf16 a[84:87], v[52:55], v[68:71], a[84:87]
  v_mfma_f32_16x16x32_bf16 a[88:91], v[52:55], v[72:75], a[88:91]
  ds_read_b128 v[92:95], v11 offset:6144
  v_mfma_f32_16x16x32_bf16 a[92:95], v[52:55], v[76:79], a[92:95]
  v_mfma_f32_16x16x32_bf16 a[96:99], v[56:59], v[64:67], a[96:99]
  ds_read_b128 v[96:99], v11 offset:8192
  v_mfma_f32_16x16x32_bf16 a[100:103], v[56:59], v[68:71], a[100:103]
  v_mfma_f32_16x16x32_bf16 a[104:107], v[56:59], v[72:75], a[104:107]
  ds_read_b128 v[100:103], v11 offset:10240
  v_mfma_f32_16x16x32_bf16 a[108:111], v[56:59], v[76:79], a[108:111]
  v_mfma_f32_16x16x32_bf16 a[112:115], v[60:63], v[64:67], a[112:115]
  ds_read_b128 v[104:107], v11 offset:12288
  v_mfma_f32_16x16x32_bf16 a[116:119], v[60:63], v[68:71], a[116:119]
  v_mfma_f32_16x16x32_bf16 a[120:123], v[60:63], v[72:75], a[120:123]
  ds_read_b128 v[108:111], v11 offset:14336
  v_mfma_f32_16x16x32_bf16 a[124:127], v[60:63], v[76:79], a[124:127]
  s_waitcnt lgkmcnt(0)
  s_waitcnt vmcnt(0)
  s_barrier
  v_xor_b32 v10, 0x10000, v10
  v_xor_b32 v11, 0x10000, v11
  v_xor_b32 v12, 0x10000, v12
  v_xor_b32 v13, 0x10000, v13
  v_xor_b32 v14, 0x10000, v14
  v_xor_b32 v15, 0x10000, v15
  v_mfma_f32_16x16x32_bf16 a[0:3], v[80:83], v[112:115], a[0:3]
  ds_read_b64_tr_b16 v[64:65], v14 offset:0
  v_mfma_f32_16x16x32_bf16 a[4:7], v[80:83], v[116:119], a[4:7]
  v_mfma_f32_16x16x32_bf16 a[8:11], v[80:83], v[120:123], a[8:11]
  ds_read_b64_tr_b16 v[66:67], v14 offset:2048
  v_mfma_f32_16x16x32_bf16 a[12:15], v[80:83], v[124:127], a[12:15]
  v_mfma_f32_16x16x32_bf16 a[16:19], v[84:87], v[112:115], a[16:19]
  ds_read_b64_tr_b16 v[68:69], v12 offset:0
  v_mfma_f32_16x16x32_bf16 a[20:23], v[84:87], v[116:119], a[20:23]
  v_mfma_f32_16x16x32_bf16 a[24:27], v[84:87], v[120:123], a[24:27]
  ds_read_b64_tr_b16 v[70:71], v12 offset:2048
  v_mfma_f32_16x16x32_bf16 a[28:31], v[84:87], v[124:127], a[28:31]
  v_mfma_f32_16x16x32_bf16 a[32:35], v[88:91], v[112:115], a[32:35]
  ds_read_b64_tr_b16 v[72:73], v15 offset:0
  v_mfma_f32_16x16x32_bf16 a[36:39], v[88:91], v[116:119], a[36:39]
  v_mfma_f32_16x16x32_bf16 a[40:43], v[88:91], v[120:123], a[40:43]
  ds_read_b64_tr_b16 v[74:75], v15 offset:2048
  v_mfma_f32_16x16x32_bf16 a[44:47], v[88:91], v[124:127], a[44:47]
  v_mfma_f32_16x16x32_bf16 a[48:51], v[92:95], v[112:115], a[48:51]
  ds_read_b64_tr_b16 v[76:77], v13 offset:0
  v_mfma_f32_16x16x32_bf16 a[52:55], v[92:95], v[116:119], a[52:55]
  v_mfma_f32_16x16x32_bf16 a[56:59], v[92:95], v[120:123], a[56:59]
  ds_read_b64_tr_b16 v[78:79], v13 offset:2048
  v_mfma_f32_16x16x32_bf16 a[60:63], v[92:95], v[124:127], a[60:63]
  v_mfma_f32_16x16x32_bf16 a[64:67], v[96:99], v[112:115], a[64:67]
  ds_read_b128 v[32:35], v10 offset:0
  v_mfma_f32_16x16x32_bf16 a[68:71], v[96:99], v[116:119], a[68:71]
  v_mfma_f32_16x16x32_bf16 a[72:75], v[96:99], v[120:123], a[72:75]
  ds_read_b128 v[36:39], v10 offset:2048
  v_mfma_f32_16x16x32_bf16 a[76:79], v[96:99], v[124:127], a[76:79]
  v_mfma_f32_16x16x32_bf16 a[80:83], v[100:103], v[112:115], a[80:83]
  ds_read_b128 v[40:43], v10 offset:4096
  v_mfma_f32_16x16x32_bf16 a[84:87], v[100:103], v[116:119], a[84:87]
  v_mfma_f32_16x16x32_bf16 a[88:91], v[100:103], v[120:123], a[88:91]
  ds_read_b128 v[44:47], v10 offset:6144
  v_mfma_f32_16x16x32_bf16 a[92:95], v[100:103], v[124:127], a[92:95]
  v_mfma_f32_16x16x32_bf16 a[96:99], v[104:107], v[112:115], a[96:99]
  ds_read_b128 v[48:51], v10 offset:8192
  v_mfma_f32_16x16x32_bf16 a[100:103], v[104:107], v[116:119], a[100:103]
  v_mfma_f32_16x16x32_bf16 a[104:107], v[104:107], v[120:123], a[104:107]
  ds_read_b128 v[52:55], v10 offset:10240
  v_mfma_f32_16x16x32_bf16 a[108:111], v[104:107], v[124:127], a[108:111]
  v_mfma_f32_16x16x32_bf16 a[112:115], v[108:111], v[112:115], a[112:115]
  ds_read_b128 v[56:59], v10 offset:12288
  v_mfma_f32_16x16x32_bf16 a[116:119], v[108:111], v[116:119], a[116:119]
  v_mfma_f32_16x16x32_bf16 a[120:123], v[108:111], v[120:123], a[120:123]
  ds_read_b128 v[60:63], v10 offset:14336
  v_mfma_f32_16x16x32_bf16 a[124:127], v[108:111], v[124:127], a[124:127]
  s_waitcnt lgkmcnt(0)
  v_mfma_f32_16x16x32_bf16 a[0:3], v[32:35], v[64:67], a[0:3]
  ds_read_b64_tr_b16 v[112:113], v14 offset:16384
  v_mfma_f32_16x16x32_bf16 a[4:7], v[32:35], v[68:71], a[4:7]
  v_mfma_f32_16x16x32_bf16 a[8:11], v[32:35], v[72:75], a[8:11]
  ds_read_b64_tr_b16 v[114:115], v14 offset:18432
  v_mfma_f32_16x16x32_bf16 a[12:15], v[32:35], v[76:79], a[12:15]
  v_mfma_f32_16x16x32_bf16 a[16:19], v[36:39], v[64:67], a[16:19]
  ds_read_b64_tr_b16 v[116:117], v12 offset:16384
  v_mfma_f32_16x16x32_bf16 a[20:23], v[36:39], v[68:71], a[20:23]
  v_mfma_f32_16x16x32_bf16 a[24:27], v[36:39], v[72:75], a[24:27]
  ds_read_b64_tr_b16 v[118:119], v12 offset:18432
  v_mfma_f32_16x16x32_bf16 a[28:31], v[36:39], v[76:79], a[28:31]
  v_mfma_f32_16x16x32_bf16 a[32:35], v[40:43], v[64:67], a[32:35]
  ds_read_b64_tr_b16 v[120:121], v15 offset:16384
  v_mfma_f32_16x16x32_bf16 a[36:39], v[40:43], v[68:71], a[36:39]
  v_mfma_f32_16x16x32_bf16 a[40:43], v[40:43], v[72:75], a[40:43]
  ds_read_b64_tr_b16 v[122:123], v15 offset:18432
  v_mfma_f32_16x16x32_bf16 a[44:47], v[40:43], v[76:79], a[44:47]
  v_mfma_f32_16x16x32_bf16 a[48:51], v[44:47], v[64:67], a[48:51]
  ds_read_b64_tr_b16 v[124:125], v13 offset:16384
  v_mfma_f32_16x16x32_bf16 a[52:55], v[44:47], v[68:71], a[52:55]
  v_mfma_f32_16x16x32_bf16 a[56:59], v[44:47], v[72:75], a[56:59]
  ds_read_b64_tr_b16 v[126:127], v13 offset:18432
  v_mfma_f32_16x16x32_bf16 a[60:63], v[44:47], v[76:79], a[60:63]
  v_mfma_f32_16x16x32_bf16 a[64:67], v[48:51], v[64:67], a[64:67]
  ds_read_b128 v[80:83], v11 offset:0
  v_mfma_f32_16x16x32_bf16 a[68:71], v[48:51], v[68:71], a[68:71]
  v_mfma_f32_16x16x32_bf16 a[72:75], v[48:51], v[72:75], a[72:75]
  ds_read_b128 v[84:87], v11 offset:2048
  v_mfma_f32_16x16x32_bf16 a[76:79], v[48:51], v[76:79], a[76:79]
  v_mfma_f32_16x16x32_bf16 a[80:83], v[52:55], v[64:67], a[80:83]
  ds_read_b128 v[88:91], v11 offset:4096
  v_mfma_f32_16x16x32_bf16 a[84:87], v[52:55], v[68:71], a[84:87]
  v_mfma_f32_16x16x32_bf16 a[88:91], v[52:55], v[72:75], a[88:91]
  ds_read_b128 v[92:95], v11 offset:6144
  v_mfma_f32_16x16x32_bf16 a[92:95], v[52:55], v[76:79], a[92:95]
  v_mfma_f32_16x16x32_bf16 a[96:99], v[56:59], v[64:67], a[96:99]
  ds_read_b128 v[96:99], v11 offset:8192
  v_mfma_f32_16x16x32_bf16 a[100:103], v[56:59], v[68:71], a[100:103]
  v_mfma_f32_16x16x32_bf16 a[104:107], v[56:59], v[72:75], a[104:107]
  ds_read_b128 v[100:103], v11 offset:10240
  v_mfma_f32_16x16x32_bf16 a[108:111], v[56:59], v[76:79], a[108:111]
  v_mfma_f32_16x16x32_bf16 a[112:115], v[60:63], v[64:67], a[112:115]
  ds_read_b128 v[104:107], v11 offset:12288
  v_mfma_f32_16x16x32_bf16 a[116:119], v[60:63], v[68:71], a[116:119]
  v_mfma_f32_16x16x32_bf16 a[120:123], v[60:63], v[72:75], a[120:123]
  ds_read_b128 v[108:111], v11 offset:14336
  v_mfma_f32_16x16x32_bf16 a[124:127], v[60:63], v[76:79], a[124:127]
  s_waitcnt lgkmcnt(0)
  v_mfma_f32_16x16x32_bf16 a[0:3], v[80:83], v[112:115], a[0:3]
  v_mfma_f32_16x16x32_bf16 a[4:7], v[80:83], v[116:119], a[4:7]
  v_mfma_f32_16x16x32_bf16 a[8:11], v[80:83], v[120:123], a[8:11]
  v_mfma_f32_16x16x32_bf16 a[12:15], v[80:83], v[124:127], a[12:15]
  v_mfma_f32_16x16x32_bf16 a[16:19], v[84:87], v[112:115], a[16:19]
  v_mfma_f32_16x16x32_bf16 a[20:23], v[84:87], v[116:119], a[20:23]
  v_mfma_f32_16x16x32_bf16 a[24:27], v[84:87], v[120:123], a[24:27]
  v_mfma_f32_16x16x32_bf16 a[28:31], v[84:87], v[124:127], a[28:31]
  v_mfma_f32_16x16x32_bf16 a[32:35], v[88:91], v[112:115], a[32:35]
  v_mfma_f32_16x16x32_bf16 a[36:39], v[88:91], v[116:119], a[36:39]
  v_mfma_f32_16x16x32_bf16 a[40:43], v[88:91], v[120:123], a[40:43]
  v_mfma_f32_16x16x32_bf16 a[44:47], v[88:91], v[124:127], a[44:47]
  v_mfma_f32_16x16x32_bf16 a[48:51], v[92:95], v[112:115], a[48:51]
  v_mfma_f32_16x16x32_bf16 a[52:55], v[92:95], v[116:119], a[52:55]
  v_mfma_f32_16x16x32_bf16 a[56:59], v[92:95], v[120:123], a[56:59]
  v_mfma_f32_16x16x32_bf16 a[60:63], v[92:95], v[124:127], a[60:63]
  v_mfma_f32_16x16x32_bf16 a[64:67], v[96:99], v[112:115], a[64:67]
  v_mfma_f32_16x16x32_bf16 a[68:71], v[96:99], v[116:119], a[68:71]
  v_mfma_f32_16x16x32_bf16 a[72:75], v[96:99], v[120:123], a[72:75]
  v_mfma_f32_16x16x32_bf16 a[76:79], v[96:99], v[124:127], a[76:79]
  v_mfma_f32_16x16x32_bf16 a[80:83], v[100:103], v[112:115], a[80:83]
  v_mfma_f32_16x16x32_bf16 a[84:87], v[100:103], v[116:119], a[84:87]
  v_mfma_f32_16x16x32_bf16 a[88:91], v[100:103], v[120:123], a[88:91]
  v_mfma_f32_16x16x32_bf16 a[92:95], v[100:103], v[124:127], a[92:95]
  v_mfma_f32_16x16x32_bf16 a[96:99], v[104:107], v[112:115], a[96:99]
  v_mfma_f32_16x16x32_bf16 a[100:103], v[104:107], v[116:119], a[100:103]
  v_mfma_f32_16x16x32_bf16 a[104:107], v[104:107], v[120:123], a[104:107]
  v_mfma_f32_16x16x32_bf16 a[108:111], v[104:107], v[124:127], a[108:111]
  v_mfma_f32_16x16x32_bf16 a[112:115], v[108:111], v[112:115], a[112:115]
  v_mfma_f32_16x16x32_bf16 a[116:119], v[108:111], v[116:119], a[116:119]
  v_mfma_f32_16x16x32_bf16 a[120:123], v[108:111], v[120:123], a[120:123]
  v_mfma_f32_16x16x32_bf16 a[124:127], v[108:111], v[124:127], a[124:127]
  s_nop 11
L_G1E:
  s_lshl_b32 s43, s53, 3
  s_lshl_b32 s39, s41, 2
  s_add_u32 s43, s43, s39
  s_lshl_b32 s43, s43, s64
  s_lshl_b32 s39, s55, 14
  s_add_u32 s43, s43, s39
  s_lshl_b32 s39, s42, 12
  s_add_u32 s43, s43, s39
  s_add_u32 s43, s43, s60
  s_mov_b32 s68, s62
  s_mov_b32 s69, s65
  s_mov_b32 s70, s61
  s_add_u32 s66, s30, s43
  s_addc_u32 s67, s31, 0
  s_add_u32 s52, s52, 1
  s_cmp_lt_u32 s52, 3
  s_cbranch_scc1 L_G1
  v_bfe_u32 v80, v0, 4, 1
  v_and_b32 v82, 15, v0
  v_lshl_add_u32 v80, v80, 5, v82
  v_lshrrev_b32 v82, 5, v0
  v_lshlrev_b32 v82, 3, v82
  v_lshl_add_u32 v80, v80, 4, v82
  v_accvgpr_read_b32 v84, a0
  v_accvgpr_read_b32 v85, a1
  v_accvgpr_read_b32 v86, a2
  v_accvgpr_read_b32 v87, a3
  v_cvt_pk_bf16_f32 v92, v84, v85
  v_cvt_pk_bf16_f32 v93, v86, v87
  global_store_dwordx2 v80, v[92:93], s[66:67] offset:0 sc1
  v_accvgpr_read_b32 v88, a4
  v_accvgpr_read_b32 v89, a5
  v_accvgpr_read_b32 v90, a6
  v_accvgpr_read_b32 v91, a7
  v_cvt_pk_bf16_f32 v94, v88, v89
  v_cvt_pk_bf16_f32 v95, v90, v91
  global_store_dwordx2 v80, v[94:95], s[66:67] offset:1024 sc1
  v_accvgpr_read_b32 v84, a8
  v_accvgpr_read_b32 v85, a9
  v_accvgpr_read_b32 v86, a10
  v_accvgpr_read_b32 v87, a11
  v_cvt_pk_bf16_f32 v96, v84, v85
  v_cvt_pk_bf16_f32 v97, v86, v87
  global_store_dwordx2 v80, v[96:97], s[66:67] offset:2048 sc1
  v_accvgpr_read_b32 v88, a12
  v_accvgpr_read_b32 v89, a13
  v_accvgpr_read_b32 v90, a14
  v_accvgpr_read_b32 v91, a15
  v_cvt_pk_bf16_f32 v98, v88, v89
  v_cvt_pk_bf16_f32 v99, v90, v91
  global_store_dwordx2 v80, v[98:99], s[66:67] offset:3072 sc1
  v_accvgpr_read_b32 v84, a16
  v_accvgpr_read_b32 v85, a17
  v_accvgpr_read_b32 v86, a18
  v_accvgpr_read_b32 v87, a19
  v_cvt_pk_bf16_f32 v100, v84, v85
  v_cvt_pk_bf16_f32 v101, v86, v87
  global_store_dwordx2 v80, v[100:101], s[66:67] offset:256 sc1
  v_accvgpr_read_b32 v88, a20
  v_accvgpr_read_b32 v89, a21
  v_accvgpr_read_b32 v90, a22
  v_accvgpr_read_b32 v91, a23
  v_cvt_pk_bf16_f32 v102, v88, v89
  v_cvt_pk_bf16_f32 v103, v90, v91
  global_store_dwordx2 v80, v[102:103], s[66:67] offset:1280 sc1
  v_accvgpr_read_b32 v84, a24
  v_accvgpr_read_b32 v85, a25
  v_accvgpr_read_b32 v86, a26
  v_accvgpr_read_b32 v87, a27
  v_cvt_pk_bf16_f32 v104, v84, v85
  v_cvt_pk_bf16_f32 v105, v86, v87
  global_store_dwordx2 v80, v[104:105], s[66:67] offset:2304 sc1
  v_accvgpr_read_b32 v88, a28
  v_accvgpr_read_b32 v89, a29
  v_accvgpr_read_b32 v90, a30
  v_accvgpr_read_b32 v91, a31
  v_cvt_pk_bf16_f32 v106, v88, v89
  v_cvt_pk_bf16_f32 v107, v90, v91
  global_store_dwordx2 v80, v[106:107], s[66:67] offset:3328 sc1
  s_add_u32 s66, s66, 262144
  s_addc_u32 s67, s67, 0
  v_accvgpr_read_b32 v84, a32
  v_accvgpr_read_b32 v85, a33
  v_accvgpr_read_b32 v86, a34
  v_accvgpr_read_b32 v87, a35
  v_cvt_pk_bf16_f32 v92, v84, v85
  v_cvt_pk_bf16_f32 v93, v86, v87
  global_store_dwordx2 v80, v[92:93], s[66:67] offset:0 sc1
  v_accvgpr_read_b32 v88, a36
  v_accvgpr_read_b32 v89, a37
  v_accvgpr_read_b32 v90, a38
  v_accvgpr_read_b32 v91, a39
  v_cvt_pk_bf16_f32 v94, v88, v89
  v_cvt_pk_bf16_f32 v95, v90, v91
  global_store_dwordx2 v80, v[94:95], s[66:67] offset:1024 sc1
  v_accvgpr_read_b32 v84, a40
  v_accvgpr_read_b32 v85, a41
  v_accvgpr_read_b32 v86, a42
  v_accvgpr_read_b32 v87, a43
  v_cvt_pk_bf16_f32 v96, v84, v85
  v_cvt_pk_bf16_f32 v97, v86, v87
  global_store_dwordx2 v80, v[96:97], s[66:67] offset:2048 sc1
  v_accvgpr_read_b32 v88, a44
  v_accvgpr_read_b32 v89, a45
  v_accvgpr_read_b32 v90, a46
  v_accvgpr_read_b32 v91, a47
  v_cvt_pk_bf16_f32 v98, v88, v89
  v_cvt_pk_bf16_f32 v99, v90, v91
  global_store_dwordx2 v80, v[98:99], s[66:67] offset:3072 sc1
  v_accvgpr_read_b32 v84, a48
  v_accvgpr_read_b32 v85, a49
  v_accvgpr_read_b32 v86, a50
  v_accvgpr_read_b32 v87, a51
  v_cvt_pk_bf16_f32 v100, v84, v85
  v_cvt_pk_bf16_f32 v101, v86, v87
  global_store_dwordx2 v80, v[100:101], s[66:67] offset:256 sc1
  v_accvgpr_read_b32 v88, a52
  v_accvgpr_read_b32 v89, a53
  v_accvgpr_read_b32 v90, a54
  v_accvgpr_read_b32 v91, a55
  v_cvt_pk_bf16_f32 v102, v88, v89
  v_cvt_pk_bf16_f32 v103, v90, v91
  global_store_dwordx2 v80, v[102:103], s[66:67] offset:1280 sc1
  v_accvgpr_read_b32 v84, a56
  v_accvgpr_read_b32 v85, a57
  v_accvgpr_read_b32 v86, a58
  v_accvgpr_read_b32 v87, a59
  v_cvt_pk_bf16_f32 v104, v84, v85
  v_cvt_pk_bf16_f32 v105, v86, v87
  global_store_dwordx2 v80, v[104:105], s[66:67] offset:2304 sc1
  v_accvgpr_read_b32 v88, a60
  v_accvgpr_read_b32 v89, a61
  v_accvgpr_read_b32 v90, a62
  v_accvgpr_read_b32 v91, a63
  v_cvt_pk_bf16_f32 v106, v88, v89
  v_cvt_pk_bf16_f32 v107, v90, v91
  global_store_dwordx2 v80, v[106:107], s[66:67] offset:3328 sc1
  s_add_u32 s66, s66, 262144
  s_addc_u32 s67, s67, 0
  v_accvgpr_read_b32 v84, a64
  v_accvgpr_read_b32 v85, a65
  v_accvgpr_read_b32 v86, a66
  v_accvgpr_read_b32 v87, a67
  v_cvt_pk_bf16_f32 v92, v84, v85
  v_cvt_pk_bf16_f32 v93, v86, v87
  global_store_dwordx2 v80, v[92:93], s[66:67] offset:0 sc1
  v_accvgpr_read_b32 v88, a68
  v_accvgpr_read_b32 v89, a69
  v_accvgpr_read_b32 v90, a70
  v_accvgpr_read_b32 v91, a71
  v_cvt_pk_bf16_f32 v94, v88, v89
  v_cvt_pk_bf16_f32 v95, v90, v91
  global_store_dwordx2 v80, v[94:95], s[66:67] offset:1024 sc1
  v_accvgpr_read_b32 v84, a72
  v_accvgpr_read_b32 v85, a73
  v_accvgpr_read_b32 v86, a74
  v_accvgpr_read_b32 v87, a75
  v_cvt_pk_bf16_f32 v96, v84, v85
  v_cvt_pk_bf16_f32 v97, v86, v87
  global_store_dwordx2 v80, v[96:97], s[66:67] offset:2048 sc1
  v_accvgpr_read_b32 v88, a76
  v_accvgpr_read_b32 v89, a77
  v_accvgpr_read_b32 v90, a78
  v_accvgpr_read_b32 v91, a79
  v_cvt_pk_bf16_f32 v98, v88, v89
  v_cvt_pk_bf16_f32 v99, v90, v91
  global_store_dwordx2 v80, v[98:99], s[66:67] offset:3072 sc1
  v_accvgpr_read_b32 v84, a80
  v_accvgpr_read_b32 v85, a81
  v_accvgpr_read_b32 v86, a82
  v_accvgpr_read_b32 v87, a83
  v_cvt_pk_bf16_f32 v100, v84, v85
  v_cvt_pk_bf16_f32 v101, v86, v87
  global_store_dwordx2 v80, v[100:101], s[66:67] offset:256 sc1
  v_accvgpr_read_b32 v88, a84
  v_accvgpr_read_b32 v89, a85
  v_accvgpr_read_b32 v90, a86
  v_accvgpr_read_b32 v91, a87
  v_cvt_pk_bf16_f32 v102, v88, v89
  v_cvt_pk_bf16_f32 v103, v90, v91
  global_store_dwordx2 v80, v[102:103], s[66:67] offset:1280 sc1
  v_accvgpr_read_b32 v84, a88
  v_accvgpr_read_b32 v85, a89
  v_accvgpr_read_b32 v86, a90
  v_accvgpr_read_b32 v87, a91
  v_cvt_pk_bf16_f32 v104, v84, v85
  v_cvt_pk_bf16_f32 v105, v86, v87
  global_store_dwordx2 v80, v[104:105], s[66:67] offset:2304 sc1
  v_accvgpr_read_b32 v88, a92
  v_accvgpr_read_b32 v89, a93
  v_accvgpr_read_b32 v90, a94
  v_accvgpr_read_b32 v91, a95
  v_cvt_pk_bf16_f32 v106, v88, v89
  v_cvt_pk_bf16_f32 v107, v90, v91
  global_store_dwordx2 v80, v[106:107], s[66:67] offset:3328 sc1
  s_add_u32 s66, s66, 262144
  s_addc_u32 s67, s67, 0
  v_accvgpr_read_b32 v84, a96
  v_accvgpr_read_b32 v85, a97
  v_accvgpr_read_b32 v86, a98
  v_accvgpr_read_b32 v87, a99
  v_cvt_pk_bf16_f32 v92, v84, v85
  v_cvt_pk_bf16_f32 v93, v86, v87
  global_store_dwordx2 v80, v[92:93], s[66:67] offset:0 sc1
  v_accvgpr_read_b32 v88, a100
  v_accvgpr_read_b32 v89, a101
  v_accvgpr_read_b32 v90, a102
  v_accvgpr_read_b32 v91, a103
  v_cvt_pk_bf16_f32 v94, v88, v89
  v_cvt_pk_bf16_f32 v95, v90, v91
  global_store_dwordx2 v80, v[94:95], s[66:67] offset:1024 sc1
  v_accvgpr_read_b32 v84, a104
  v_accvgpr_read_b32 v85, a105
  v_accvgpr_read_b32 v86, a106
  v_accvgpr_read_b32 v87, a107
  v_cvt_pk_bf16_f32 v96, v84, v85
  v_cvt_pk_bf16_f32 v97, v86, v87
  global_store_dwordx2 v80, v[96:97], s[66:67] offset:2048 sc1
  v_accvgpr_read_b32 v88, a108
  v_accvgpr_read_b32 v89, a109
  v_accvgpr_read_b32 v90, a110
  v_accvgpr_read_b32 v91, a111
  v_cvt_pk_bf16_f32 v98, v88, v89
  v_cvt_pk_bf16_f32 v99, v90, v91
  global_store_dwordx2 v80, v[98:99], s[66:67] offset:3072 sc1
  v_accvgpr_read_b32 v84, a112
  v_accvgpr_read_b32 v85, a113
  v_accvgpr_read_b32 v86, a114
  v_accvgpr_read_b32 v87, a115
  v_cvt_pk_bf16_f32 v100, v84, v85
  v_cvt_pk_bf16_f32 v101, v86, v87
  global_store_dwordx2 v80, v[100:101], s[66:67] offset:256 sc1
  v_accvgpr_read_b32 v88, a116
  v_accvgpr_read_b32 v89, a117
  v_accvgpr_read_b32 v90, a118
  v_accvgpr_read_b32 v91, a119
  v_cvt_pk_bf16_f32 v102, v88, v89
  v_cvt_pk_bf16_f32 v103, v90, v91
  global_store_dwordx2 v80, v[102:103], s[66:67] offset:1280 sc1
  v_accvgpr_read_b32 v84, a120
  v_accvgpr_read_b32 v85, a121
  v_accvgpr_read_b32 v86, a122
  v_accvgpr_read_b32 v87, a123
  v_cvt_pk_bf16_f32 v104, v84, v85
  v_cvt_pk_bf16_f32 v105, v86, v87
  global_store_dwordx2 v80, v[104:105], s[66:67] offset:2304 sc1
  v_accvgpr_read_b32 v88, a124
  v_accvgpr_read_b32 v89, a125
  v_accvgpr_read_b32 v90, a126
  v_accvgpr_read_b32 v91, a127
  v_cvt_pk_bf16_f32 v106, v88, v89
  v_cvt_pk_bf16_f32 v107, v90, v91
  global_store_dwordx2 v80, v[106:107], s[66:67] offset:3328 sc1
  s_waitcnt vmcnt(0)
  s_barrier
  s_cmp_lg_u32 s34, 0
  s_cbranch_scc1 S6
  s_add_u32 s39, s68, 0
  v_mov_b32 v2, s39
  v_mov_b32 v3, s69
  s_mov_b64 exec, 1
  global_atomic_add v2, v3, s[28:29] sc1
  s_mov_b64 exec, -1
S6:
  s_lshr_b32 s53, s51, 3
  s_lshl_b32 s39, s50, 2
  s_add_u32 s53, s53, s39
  s_and_b32 s54, s51, 7
  s_lshl_b32 s39, s53, 18
  s_and_b32 s41, s34, 3
  s_lshr_b32 s42, s34, 2
  v_mov_b32 v4, 0x3f803f80
  v_mov_b32 v5, 0x20000
  v_mov_b32 v6, 0
  ds_write_b32 v5, v6
  v_accvgpr_write_b32 a112, v4
  v_accvgpr_write_b32 a113, v4
  v_accvgpr_write_b32 a114, v4
  v_accvgpr_write_b32 a115, v4
  s_waitcnt lgkmcnt(0)
  s_cmp_lg_u32 s34, 0
  s_cbranch_scc1 S7
  v_mov_b32 v2, 40
  s_mov_b32 s38, 524288
W8:
  global_load_dword v3, v2, s[28:29] sc1
  s_waitcnt vmcnt(0)
  v_readfirstlane_b32 s39, v3
  s_cmp_ge_u32 s39, 160
  s_cbranch_scc1 WD9
  s_sleep 4
  s_sub_u32 s38, s38, 1
  s_cbranch_scc1 L_END
  s_branch W8
WD9:
S7:
  s_barrier
  s_lshl_b32 s43, s53, 2
  s_add_u32 s43, s43, s41
  s_lshl_b32 s43, s43, 16
  s_lshl_b32 s39, s54, 13
  s_add_u32 s43, s43, s39
  s_lshl_b32 s39, s42, 12
  s_add_u32 s43, s43, s39
  s_add_u32 s43, s43, 92274688
  v_lshl_add_u32 v2, v0, 4, s43
  global_load_dwordx4 a[64:67], v2, s[30:31] offset:0 sc1
  global_load_dwordx4 a[68:71], v2, s[30:31] offset:1024 sc1
  global_load_dwordx4 a[72:75], v2, s[30:31] offset:2048 sc1
  global_load_dwordx4 a[76:79], v2, s[30:31] offset:3072 sc1
  s_lshl_b32 s39, s34, 12
  v_lshl_add_u32 v2, v0, 4, s39
  v_lshlrev_b32 v3, 4, v0
  s_mov_b32 s45, s39
  s_add_u32 s56, s30, 71303168
  s_addc_u32 s57, s31, 0
  s_add_u32 s58, s30, 71434240
  s_addc_u32 s59, s31, 0
  s_mov_b32 m0, s45
  s_nop 0
  global_load_lds_dwordx4 v2, s[56:57] offset:0
  global_load_lds_dwordx4 v2, s[56:57] offset:1024
  global_load_lds_dwordx4 v2, s[56:57] offset:2048
  global_load_lds_dwordx4 v2, s[56:57] offset:3072
  s_add_u32 m0, m0, 0x8000
  s_nop 0
  global_load_lds_dwordx4 v2, s[58:59] offset:0
  global_load_lds_dwordx4 v2, s[58:59] offset:1024
  global_load_lds_dwordx4 v2, s[58:59] offset:2048
  global_load_lds_dwordx4 v2, s[58:59] offset:3072
  s_add_u32 s56, s56, 0x8000
  s_addc_u32 s57, s57, 0
  s_add_u32 s58, s58, 0x8000
  s_addc_u32 s59, s59, 0
  s_xor_b32 s45, s45, 0x10000
  s_mov_b32 m0, s45
  s_nop 0
  global_load_lds_dwordx4 v2, s[56:57] offset:0
  global_load_lds_dwordx4 v2, s[56:57] offset:1024
  global_load_lds_dwordx4 v2, s[56:57] offset:2048
  global_load_lds_dwordx4 v2, s[56:57] offset:3072
  s_add_u32 m0, m0, 0x8000
  s_nop 0
  global_load_lds_dwordx4 v2, s[58:59] offset:0
  global_load_lds_dwordx4 v2, s[58:59] offset:1024
  global_load_lds_dwordx4 v2, s[58:59] offset:2048
  global_load_lds_dwordx4 v2, s[58:59] offset:3072
  s_add_u32 s56, s56, 0x8000
  s_addc_u32 s57, s57, 0
  s_add_u32 s58, s58, 0x8000
  s_addc_u32 s59, s59, 0
  s_xor_b32 s45, s45, 0x10000
  v_accvgpr_write_b32 a0, 0
  v_accvgpr_write_b32 a1, 0
  v_accvgpr_write_b32 a2, 0
  v_accvgpr_write_b32 a3, 0
  v_accvgpr_write_b32 a4, 0
  v_accvgpr_write_b32 a5, 0
  v_accvgpr_write_b32 a6, 0
  v_accvgpr_write_b32 a7, 0
  v_accvgpr_write_b32 a8, 0
  v_accvgpr_write_b32 a9, 0
  v_accvgpr_write_b32 a10, 0
  v_accvgpr_write_b32 a11, 0
  v_accvgpr_write_b32 a12, 0
  v_accvgpr_write_b32 a13, 0
  v_accvgpr_write_b32 a14, 0
  v_accvgpr_write_b32 a15, 0
  v_accvgpr_write_b32 a16, 0
  v_accvgpr_write_b32 a17, 0
  v_accvgpr_write_b32 a18, 0
  v_accvgpr_write_b32 a19, 0
  v_accvgpr_write_b32 a20, 0
  v_accvgpr_write_b32 a21, 0
  v_accvgpr_write_b32 a22, 0
  v_accvgpr_write_b32 a23, 0
  v_accvgpr_write_b32 a24, 0
  v_accvgpr_write_b32 a25, 0
  v_accvgpr_write_b32 a26, 0
  v_accvgpr_write_b32 a27, 0
  v_accvgpr_write_b32 a28, 0
  v_accvgpr_write_b32 a29, 0
  v_accvgpr_write_b32 a30, 0
  v_accvgpr_write_b32 a31, 0
  v_accvgpr_write_b32 a32, 0
  v_accvgpr_write_b32 a33, 0
  v_accvgpr_write_b32 a34, 0
  v_accvgpr_write_b32 a35, 0
  v_accvgpr_write_b32 a36, 0
  v_accvgpr_write_b32 a37, 0
  v_accvgpr_write_b32 a38, 0
  v_accvgpr_write_b32 a39, 0
  v_accvgpr_write_b32 a40, 0
  v_accvgpr_write_b32 a41, 0
  v_accvgpr_write_b32 a42, 0
  v_accvgpr_write_b32 a43, 0
  v_accvgpr_write_b32 a44, 0
  v_accvgpr_write_b32 a45, 0
  v_accvgpr_write_b32 a46, 0
  v_accvgpr_write_b32 a47, 0
  v_accvgpr_write_b32 a48, 0
  v_accvgpr_write_b32 a49, 0
  v_accvgpr_write_b32 a50, 0
  v_accvgpr_write_b32 a51, 0
  v_accvgpr_write_b32 a52, 0
  v_accvgpr_write_b32 a53, 0
  v_accvgpr_write_b32 a54, 0
  v_accvgpr_write_b32 a55, 0
  v_accvgpr_write_b32 a56, 0
  v_accvgpr_write_b32 a57, 0
  v_accvgpr_write_b32 a58, 0
  v_accvgpr_write_b32 a59, 0
  v_accvgpr_write_b32 a60, 0
  v_accvgpr_write_b32 a61, 0
  v_accvgpr_write_b32 a62, 0
  v_accvgpr_write_b32 a63, 0
  s_waitcnt vmcnt(8)
  s_barrier
  ds_read_b128 a[80:83], v3 offset:0
  ds_read_b128 a[84:87], v3 offset:1024
  ds_read_b128 a[88:91], v3 offset:2048
  ds_read_b128 a[92:95], v3 offset:3072
  s_waitcnt lgkmcnt(0)
  v_mfma_f32_32x32x16_bf16 v[32:47], a[80:83], a[64:67], 0
  v_mfma_f32_32x32x16_bf16 v[32:47], a[84:87], a[68:71], v[32:47]
  v_mfma_f32_32x32x16_bf16 v[48:63], a[88:91], a[64:67], 0
  v_mfma_f32_32x32x16_bf16 v[48:63], a[92:95], a[68:71], v[48:63]
  v_mfma_f32_32x32x16_bf16 v[64:79], a[80:83], a[72:75], 0
  v_mfma_f32_32x32x16_bf16 v[64:79], a[84:87], a[76:79], v[64:79]
  v_mfma_f32_32x32x16_bf16 v[80:95], a[88:91], a[72:75], 0
  v_mfma_f32_32x32x16_bf16 v[80:95], a[92:95], a[76:79], v[80:95]
  s_nop 11
  v_max3_f32 v8, v32, v33, v34
  v_max3_f32 v8, v8, v35, v36
  v_max3_f32 v8, v8, v37, v38
  v_max3_f32 v8, v8, v39, v40
  v_max3_f32 v8, v8, v41, v42
  v_max3_f32 v8, v8, v43, v44
  v_max3_f32 v8, v8, v45, v46
  v_max3_f32 v8, v8, v47, v48
  v_max3_f32 v8, v8, v49, v50
  v_max3_f32 v8, v8, v51, v52
  v_max3_f32 v8, v8, v53, v54
  v_max3_f32 v8, v8, v55, v56
  v_max3_f32 v8, v8, v57, v58
  v_max3_f32 v8, v8, v59, v60
  v_max3_f32 v8, v8, v61, v62
  v_max_f32 v8, v8, v63
  v_mov_b32 v9, v8
  s_nop 1
  v_permlane32_swap_b32 v9, v8
  s_nop 1
  v_max_f32 v8, v8, v9
  v_sub_f32 v96, 0, v8
  v_sub_f32 v97, 0, v8
  v_sub_f32 v98, 0, v8
  v_sub_f32 v99, 0, v8
  v_sub_f32 v100, 0, v8
  v_sub_f32 v101, 0, v8
  v_sub_f32 v102, 0, v8
  v_sub_f32 v103, 0, v8
  v_sub_f32 v104, 0, v8
  v_sub_f32 v105, 0, v8
  v_sub_f32 v106, 0, v8
  v_sub_f32 v107, 0, v8
  v_sub_f32 v108, 0, v8
  v_sub_f32 v109, 0, v8
  v_sub_f32 v110, 0, v8
  v_sub_f32 v111, 0, v8
  v_max3_f32 v8, v64, v65, v66
  v_max3_f32 v8, v8, v67, v68
  v_max3_f32 v8, v8, v69, v70
  v_max3_f32 v8, v8, v71, v72
  v_max3_f32 v8, v8, v73, v74
  v_max3_f32 v8, v8, v75, v76
  v_max3_f32 v8, v8, v77, v78
  v_max3_f32 v8, v8, v79, v80
  v_max3_f32 v8, v8, v81, v82
  v_max3_f32 v8, v8, v83, v84
  v_max3_f32 v8, v8, v85, v86
  v_max3_f32 v8, v8, v87, v88
  v_max3_f32 v8, v8, v89, v90
  v_max3_f32 v8, v8, v91, v92
  v_max3_f32 v8, v8, v93, v94
  v_max_f32 v8, v8, v95
  v_mov_b32 v9, v8
  s_nop 1
  v_permlane32_swap_b32 v9, v8
  s_nop 1
  v_max_f32 v8, v8, v9
  v_sub_f32 v112, 0, v8
  v_sub_f32 v113, 0, v8
  v_sub_f32 v114, 0, v8
  v_sub_f32 v115, 0, v8
  v_sub_f32 v116, 0, v8
  v_sub_f32 v117, 0, v8
  v_sub_f32 v118, 0, v8
  v_sub_f32 v119, 0, v8
  v_sub_f32 v120, 0, v8
  v_sub_f32 v121, 0, v8
  v_sub_f32 v122, 0, v8
  v_sub_f32 v123, 0, v8
  v_sub_f32 v124, 0, v8
  v_sub_f32 v125, 0, v8
  v_sub_f32 v126, 0, v8
  v_sub_f32 v127, 0, v8
  v_mov_b32 v64, 0
  v_accvgpr_write_b32 a96, 0
  v_mov_b32 v65, 0
  v_accvgpr_write_b32 a97, 0
  v_mov_b32 v66, 0
  v_accvgpr_write_b32 a98, 0
  v_mov_b32 v67, 0
  v_accvgpr_write_b32 a99, 0
  v_mov_b32 v68, 0
  v_accvgpr_write_b32 a100, 0
  v_mov_b32 v69, 0
  v_accvgpr_write_b32 a101, 0
  v_mov_b32 v70, 0
  v_accvgpr_write_b32 a102, 0
  v_mov_b32 v71, 0
  v_accvgpr_write_b32 a103, 0
  v_mov_b32 v72, 0
  v_accvgpr_write_b32 a104, 0
  v_mov_b32 v73, 0
  v_accvgpr_write_b32 a105, 0
  v_mov_b32 v74, 0
  v_accvgpr_write_b32 a106, 0
  v_mov_b32 v75, 0
  v_accvgpr_write_b32 a107, 0
  v_mov_b32 v76, 0
  v_accvgpr_write_b32 a108, 0
  v_mov_b32 v77, 0
  v_accvgpr_write_b32 a109, 0
  v_mov_b32 v78, 0
  v_accvgpr_write_b32 a110, 0
  v_mov_b32 v79, 0
  v_accvgpr_write_b32 a111, 0
  v_mfma_f32_32x32x16_bf16 v[32:47], a[80:83], a[64:67], v[96:111]
  v_mfma_f32_32x32x16_bf16 v[48:63], a[88:91], a[64:67], v[96:111]
  v_mfma_f32_32x32x16_bf16 v[32:47], a[84:87], a[68:71], v[32:47]
  v_mfma_f32_32x32x16_bf16 v[48:63], a[92:95], a[68:71], v[48:63]
  s_mov_b32 s60, 0
  s_mov_b32 s61, 0
  s_mov_b32 s62, 0x41000000
  s_nop 9
L_BA_I0:
  v_exp_f32 v32, v32
  v_mfma_f32_32x32x16_bf16 a[48:63], a[96:99], v[64:67], a[48:63]
  v_exp_f32 v33, v33
  v_exp_f32 v34, v34
  v_exp_f32 v35, v35
  v_mfma_f32_32x32x16_bf16 a[16:31], a[112:115], v[64:67], a[16:31]
  v_exp_f32 v36, v36
  v_exp_f32 v37, v37
  v_exp_f32 v38, v38
  v_mfma_f32_32x32x16_bf16 a[48:63], a[100:103], v[68:71], a[48:63]
  v_exp_f32 v39, v39
  v_exp_f32 v40, v40
  v_exp_f32 v41, v41
  v_mfma_f32_32x32x16_bf16 a[16:31], a[112:115], v[68:71], a[16:31]
  v_exp_f32 v42, v42
  v_exp_f32 v43, v43
  v_exp_f32 v44, v44
  v_mfma_f32_32x32x16_bf16 a[48:63], a[104:107], v[72:75], a[48:63]
  v_exp_f32 v45, v45
  v_exp_f32 v46, v46
  v_exp_f32 v47, v47
  v_mfma_f32_32x32x16_bf16 a[16:31], a[112:115], v[72:75], a[16:31]
  v_exp_f32 v48, v48
  v_exp_f32 v49, v49
  v_exp_f32 v50, v50
  v_mfma_f32_32x32x16_bf16 a[48:63], a[108:111], v[76:79], a[48:63]
  v_exp_f32 v51, v51
  v_exp_f32 v52, v52
  v_exp_f32 v53, v53
  v_mfma_f32_32x32x16_bf16 a[16:31], a[112:115], v[76:79], a[16:31]
  v_exp_f32 v54, v54
  v_exp_f32 v55, v55
  v_exp_f32 v56, v56
  v_mfma_f32_32x32x16_bf16 v[64:79], a[80:83], a[72:75], v[112:127]
  v_exp_f32 v57, v57
  v_exp_f32 v58, v58
  v_exp_f32 v59, v59
  v_mfma_f32_32x32x16_bf16 v[80:95], a[88:91], a[72:75], v[112:127]
  ds_read_b128 a[96:99], v3 offset:32768
  ds_read_b128 a[100:103], v3 offset:33792
  ds_read_b128 a[104:107], v3 offset:34816
  ds_read_b128 a[108:111], v3 offset:35840
  v_add_u32 v3, 0x1000, v3
  v_exp_f32 v60, v60
  v_exp_f32 v61, v61
  v_exp_f32 v62, v62
  v_mfma_f32_32x32x16_bf16 v[64:79], a[84:87], a[76:79], v[64:79]
  v_exp_f32 v63, v63
  s_nop 0
  v_cvt_pk_bf16_f32 v32, v32, v33
  v_cvt_pk_bf16_f32 v33, v34, v35
  v_cvt_pk_bf16_f32 v34, v36, v37
  v_cvt_pk_bf16_f32 v35, v38, v39
  v_cvt_pk_bf16_f32 v36, v40, v41
  v_mfma_f32_32x32x16_bf16 v[80:95], a[92:95], a[76:79], v[80:95]
  v_cvt_pk_bf16_f32 v37, v42, v43
  v_cvt_pk_bf16_f32 v38, v44, v45
  v_cvt_pk_bf16_f32 v39, v46, v47
  v_cvt_pk_bf16_f32 v40, v48, v49
  v_cvt_pk_bf16_f32 v41, v50, v51
  v_cvt_pk_bf16_f32 v42, v52, v53
  v_cvt_pk_bf16_f32 v43, v54, v55
  v_cvt_pk_bf16_f32 v44, v56, v57
  v_cvt_pk_bf16_f32 v45, v58, v59
  v_cvt_pk_bf16_f32 v46, v60, v61
  v_cvt_pk_bf16_f32 v47, v62, v63
  s_cmp_eq_u32 s61, 7
  s_cbranch_scc1 L_BA_N0
L_BA_K0:
  ds_read_b128 a[80:83], v3 offset:0
  ds_read_b128 a[84:87], v3 offset:1024
  ds_read_b128 a[88:91], v3 offset:2048
  ds_read_b128 a[92:95], v3 offset:3072
L_BA_NK0:
  v_exp_f32 v64, v64
  s_waitcnt lgkmcnt(4)
  v_mfma_f32_32x32x16_bf16 a[32:47], a[96:99], v[32:35], a[32:47]
  v_exp_f32 v65, v65
  v_exp_f32 v66, v66
  v_exp_f32 v67, v67
  v_mfma_f32_32x32x16_bf16 a[0:15], a[112:115], v[32:35], a[0:15]
  v_exp_f32 v68, v68
  v_exp_f32 v69, v69
  v_exp_f32 v70, v70
  v_mfma_f32_32x32x16_bf16 a[32:47], a[100:103], v[36:39], a[32:47]
  v_exp_f32 v71, v71
  v_exp_f32 v72, v72
  v_exp_f32 v73, v73
  v_mfma_f32_32x32x16_bf16 a[0:15], a[112:115], v[36:39], a[0:15]
  v_exp_f32 v74, v74
  v_exp_f32 v75, v75
  v_exp_f32 v76, v76
  v_mfma_f32_32x32x16_bf16 a[32:47], a[104:107], v[40:43], a[32:47]
  v_exp_f32 v77, v77
  v_exp_f32 v78, v78
  v_exp_f32 v79, v79
  v_mfma_f32_32x32x16_bf16 a[0:15], a[112:115], v[40:43], a[0:15]
  v_exp_f32 v80, v80
  v_exp_f32 v81, v81
  v_exp_f32 v82, v82
  v_mfma_f32_32x32x16_bf16 a[32:47], a[108:111], v[44:47], a[32:47]
  v_exp_f32 v83, v83
  v_exp_f32 v84, v84
  v_exp_f32 v85, v85
  v_mfma_f32_32x32x16_bf16 a[0:15], a[112:115], v[44:47], a[0:15]
  v_exp_f32 v86, v86
  v_exp_f32 v87, v87
  v_exp_f32 v88, v88
  s_waitcnt lgkmcnt(0)
  v_mfma_f32_32x32x16_bf16 v[32:47], a[80:83], a[64:67], v[96:111]
  v_exp_f32 v89, v89
  v_exp_f32 v90, v90
  v_exp_f32 v91, v91
  v_mfma_f32_32x32x16_bf16 v[48:63], a[88:91], a[64:67], v[96:111]
  v_exp_f32 v92, v92
  v_exp_f32 v93, v93
  v_exp_f32 v94, v94
  v_mfma_f32_32x32x16_bf16 v[32:47], a[84:87], a[68:71], v[32:47]
  v_exp_f32 v95, v95
  s_nop 0
  v_cvt_pk_bf16_f32 v64, v64, v65
  v_cvt_pk_bf16_f32 v65, v66, v67
  v_cvt_pk_bf16_f32 v66, v68, v69
  v_cvt_pk_bf16_f32 v67, v70, v71
  v_cvt_pk_bf16_f32 v68, v72, v73
  v_mfma_f32_32x32x16_bf16 v[48:63], a[92:95], a[68:71], v[48:63]
  v_cvt_pk_bf16_f32 v69, v74, v75
  v_cvt_pk_bf16_f32 v70, v76, v77
  v_cvt_pk_bf16_f32 v71, v78, v79
  v_cvt_pk_bf16_f32 v72, v80, v81
  v_cvt_pk_bf16_f32 v73, v82, v83
  v_cvt_pk_bf16_f32 v74, v84, v85
  v_cvt_pk_bf16_f32 v75, v86, v87
  v_cvt_pk_bf16_f32 v76, v88, v89
  v_cvt_pk_bf16_f32 v77, v90, v91
  v_cvt_pk_bf16_f32 v78, v92, v93
  v_cvt_pk_bf16_f32 v79, v94, v95
  s_add_u32 s61, s61, 1
  s_cmp_lt_u32 s60, 4
  s_cbranch_scc1 L_BA_I0
  s_nop 1
  v_mfma_f32_32x32x16_bf16 a[48:63], a[96:99], v[64:67], a[48:63]
  v_mfma_f32_32x32x16_bf16 a[16:31], a[112:115], v[64:67], a[16:31]
  v_mfma_f32_32x32x16_bf16 a[48:63], a[100:103], v[68:71], a[48:63]
  v_mfma_f32_32x32x16_bf16 a[16:31], a[112:115], v[68:71], a[16:31]
  v_mfma_f32_32x32x16_bf16 a[48:63], a[104:107], v[72:75], a[48:63]
  v_mfma_f32_32x32x16_bf16 a[16:31], a[112:115], v[72:75], a[16:31]
  v_mfma_f32_32x32x16_bf16 a[48:63], a[108:111], v[76:79], a[48:63]
  v_mfma_f32_32x32x16_bf16 a[16:31], a[112:115], v[76:79], a[16:31]
  s_nop 15
  s_branch L_BA_X0
L_BA_N0:
  s_mov_b32 s61, -1
  s_add_u32 s60, s60, 1
  s_waitcnt lgkmcnt(0)
  s_cmp_eq_u32 s60, 4
  s_cbranch_scc1 L_BA_NK0
  s_waitcnt vmcnt(0)
  s_barrier
  v_add_u32 v3, 0x8000, v3
  v_and_b32 v3, 0x1ffff, v3
  s_cmp_eq_u32 s60, 3
  s_cbranch_scc1 L_BA_K0
  s_mov_b32 m0, s45
  s_nop 0
  global_load_lds_dwordx4 v2, s[56:57] offset:0
  global_load_lds_dwordx4 v2, s[56:57] offset:1024
  global_load_lds_dwordx4 v2, s[56:57] offset:2048
  global_load_lds_dwordx4 v2, s[56:57] offset:3072
  s_add_u32 m0, m0, 0x8000
  s_nop 0
  global_load_lds_dwordx4 v2, s[58:59] offset:0
  global_load_lds_dwordx4 v2, s[58:59] offset:1024
  global_load_lds_dwordx4 v2, s[58:59] offset:2048
  global_load_lds_dwordx4 v2, s[58:59] offset:3072
  s_add_u32 s56, s56, 0x8000
  s_addc_u32 s57, s57, 0
  s_add_u32 s58, s58, 0x8000
  s_addc_u32 s59, s59, 0
  s_xor_b32 s45, s45, 0x10000
  s_branch L_BA_K0
L_BA_X0:
  v_accvgpr_read_b32 v4, a0
  v_accvgpr_read_b32 v6, a16
  s_mov_b32 s39, 0x49000000
  v_cmp_nge_f32 vcc, s39, v4
  v_cmp_nge_f32 s[42:43], s39, v6
  v_mov_b32 v5, 0x20000
  s_or_b64 vcc, vcc, s[42:43]
  s_lshr_b32 s42, s34, 2
  s_cbranch_vccz L_BA_V
  v_mov_b32 v7, 1
  ds_write_b32 v5, v7
  s_waitcnt lgkmcnt(0)
L_BA_V:
  s_barrier
  ds_read_b32 v7, v5
  s_waitcnt lgkmcnt(0)
  v_readfirstlane_b32 s39, v7
  s_cmp_eq_u32 s39, 0
  s_cbranch_scc1 L_BA_E
  s_lshl_b32 s39, s34, 12
  v_lshl_add_u32 v2, v0, 4, s39
  v_lshlrev_b32 v3, 4, v0
  s_mov_b32 s45, s39
  s_add_u32 s56, s30, 71303168
  s_addc_u32 s57, s31, 0
  s_add_u32 s58, s30, 71434240
  s_addc_u32 s59, s31, 0
  s_mov_b32 m0, s45
  s_nop 0
  global_load_lds_dwordx4 v2, s[56:57] offset:0
  global_load_lds_dwordx4 v2, s[56:57] offset:1024
  global_load_lds_dwordx4 v2, s[56:57] offset:2048
  global_load_lds_dwordx4 v2, s[56:57] offset:3072
  s_add_u32 m0, m0, 0x8000
  s_nop 0
  global_load_lds_dwordx4 v2, s[58:59] offset:0
  global_load_lds_dwordx4 v2, s[58:59] offset:1024
  global_load_lds_dwordx4 v2, s[58:59] offset:2048
  global_load_lds_dwordx4 v2, s[58:59] offset:3072
  s_add_u32 s56, s56, 0x8000
  s_addc_u32 s57, s57, 0
  s_add_u32 s58, s58, 0x8000
  s_addc_u32 s59, s59, 0
  s_xor_b32 s45, s45, 0x10000
  s_mov_b32 m0, s45
  s_nop 0
  global_load_lds_dwordx4 v2, s[56:57] offset:0
  global_load_lds_dwordx4 v2, s[56:57] offset:1024
  global_load_lds_dwordx4 v2, s[56:57] offset:2048
  global_load_lds_dwordx4 v2, s[56:57] offset:3072
  s_add_u32 m0, m0, 0x8000
  s_nop 0
  global_load_lds_dwordx4 v2, s[58:59] offset:0
  global_load_lds_dwordx4 v2, s[58:59] offset:1024
  global_load_lds_dwordx4 v2, s[58:59] offset:2048
  global_load_lds_dwordx4 v2, s[58:59] offset:3072
  s_add_u32 s56, s56, 0x8000
  s_addc_u32 s57, s57, 0
  s_add_u32 s58, s58, 0x8000
  s_addc_u32 s59, s59, 0
  s_xor_b32 s45, s45, 0x10000
  v_accvgpr_write_b32 a0, 0
  v_accvgpr_write_b32 a1, 0
  v_accvgpr_write_b32 a2, 0
  v_accvgpr_write_b32 a3, 0
  v_accvgpr_write_b32 a4, 0
  v_accvgpr_write_b32 a5, 0
  v_accvgpr_write_b32 a6, 0
  v_accvgpr_write_b32 a7, 0
  v_accvgpr_write_b32 a8, 0
  v_accvgpr_write_b32 a9, 0
  v_accvgpr_write_b32 a10, 0
  v_accvgpr_write_b32 a11, 0
  v_accvgpr_write_b32 a12, 0
  v_accvgpr_write_b32 a13, 0
  v_accvgpr_write_b32 a14, 0
  v_accvgpr_write_b32 a15, 0
  v_accvgpr_write_b32 a16, 0
  v_accvgpr_write_b32 a17, 0
  v_accvgpr_write_b32 a18, 0
  v_accvgpr_write_b32 a19, 0
  v_accvgpr_write_b32 a20, 0
  v_accvgpr_write_b32 a21, 0
  v_accvgpr_write_b32 a22, 0
  v_accvgpr_write_b32 a23, 0
  v_accvgpr_write_b32 a24, 0
  v_accvgpr_write_b32 a25, 0
  v_accvgpr_write_b32 a26, 0
  v_accvgpr_write_b32 a27, 0
  v_accvgpr_write_b32 a28, 0
  v_accvgpr_write_b32 a29, 0
  v_accvgpr_write_b32 a30, 0
  v_accvgpr_write_b32 a31, 0
  v_accvgpr_write_b32 a32, 0
  v_accvgpr_write_b32 a33, 0
  v_accvgpr_write_b32 a34, 0
  v_accvgpr_write_b32 a35, 0
  v_accvgpr_write_b32 a36, 0
  v_accvgpr_write_b32 a37, 0
  v_accvgpr_write_b32 a38, 0
  v_accvgpr_write_b32 a39, 0
  v_accvgpr_write_b32 a40, 0
  v_accvgpr_write_b32 a41, 0
  v_accvgpr_write_b32 a42, 0
  v_accvgpr_write_b32 a43, 0
  v_accvgpr_write_b32 a44, 0
  v_accvgpr_write_b32 a45, 0
  v_accvgpr_write_b32 a46, 0
  v_accvgpr_write_b32 a47, 0
  v_accvgpr_write_b32 a48, 0
  v_accvgpr_write_b32 a49, 0
  v_accvgpr_write_b32 a50, 0
  v_accvgpr_write_b32 a51, 0
  v_accvgpr_write_b32 a52, 0
  v_accvgpr_write_b32 a53, 0
  v_accvgpr_write_b32 a54, 0
  v_accvgpr_write_b32 a55, 0
  v_accvgpr_write_b32 a56, 0
  v_accvgpr_write_b32 a57, 0
  v_accvgpr_write_b32 a58, 0
  v_accvgpr_write_b32 a59, 0
  v_accvgpr_write_b32 a60, 0
  v_accvgpr_write_b32 a61, 0
  v_accvgpr_write_b32 a62, 0
  v_accvgpr_write_b32 a63, 0
  s_waitcnt vmcnt(8)
  s_barrier
  ds_read_b128 a[80:83], v3 offset:0
  ds_read_b128 a[84:87], v3 offset:1024
  ds_read_b128 a[88:91], v3 offset:2048
  ds_read_b128 a[92:95], v3 offset:3072
  s_waitcnt lgkmcnt(0)
  v_mfma_f32_32x32x16_bf16 v[32:47], a[80:83], a[64:67], 0
  v_mfma_f32_32x32x16_bf16 v[32:47], a[84:87], a[68:71], v[32:47]
  v_mfma_f32_32x32x16_bf16 v[48:63], a[88:91], a[64:67], 0
  v_mfma_f32_32x32x16_bf16 v[48:63], a[92:95], a[68:71], v[48:63]
  v_mfma_f32_32x32x16_bf16 v[64:79], a[80:83], a[72:75], 0
  v_mfma_f32_32x32x16_bf16 v[64:79], a[84:87], a[76:79], v[64:79]
  v_mfma_f32_32x32x16_bf16 v[80:95], a[88:91], a[72:75], 0
  v_mfma_f32_32x32x16_bf16 v[80:95], a[92:95], a[76:79], v[80:95]
  s_nop 11
  v_max3_f32 v8, v32, v33, v34
  v_max3_f32 v8, v8, v35, v36
  v_max3_f32 v8, v8, v37, v38
  v_max3_f32 v8, v8, v39, v40
  v_max3_f32 v8, v8, v41, v42
  v_max3_f32 v8, v8, v43, v44
  v_max3_f32 v8, v8, v45, v46
  v_max3_f32 v8, v8, v47, v48
  v_max3_f32 v8, v8, v49, v50
  v_max3_f32 v8, v8, v51, v52
  v_max3_f32 v8, v8, v53, v54
  v_max3_f32 v8, v8, v55, v56
  v_max3_f32 v8, v8, v57, v58
  v_max3_f32 v8, v8, v59, v60
  v_max3_f32 v8, v8, v61, v62
  v_max_f32 v8, v8, v63
  v_mov_b32 v9, v8
  s_nop 1
  v_permlane32_swap_b32 v9, v8
  s_nop 1
  v_max_f32 v8, v8, v9
  v_sub_f32 v96, 0, v8
  v_sub_f32 v97, 0, v8
  v_sub_f32 v98, 0, v8
  v_sub_f32 v99, 0, v8
  v_sub_f32 v100, 0, v8
  v_sub_f32 v101, 0, v8
  v_sub_f32 v102, 0, v8
  v_sub_f32 v103, 0, v8
  v_sub_f32 v104, 0, v8
  v_sub_f32 v105, 0, v8
  v_sub_f32 v106, 0, v8
  v_sub_f32 v107, 0, v8
  v_sub_f32 v108, 0, v8
  v_sub_f32 v109, 0, v8
  v_sub_f32 v110, 0, v8
  v_sub_f32 v111, 0, v8
  v_max3_f32 v8, v64, v65, v66
  v_max3_f32 v8, v8, v67, v68
  v_max3_f32 v8, v8, v69, v70
  v_max3_f32 v8, v8, v71, v72
  v_max3_f32 v8, v8, v73, v74
  v_max3_f32 v8, v8, v75, v76
  v_max3_f32 v8, v8, v77, v78
  v_max3_f32 v8, v8, v79, v80
  v_max3_f32 v8, v8, v81, v82
  v_max3_f32 v8, v8, v83, v84
  v_max3_f32 v8, v8, v85, v86
  v_max3_f32 v8, v8, v87, v88
  v_max3_f32 v8, v8, v89, v90
  v_max3_f32 v8, v8, v91, v92
  v_max3_f32 v8, v8, v93, v94
  v_max_f32 v8, v8, v95
  v_mov_b32 v9, v8
  s_nop 1
  v_permlane32_swap_b32 v9, v8
  s_nop 1
  v_max_f32 v8, v8, v9
  v_sub_f32 v112, 0, v8
  v_sub_f32 v113, 0, v8
  v_sub_f32 v114, 0, v8
  v_sub_f32 v115, 0, v8
  v_sub_f32 v116, 0, v8
  v_sub_f32 v117, 0, v8
  v_sub_f32 v118, 0, v8
  v_sub_f32 v119, 0, v8
  v_sub_f32 v120, 0, v8
  v_sub_f32 v121, 0, v8
  v_sub_f32 v122, 0, v8
  v_sub_f32 v123, 0, v8
  v_sub_f32 v124, 0, v8
  v_sub_f32 v125, 0, v8
  v_sub_f32 v126, 0, v8
  v_sub_f32 v127, 0, v8
  v_mov_b32 v64, 0
  v_accvgpr_write_b32 a96, 0
  v_mov_b32 v65, 0
  v_accvgpr_write_b32 a97, 0
  v_mov_b32 v66, 0
  v_accvgpr_write_b32 a98, 0
  v_mov_b32 v67, 0
  v_accvgpr_write_b32 a99, 0
  v_mov_b32 v68, 0
  v_accvgpr_write_b32 a100, 0
  v_mov_b32 v69, 0
  v_accvgpr_write_b32 a101, 0
  v_mov_b32 v70, 0
  v_accvgpr_write_b32 a102, 0
  v_mov_b32 v71, 0
  v_accvgpr_write_b32 a103, 0
  v_mov_b32 v72, 0
  v_accvgpr_write_b32 a104, 0
  v_mov_b32 v73, 0
  v_accvgpr_write_b32 a105, 0
  v_mov_b32 v74, 0
  v_accvgpr_write_b32 a106, 0
  v_mov_b32 v75, 0
  v_accvgpr_write_b32 a107, 0
  v_mov_b32 v76, 0
  v_accvgpr_write_b32 a108, 0
  v_mov_b32 v77, 0
  v_accvgpr_write_b32 a109, 0
  v_mov_b32 v78, 0
  v_accvgpr_write_b32 a110, 0
  v_mov_b32 v79, 0
  v_accvgpr_write_b32 a111, 0
  v_mfma_f32_32x32x16_bf16 v[32:47], a[80:83], a[64:67], v[96:111]
  v_mfma_f32_32x32x16_bf16 v[48:63], a[88:91], a[64:67], v[96:111]
  v_mfma_f32_32x32x16_bf16 v[32:47], a[84:87], a[68:71], v[32:47]
  v_mfma_f32_32x32x16_bf16 v[48:63], a[92:95], a[68:71], v[48:63]
  s_mov_b32 s60, 0
  s_mov_b32 s61, 0
  s_mov_b32 s62, 0x41000000
  s_nop 9
L_BA_I1:
  v_max3_f32 v8, v32, v33, v34
  v_max3_f32 v8, v8, v35, v36
  v_max3_f32 v8, v8, v37, v38
  v_max3_f32 v8, v8, v39, v40
  v_max3_f32 v8, v8, v41, v42
  v_max3_f32 v8, v8, v43, v44
  v_max3_f32 v8, v8, v45, v46
  v_max3_f32 v8, v8, v47, v48
  v_max3_f32 v8, v8, v49, v50
  v_max3_f32 v8, v8, v51, v52
  v_max3_f32 v8, v8, v53, v54
  v_max3_f32 v8, v8, v55, v56
  v_max3_f32 v8, v8, v57, v58
  v_max3_f32 v8, v8, v59, v60
  v_max3_f32 v8, v8, v61, v62
  v_max_f32 v8, v8, v63
  v_cmp_lt_f32 vcc, s62, v8
  s_nop 1
  s_cbranch_vccnz L_BA_R0
L_BA_B0:
  v_exp_f32 v32, v32
  v_mfma_f32_32x32x16_bf16 a[48:63], a[96:99], v[64:67], a[48:63]
  v_exp_f32 v33, v33
  v_exp_f32 v34, v34
  v_exp_f32 v35, v35
  v_mfma_f32_32x32x16_bf16 a[16:31], a[112:115], v[64:67], a[16:31]
  v_exp_f32 v36, v36
  v_exp_f32 v37, v37
  v_exp_f32 v38, v38
  v_mfma_f32_32x32x16_bf16 a[48:63], a[100:103], v[68:71], a[48:63]
  v_exp_f32 v39, v39
  v_exp_f32 v40, v40
  v_exp_f32 v41, v41
  v_mfma_f32_32x32x16_bf16 a[16:31], a[112:115], v[68:71], a[16:31]
  v_exp_f32 v42, v42
  v_exp_f32 v43, v43
  v_exp_f32 v44, v44
  v_mfma_f32_32x32x16_bf16 a[48:63], a[104:107], v[72:75], a[48:63]
  v_exp_f32 v45, v45
  v_exp_f32 v46, v46
  v_exp_f32 v47, v47
  v_mfma_f32_32x32x16_bf16 a[16:31], a[112:115], v[72:75], a[16:31]
  v_exp_f32 v48, v48
  v_exp_f32 v49, v49
  v_exp_f32 v50, v50
  v_mfma_f32_32x32x16_bf16 a[48:63], a[108:111], v[76:79], a[48:63]
  v_exp_f32 v51, v51
  v_exp_f32 v52, v52
  v_exp_f32 v53, v53
  v_mfma_f32_32x32x16_bf16 a[16:31], a[112:115], v[76:79], a[16:31]
  v_exp_f32 v54, v54
  v_exp_f32 v55, v55
  v_exp_f32 v56, v56
  v_mfma_f32_32x32x16_bf16 v[64:79], a[80:83], a[72:75], v[112:127]
  v_exp_f32 v57, v57
  v_exp_f32 v58, v58
  v_exp_f32 v59, v59
  v_mfma_f32_32x32x16_bf16 v[80:95], a[88:91], a[72:75], v[112:127]
  ds_read_b128 a[96:99], v3 offset:32768
  ds_read_b128 a[100:103], v3 offset:33792
  ds_read_b128 a[104:107], v3 offset:34816
  ds_read_b128 a[108:111], v3 offset:35840
  v_add_u32 v3, 0x1000, v3
  v_exp_f32 v60, v60
  v_exp_f32 v61, v61
  v_exp_f32 v62, v62
  v_mfma_f32_32x32x16_bf16 v[64:79], a[84:87], a[76:79], v[64:79]
  v_exp_f32 v63, v63
  s_nop 0
  v_cvt_pk_bf16_f32 v32, v32, v33
  v_cvt_pk_bf16_f32 v33, v34, v35
  v_cvt_pk_bf16_f32 v34, v36, v37
  v_cvt_pk_bf16_f32 v35, v38, v39
  v_cvt_pk_bf16_f32 v36, v40, v41
  v_mfma_f32_32x32x16_bf16 v[80:95], a[92:95], a[76:79], v[80:95]
  v_cvt_pk_bf16_f32 v37, v42, v43
  v_cvt_pk_bf16_f32 v38, v44, v45
  v_cvt_pk_bf16_f32 v39, v46, v47
  v_cvt_pk_bf16_f32 v40, v48, v49
  v_cvt_pk_bf16_f32 v41, v50, v51
  v_cvt_pk_bf16_f32 v42, v52, v53
  v_cvt_pk_bf16_f32 v43, v54, v55
  v_cvt_pk_bf16_f32 v44, v56, v57
  v_cvt_pk_bf16_f32 v45, v58, v59
  v_cvt_pk_bf16_f32 v46, v60, v61
  v_cvt_pk_bf16_f32 v47, v62, v63
  s_cmp_eq_u32 s61, 7
  s_cbranch_scc1 L_BA_N1
L_BA_K1:
  ds_read_b128 a[80:83], v3 offset:0
  ds_read_b128 a[84:87], v3 offset:1024
  ds_read_b128 a[88:91], v3 offset:2048
  ds_read_b128 a[92:95], v3 offset:3072
L_BA_NK1:
  v_max3_f32 v8, v64, v65, v66
  v_max3_f32 v8, v8, v67, v68
  v_max3_f32 v8, v8, v69, v70
  v_max3_f32 v8, v8, v71, v72
  v_max3_f32 v8, v8, v73, v74
  v_max3_f32 v8, v8, v75, v76
  v_max3_f32 v8, v8, v77, v78
  v_max3_f32 v8, v8, v79, v80
  v_max3_f32 v8, v8, v81, v82
  v_max3_f32 v8, v8, v83, v84
  v_max3_f32 v8, v8, v85, v86
  v_max3_f32 v8, v8, v87, v88
  v_max3_f32 v8, v8, v89, v90
  v_max3_f32 v8, v8, v91, v92
  v_max3_f32 v8, v8, v93, v94
  v_max_f32 v8, v8, v95
  v_cmp_lt_f32 vcc, s62, v8
  s_nop 1
  s_cbranch_vccnz L_BA_R1
L_BA_B1:
  v_exp_f32 v64, v64
  s_waitcnt lgkmcnt(4)
  v_mfma_f32_32x32x16_bf16 a[32:47], a[96:99], v[32:35], a[32:47]
  v_exp_f32 v65, v65
  v_exp_f32 v66, v66
  v_exp_f32 v67, v67
  v_mfma_f32_32x32x16_bf16 a[0:15], a[112:115], v[32:35], a[0:15]
  v_exp_f32 v68, v68
  v_exp_f32 v69, v69
  v_exp_f32 v70, v70
  v_mfma_f32_32x32x16_bf16 a[32:47], a[100:103], v[36:39], a[32:47]
  v_exp_f32 v71, v71
  v_exp_f32 v72, v72
  v_exp_f32 v73, v73
  v_mfma_f32_32x32x16_bf16 a[0:15], a[112:115], v[36:39], a[0:15]
  v_exp_f32 v74, v74
  v_exp_f32 v75, v75
  v_exp_f32 v76, v76
  v_mfma_f32_32x32x16_bf16 a[32:47], a[104:107], v[40:43], a[32:47]
  v_exp_f32 v77, v77
  v_exp_f32 v78, v78
  v_exp_f32 v79, v79
  v_mfma_f32_32x32x16_bf16 a[0:15], a[112:115], v[40:43], a[0:15]
  v_exp_f32 v80, v80
  v_exp_f32 v81, v81
  v_exp_f32 v82, v82
  v_mfma_f32_32x32x16_bf16 a[32:47], a[108:111], v[44:47], a[32:47]
  v_exp_f32 v83, v83
  v_exp_f32 v84, v84
  v_exp_f32 v85, v85
  v_mfma_f32_32x32x16_bf16 a[0:15], a[112:115], v[44:47], a[0:15]
  v_exp_f32 v86, v86
  v_exp_f32 v87, v87
  v_exp_f32 v88, v88
  s_waitcnt lgkmcnt(0)
  v_mfma_f32_32x32x16_bf16 v[32:47], a[80:83], a[64:67], v[96:111]
  v_exp_f32 v89, v89
  v_exp_f32 v90, v90
  v_exp_f32 v91, v91
  v_mfma_f32_32x32x16_bf16 v[48:63], a[88:91], a[64:67], v[96:111]
  v_exp_f32 v92, v92
  v_exp_f32 v93, v93
  v_exp_f32 v94, v94
  v_mfma_f32_32x32x16_bf16 v[32:47], a[84:87], a[68:71], v[32:47]
  v_exp_f32 v95, v95
  s_nop 0
  v_cvt_pk_bf16_f32 v64, v64, v65
  v_cvt_pk_bf16_f32 v65, v66, v67
  v_cvt_pk_bf16_f32 v66, v68, v69
  v_cvt_pk_bf16_f32 v67, v70, v71
  v_cvt_pk_bf16_f32 v68, v72, v73
  v_mfma_f32_32x32x16_bf16 v[48:63], a[92:95], a[68:71], v[48:63]
  v_cvt_pk_bf16_f32 v69, v74, v75
  v_cvt_pk_bf16_f32 v70, v76, v77
  v_cvt_pk_bf16_f32 v71, v78, v79
  v_cvt_pk_bf16_f32 v72, v80, v81
  v_cvt_pk_bf16_f32 v73, v82, v83
  v_cvt_pk_bf16_f32 v74, v84, v85
  v_cvt_pk_bf16_f32 v75, v86, v87
  v_cvt_pk_bf16_f32 v76, v88, v89
  v_cvt_pk_bf16_f32 v77, v90, v91
  v_cvt_pk_bf16_f32 v78, v92, v93
  v_cvt_pk_bf16_f32 v79, v94, v95
  s_add_u32 s61, s61, 1
  s_cmp_lt_u32 s60, 4
  s_cbranch_scc1 L_BA_I1
  s_nop 1
  v_mfma_f32_32x32x16_bf16 a[48:63], a[96:99], v[64:67], a[48:63]
  v_mfma_f32_32x32x16_bf16 a[16:31], a[112:115], v[64:67], a[16:31]
  v_mfma_f32_32x32x16_bf16 a[48:63], a[100:103], v[68:71], a[48:63]
  v_mfma_f32_32x32x16_bf16 a[16:31], a[112:115], v[68:71], a[16:31]
  v_mfma_f32_32x32x16_bf16 a[48:63], a[104:107], v[72:75], a[48:63]
  v_mfma_f32_32x32x16_bf16 a[16:31], a[112:115], v[72:75], a[16:31]
  v_mfma_f32_32x32x16_bf16 a[48:63], a[108:111], v[76:79], a[48:63]
  v_mfma_f32_32x32x16_bf16 a[16:31], a[112:115], v[76:79], a[16:31]
  s_nop 15
  s_branch L_BA_X1
L_BA_N1:
  s_mov_b32 s61, -1
  s_add_u32 s60, s60, 1
  s_waitcnt lgkmcnt(0)
  s_cmp_eq_u32 s60, 4
  s_cbranch_scc1 L_BA_NK1
  s_waitcnt vmcnt(0)
  s_barrier
  v_add_u32 v3, 0x8000, v3
  v_and_b32 v3, 0x1ffff, v3
  s_cmp_eq_u32 s60, 3
  s_cbranch_scc1 L_BA_K1
  s_mov_b32 m0, s45
  s_nop 0
  global_load_lds_dwordx4 v2, s[56:57] offset:0
  global_load_lds_dwordx4 v2, s[56:57] offset:1024
  global_load_lds_dwordx4 v2, s[56:57] offset:2048
  global_load_lds_dwordx4 v2, s[56:57] offset:3072
  s_add_u32 m0, m0, 0x8000
  s_nop 0
  global_load_lds_dwordx4 v2, s[58:59] offset:0
  global_load_lds_dwordx4 v2, s[58:59] offset:1024
  global_load_lds_dwordx4 v2, s[58:59] offset:2048
  global_load_lds_dwordx4 v2, s[58:59] offset:3072
  s_add_u32 s56, s56, 0x8000
  s_addc_u32 s57, s57, 0
  s_add_u32 s58, s58, 0x8000
  s_addc_u32 s59, s59, 0
  s_xor_b32 s45, s45, 0x10000
  s_branch L_BA_K1
L_BA_R0:
  v_mov_b32 v9, v8
  s_nop 1
  v_permlane32_swap_b32 v9, v8
  s_nop 1
  v_max_f32 v8, v8, v9
  v_max_f32 v8, 0, v8
  v_sub_f32 v9, 0, v8
  v_exp_f32 v9, v9
  v_sub_f32 v32, v32, v8
  v_sub_f32 v33, v33, v8
  v_sub_f32 v34, v34, v8
  v_sub_f32 v35, v35, v8
  v_sub_f32 v36, v36, v8
  v_sub_f32 v37, v37, v8
  v_sub_f32 v38, v38, v8
  v_sub_f32 v39, v39, v8
  v_sub_f32 v40, v40, v8
  v_sub_f32 v41, v41, v8
  v_sub_f32 v42, v42, v8
  v_sub_f32 v43, v43, v8
  v_sub_f32 v44, v44, v8
  v_sub_f32 v45, v45, v8
  v_sub_f32 v46, v46, v8
  v_sub_f32 v47, v47, v8
  v_sub_f32 v48, v48, v8
  v_sub_f32 v49, v49, v8
  v_sub_f32 v50, v50, v8
  v_sub_f32 v51, v51, v8
  v_sub_f32 v52, v52, v8
  v_sub_f32 v53, v53, v8
  v_sub_f32 v54, v54, v8
  v_sub_f32 v55, v55, v8
  v_sub_f32 v56, v56, v8
  v_sub_f32 v57, v57, v8
  v_sub_f32 v58, v58, v8
  v_sub_f32 v59, v59, v8
  v_sub_f32 v60, v60, v8
  v_sub_f32 v61, v61, v8
  v_sub_f32 v62, v62, v8
  v_sub_f32 v63, v63, v8
  s_nop 15
  v_sub_f32 v96, v96, v8
  v_sub_f32 v97, v97, v8
  v_sub_f32 v98, v98, v8
  v_sub_f32 v99, v99, v8
  v_sub_f32 v100, v100, v8
  v_sub_f32 v101, v101, v8
  v_sub_f32 v102, v102, v8
  v_sub_f32 v103, v103, v8
  v_sub_f32 v104, v104, v8
  v_sub_f32 v105, v105, v8
  v_sub_f32 v106, v106, v8
  v_sub_f32 v107, v107, v8
  v_sub_f32 v108, v108, v8
  v_sub_f32 v109, v109, v8
  v_sub_f32 v110, v110, v8
  v_sub_f32 v111, v111, v8
  v_accvgpr_read_b32 v10, a0
  v_mul_f32 v10, v10, v9
  v_accvgpr_write_b32 a0, v10
  v_accvgpr_read_b32 v10, a32
  v_mul_f32 v10, v10, v9
  v_accvgpr_write_b32 a32, v10
  v_accvgpr_read_b32 v10, a33
  v_mul_f32 v10, v10, v9
  v_accvgpr_write_b32 a33, v10
  v_accvgpr_read_b32 v10, a34
  v_mul_f32 v10, v10, v9
  v_accvgpr_write_b32 a34, v10
  v_accvgpr_read_b32 v10, a35
  v_mul_f32 v10, v10, v9
  v_accvgpr_write_b32 a35, v10
  v_accvgpr_read_b32 v10, a36
  v_mul_f32 v10, v10, v9
  v_accvgpr_write_b32 a36, v10
  v_accvgpr_read_b32 v10, a37
  v_mul_f32 v10, v10, v9
  v_accvgpr_write_b32 a37, v10
  v_accvgpr_read_b32 v10, a38
  v_mul_f32 v10, v10, v9
  v_accvgpr_write_b32 a38, v10
  v_accvgpr_read_b32 v10, a39
  v_mul_f32 v10, v10, v9
  v_accvgpr_write_b32 a39, v10
  v_accvgpr_read_b32 v10, a40
  v_mul_f32 v10, v10, v9
  v_accvgpr_write_b32 a40, v10
  v_accvgpr_read_b32 v10, a41
  v_mul_f32 v10, v10, v9
  v_accvgpr_write_b32 a41, v10
  v_accvgpr_read_b32 v10, a42
  v_mul_f32 v10, v10, v9
  v_accvgpr_write_b32 a42, v10
  v_accvgpr_read_b32 v10, a43
  v_mul_f32 v10, v10, v9
  v_accvgpr_write_b32 a43, v10
  v_accvgpr_read_b32 v10, a44
  v_mul_f32 v10, v10, v9
  v_accvgpr_write_b32 a44, v10
  v_accvgpr_read_b32 v10, a45
  v_mul_f32 v10, v10, v9
  v_accvgpr_write_b32 a45, v10
  v_accvgpr_read_b32 v10, a46
  v_mul_f32 v10, v10, v9
  v_accvgpr_write_b32 a46, v10
  v_accvgpr_read_b32 v10, a47
  v_mul_f32 v10, v10, v9
  v_accvgpr_write_b32 a47, v10
  s_branch L_BA_B0
L_BA_R1:
  v_mov_b32 v9, v8
  s_nop 1
  v_permlane32_swap_b32 v9, v8
  s_nop 1
  v_max_f32 v8, v8, v9
  v_max_f32 v8, 0, v8
  v_sub_f32 v9, 0, v8
  v_exp_f32 v9, v9
  v_sub_f32 v64, v64, v8
  v_sub_f32 v65, v65, v8
  v_sub_f32 v66, v66, v8
  v_sub_f32 v67, v67, v8
  v_sub_f32 v68, v68, v8
  v_sub_f32 v69, v69, v8
  v_sub_f32 v70, v70, v8
  v_sub_f32 v71, v71, v8
  v_sub_f32 v72, v72, v8
  v_sub_f32 v73, v73, v8
  v_sub_f32 v74, v74, v8
  v_sub_f32 v75, v75, v8
  v_sub_f32 v76, v76, v8
  v_sub_f32 v77, v77, v8
  v_sub_f32 v78, v78, v8
  v_sub_f32 v79, v79, v8
  v_sub_f32 v80, v80, v8
  v_sub_f32 v81, v81, v8
  v_sub_f32 v82, v82, v8
  v_sub_f32 v83, v83, v8
  v_sub_f32 v84, v84, v8
  v_sub_f32 v85, v85, v8
  v_sub_f32 v86, v86, v8
  v_sub_f32 v87, v87, v8
  v_sub_f32 v88, v88, v8
  v_sub_f32 v89, v89, v8
  v_sub_f32 v90, v90, v8
  v_sub_f32 v91, v91, v8
  v_sub_f32 v92, v92, v8
  v_sub_f32 v93, v93, v8
  v_sub_f32 v94, v94, v8
  v_sub_f32 v95, v95, v8
  s_nop 15
  v_sub_f32 v112, v112, v8
  v_sub_f32 v113, v113, v8
  v_sub_f32 v114, v114, v8
  v_sub_f32 v115, v115, v8
  v_sub_f32 v116, v116, v8
  v_sub_f32 v117, v117, v8
  v_sub_f32 v118, v118, v8
  v_sub_f32 v119, v119, v8
  v_sub_f32 v120, v120, v8
  v_sub_f32 v121, v121, v8
  v_sub_f32 v122, v122, v8
  v_sub_f32 v123, v123, v8
  v_sub_f32 v124, v124, v8
  v_sub_f32 v125, v125, v8
  v_sub_f32 v126, v126, v8
  v_sub_f32 v127, v127, v8
  v_accvgpr_read_b32 v10, a16
  v_mul_f32 v10, v10, v9
  v_accvgpr_write_b32 a16, v10
  v_accvgpr_read_b32 v10, a48
  v_mul_f32 v10, v10, v9
  v_accvgpr_write_b32 a48, v10
  v_accvgpr_read_b32 v10, a49
  v_mul_f32 v10, v10, v9
  v_accvgpr_write_b32 a49, v10
  v_accvgpr_read_b32 v10, a50
  v_mul_f32 v10, v10, v9
  v_accvgpr_write_b32 a50, v10
  v_accvgpr_read_b32 v10, a51
  v_mul_f32 v10, v10, v9
  v_accvgpr_write_b32 a51, v10
  v_accvgpr_read_b32 v10, a52
  v_mul_f32 v10, v10, v9
  v_accvgpr_write_b32 a52, v10
  v_accvgpr_read_b32 v10, a53
  v_mul_f32 v10, v10, v9
  v_accvgpr_write_b32 a53, v10
  v_accvgpr_read_b32 v10, a54
  v_mul_f32 v10, v10, v9
  v_accvgpr_write_b32 a54, v10
  v_accvgpr_read_b32 v10, a55
  v_mul_f32 v10, v10, v9
  v_accvgpr_write_b32 a55, v10
  v_accvgpr_read_b32 v10, a56
  v_mul_f32 v10, v10, v9
  v_accvgpr_write_b32 a56, v10
  v_accvgpr_read_b32 v10, a57
  v_mul_f32 v10, v10, v9
  v_accvgpr_write_b32 a57, v10
  v_accvgpr_read_b32 v10, a58
  v_mul_f32 v10, v10, v9
  v_accvgpr_write_b32 a58, v10
  v_accvgpr_read_b32 v10, a59
  v_mul_f32 v10, v10, v9
  v_accvgpr_write_b32 a59, v10
  v_accvgpr_read_b32 v10, a60
  v_mul_f32 v10, v10, v9
  v_accvgpr_write_b32 a60, v10
  v_accvgpr_read_b32 v10, a61
  v_mul_f32 v10, v10, v9
  v_accvgpr_write_b32 a61, v10
  v_accvgpr_read_b32 v10, a62
  v_mul_f32 v10, v10, v9
  v_accvgpr_write_b32 a62, v10
  v_accvgpr_read_b32 v10, a63
  v_mul_f32 v10, v10, v9
  v_accvgpr_write_b32 a63, v10
  s_branch L_BA_B1
L_BA_X1:
  v_accvgpr_read_b32 v4, a0
  v_accvgpr_read_b32 v6, a16
L_BA_E:
  s_lshl_b32 s43, s53, 2
  s_add_u32 s43, s43, s41
  s_lshl_b32 s39, s43, 7
  s_add_u32 s39, s39, 71565312
  v_and_b32 v8, 31, v0
  v_lshl_add_u32 v8, v8, 2, s39
  global_load_dword v8, v8, s[30:31] sc1
  s_lshl_b32 s43, s43, 16
  s_lshl_b32 s39, s54, 13
  s_add_u32 s43, s43, s39
  s_lshl_b32 s39, s42, 12
  s_add_u32 s43, s43, s39
  s_add_u32 s43, s43, 67108864
  v_lshl_add_u32 v2, v0, 4, s43
  v_and_b32 v10, 7, v0
  v_lshlrev_b32 v10, 2, v10
  s_mov_b32 s38, 524288
R10:
  s_sub_u32 s38, s38, 1
  s_cbranch_scc1 L_END
  global_load_dword v11, v10, s[28:29] sc1
  s_waitcnt vmcnt(0)
  s_mov_b32 s32, 0
  v_cmp_ne_u32 vcc, 32, v11
  s_nop 0
  s_cbranch_vccz RD11
  s_mov_b32 s32, 1
  v_cmp_lt_u32 vcc, 32, v11
  s_nop 0
  s_cbranch_vccz R10
RD11:
  v_rcp_f32 v4, v4
  v_rcp_f32 v6, v6
  s_waitcnt vmcnt(0)
  v_sub_f32 v8, 1.0, v8
  v_mul_f32 v4, v4, v8
  v_mul_f32 v6, v6, v8
  v_accvgpr_read_b32 v16, a32
  v_accvgpr_read_b32 v17, a33
  v_accvgpr_read_b32 v18, a34
  v_accvgpr_read_b32 v19, a35
  v_accvgpr_read_b32 v20, a36
  v_accvgpr_read_b32 v21, a37
  v_accvgpr_read_b32 v22, a38
  v_accvgpr_read_b32 v23, a39
  v_mul_f32 v16, v4, v16
  v_mul_f32 v17, v4, v17
  v_mul_f32 v18, v4, v18
  v_mul_f32 v19, v4, v19
  v_mul_f32 v20, v4, v20
  v_mul_f32 v21, v4, v21
  v_mul_f32 v22, v4, v22
  v_mul_f32 v23, v4, v23
  v_cvt_pk_bf16_f32 v32, v16, v17
  v_cvt_pk_bf16_f32 v33, v18, v19
  v_cvt_pk_bf16_f32 v34, v20, v21
  v_cvt_pk_bf16_f32 v35, v22, v23
  global_store_dwordx4 v2, v[32:35], s[30:31] offset:0 sc1
  v_accvgpr_read_b32 v16, a40
  v_accvgpr_read_b32 v17, a41
  v_accvgpr_read_b32 v18, a42
  v_accvgpr_read_b32 v19, a43
  v_accvgpr_read_b32 v20, a44
  v_accvgpr_read_b32 v21, a45
  v_accvgpr_read_b32 v22, a46
  v_accvgpr_read_b32 v23, a47
  v_mul_f32 v16, v4, v16
  v_mul_f32 v17, v4, v17
  v_mul_f32 v18, v4, v18
  v_mul_f32 v19, v4, v19
  v_mul_f32 v20, v4, v20
  v_mul_f32 v21, v4, v21
  v_mul_f32 v22, v4, v22
  v_mul_f32 v23, v4, v23
  v_cvt_pk_bf16_f32 v36, v16, v17
  v_cvt_pk_bf16_f32 v37, v18, v19
  v_cvt_pk_bf16_f32 v38, v20, v21
  v_cvt_pk_bf16_f32 v39, v22, v23
  global_store_dwordx4 v2, v[36:39], s[30:31] offset:1024 sc1
  v_accvgpr_read_b32 v16, a48
  v_accvgpr_read_b32 v17, a49
  v_accvgpr_read_b32 v18, a50
  v_accvgpr_read_b32 v19, a51
  v_accvgpr_read_b32 v20, a52
  v_accvgpr_read_b32 v21, a53
  v_accvgpr_read_b32 v22, a54
  v_accvgpr_read_b32 v23, a55
  v_mul_f32 v16, v6, v16
  v_mul_f32 v17, v6, v17
  v_mul_f32 v18, v6, v18
  v_mul_f32 v19, v6, v19
  v_mul_f32 v20, v6, v20
  v_mul_f32 v21, v6, v21
  v_mul_f32 v22, v6, v22
  v_mul_f32 v23, v6, v23
  v_cvt_pk_bf16_f32 v40, v16, v17
  v_cvt_pk_bf16_f32 v41, v18, v19
  v_cvt_pk_bf16_f32 v42, v20, v21
  v_cvt_pk_bf16_f32 v43, v22, v23
  global_store_dwordx4 v2, v[40:43], s[30:31] offset:2048 sc1
  v_accvgpr_read_b32 v16, a56
  v_accvgpr_read_b32 v17, a57
  v_accvgpr_read_b32 v18, a58
  v_accvgpr_read_b32 v19, a59
  v_accvgpr_read_b32 v20, a60
  v_accvgpr_read_b32 v21, a61
  v_accvgpr_read_b32 v22, a62
  v_accvgpr_read_b32 v23, a63
  v_mul_f32 v16, v6, v16
  v_mul_f32 v17, v6, v17
  v_mul_f32 v18, v6, v18
  v_mul_f32 v19, v6, v19
  v_mul_f32 v20, v6, v20
  v_mul_f32 v21, v6, v21
  v_mul_f32 v22, v6, v22
  v_mul_f32 v23, v6, v23
  v_cvt_pk_bf16_f32 v44, v16, v17
  v_cvt_pk_bf16_f32 v45, v18, v19
  v_cvt_pk_bf16_f32 v46, v20, v21
  v_cvt_pk_bf16_f32 v47, v22, v23
  global_store_dwordx4 v2, v[44:47], s[30:31] offset:3072 sc1
  s_lshr_b32 s53, s53, 1
  s_lshl_b32 s53, s53, 2
  s_waitcnt vmcnt(0)
  s_barrier
  s_cmp_lg_u32 s34, 0
  s_cbranch_scc1 S12
  s_add_u32 s39, s53, 128
  v_mov_b32 v2, s39
  v_mov_b32 v3, 1
  s_mov_b64 exec, 1
  global_atomic_add v2, v3, s[28:29] sc1
  s_mov_b64 exec, -1
S12:
  s_xor_b32 s39, s33, 1
  s_lshl_b32 s39, s39, 16
  s_lshl_b32 s48, s34, 13
  s_add_u32 s39, s39, s48
  v_lshlrev_b32 v12, 4, v0
  v_mov_b32 v16, -1
  v_mov_b32 v17, -1
  v_mov_b32 v18, -1
  v_mov_b32 v19, -1
  s_add_u32 s56, s30, s39
  s_addc_u32 s57, s31, 0
  s_add_u32 s56, s56, 100667392
  s_addc_u32 s57, s57, 0
  s_cmp_eq_u32 s32, 0
  s_cbranch_scc1 F13
  global_store_dwordx4 v12, v[16:19], s[56:57] offset:-4096 sc1
  global_store_dwordx4 v12, v[16:19], s[56:57] offset:-3072 sc1
  global_store_dwordx4 v12, v[16:19], s[56:57] offset:-2048 sc1
  global_store_dwordx4 v12, v[16:19], s[56:57] offset:-1024 sc1
  global_store_dwordx4 v12, v[16:19], s[56:57] offset:0 sc1
  global_store_dwordx4 v12, v[16:19], s[56:57] offset:1024 sc1
  global_store_dwordx4 v12, v[16:19], s[56:57] offset:2048 sc1
  global_store_dwordx4 v12, v[16:19], s[56:57] offset:3072 sc1
  s_branch E14
F13:
  global_store_dwordx4 v12, v[16:19], s[56:57] offset:-4096
  global_store_dwordx4 v12, v[16:19], s[56:57] offset:-3072
  global_store_dwordx4 v12, v[16:19], s[56:57] offset:-2048
  global_store_dwordx4 v12, v[16:19], s[56:57] offset:-1024
  global_store_dwordx4 v12, v[16:19], s[56:57] offset:0
  global_store_dwordx4 v12, v[16:19], s[56:57] offset:1024
  global_store_dwordx4 v12, v[16:19], s[56:57] offset:2048
  global_store_dwordx4 v12, v[16:19], s[56:57] offset:3072
E14:
  s_cmp_lg_u32 s34, 0
  s_cbranch_scc1 L_FWD16
  v_min_u32 v2, 15, v0
  v_mov_b32 v3, 16
  v_mov_b32 v4, 128
  v_cmp_gt_u32 vcc, 8, v2
  v_lshlrev_b32 v2, 2, v2
  v_cndmask_b32 v3, v3, v4, vcc
  s_mov_b32 s38, 524288
L_FW16:
  s_sub_u32 s38, s38, 1
  s_cbranch_scc1 L_END
  global_load_dword v4, v2, s[28:29] offset:64 sc1
  s_waitcnt vmcnt(0)
  v_cmp_lt_u32 vcc, v4, v3
  s_nop 0
  s_cbranch_vccz L_FWD16
  s_sleep 2
  s_branch L_FW16
L_FWD16:
  s_mov_b32 s52, 0
  s_mov_b32 s49, 0
L_FB:
  s_lshr_b32 s62, 8, s52
  s_lshl_b32 s39, s62, 3
  s_sub_u32 s63, 64, s39
  s_max_u32 s62, s62, 2
  s_mul_i32 s39, s62, s50
  s_add_u32 s63, s63, s39
  s_cmp_lt_u32 s52, 3
  s_cbranch_scc1 L_FB_T
  s_sub_u32 s63, 59, s50
  s_add_u32 s39, s50, 60
  s_cmp_eq_u32 s52, 4
  s_cselect_b32 s63, s39, s63
  s_cmp_eq_u32 s50, 0
  s_cselect_b32 s62, 2, 1
L_FB_T:
  s_add_u32 s67, s63, s62
  s_add_u32 s67, s67, 2
  s_cmp_ge_u32 s67, 64
  s_cselect_b32 s67, 191, s67
  s_barrier
  s_add_u32 s64, s63, s34
  s_cmp_ge_u32 s34, s62
  s_cbranch_scc1 L_FB_X
  s_lshl_b32 s39, s64, 18
  s_lshl_b32 s43, s51, 13
  s_add_u32 s65, s39, s43
  s_lshr_b32 s66, s65, 2
  v_lshlrev_b32 v2, 4, v0
  v_and_b32 v3, 7, v0
  v_lshlrev_b32 v3, 4, v3
  v_lshrrev_b32 v1, 5, v0
  v_lshl_add_u32 v3, v1, 7, v3
  s_add_u32 s56, s30, s65
  s_addc_u32 s57, s31, 0
  s_add_u32 s56, s56, 4096
  s_addc_u32 s57, s57, 0
  s_add_u32 s58, s30, s65
  s_addc_u32 s59, s31, 0
  s_add_u32 s58, s58, 16781312
  s_addc_u32 s59, s59, 0
  s_add_u32 s60, s30, s65
  s_addc_u32 s61, s31, 0
  s_add_u32 s60, s60, 33554432
  s_addc_u32 s61, s61, 0
  global_load_dwordx4 v[4:7], v2, s[56:57] offset:-4096 sc1
  global_load_dwordx4 v[36:39], v2, s[58:59] offset:-4096 sc1
  global_load_dwordx4 v[8:11], v2, s[56:57] offset:-3072 sc1
  global_load_dwordx4 v[40:43], v2, s[58:59] offset:-3072 sc1
  global_load_dwordx4 v[12:15], v2, s[56:57] offset:-2048 sc1
  global_load_dwordx4 v[44:47], v2, s[58:59] offset:-2048 sc1
  global_load_dwordx4 v[16:19], v2, s[56:57] offset:-1024 sc1
  global_load_dwordx4 v[48:51], v2, s[58:59] offset:-1024 sc1
  global_load_dwordx4 v[20:23], v2, s[56:57] offset:0 sc1
  global_load_dwordx4 v[52:55], v2, s[58:59] offset:0 sc1
  global_load_dwordx4 v[24:27], v2, s[56:57] offset:1024 sc1
  global_load_dwordx4 v[56:59], v2, s[58:59] offset:1024 sc1
  global_load_dwordx4 v[28:31], v2, s[56:57] offset:2048 sc1
  global_load_dwordx4 v[60:63], v2, s[58:59] offset:2048 sc1
  global_load_dwordx4 v[32:35], v2, s[56:57] offset:3072 sc1
  global_load_dwordx4 v[64:67], v2, s[58:59] offset:3072 sc1
  s_lshl_b32 s43, s34, 13
  s_mov_b32 m0, s43
  v_add_u32 v116, s43, v2
  s_nop 0
  global_load_lds_dwordx4 v2, s[60:61] offset:0 sc1
  global_load_lds_dwordx4 v2, s[60:61] offset:1024 sc1
  global_load_lds_dwordx4 v2, s[60:61] offset:2048 sc1
  global_load_lds_dwordx4 v2, s[60:61] offset:3072 sc1
  s_add_u32 s60, s60, 4096
  s_addc_u32 s61, s61, 0
  s_add_u32 m0, m0, 4096
  s_nop 0
  global_load_lds_dwordx4 v2, s[60:61] offset:0 sc1
  global_load_lds_dwordx4 v2, s[60:61] offset:1024 sc1
  global_load_lds_dwordx4 v2, s[60:61] offset:2048 sc1
  global_load_lds_dwordx4 v2, s[60:61] offset:3072 sc1
  s_lshl_b32 s39, s64, 7
  s_add_u32 s39, s39, 71565312
  v_and_b32 v119, 31, v0
  v_lshl_add_u32 v117, v119, 2, s39
  global_load_dword v117, v117, s[30:31] sc1
  v_lshlrev_b32 v118, 2, v1
  v_sub_u32 v118, v119, v118
  v_lshlrev_b32 v119, 4, v119
  v_lshl_add_u32 v119, v1, 3, v119
  s_add_u32 s56, s30, s66
  s_addc_u32 s57, s31, 0
  s_add_u32 s56, s56, 75497472
  s_addc_u32 s57, s57, 0
  s_add_u32 s58, s30, s66
  s_addc_u32 s59, s31, 0
  s_add_u32 s58, s58, 79691776
  s_addc_u32 s59, s59, 0
  s_add_u32 s60, s30, s65
  s_addc_u32 s61, s31, 0
  s_add_u32 s60, s60, 50335744
  s_addc_u32 s61, s61, 0
  s_waitcnt vmcnt(23)
  v_mfma_f32_32x32x16_bf16 v[100:115], v[36:39], v[4:7], 0
  s_waitcnt vmcnt(21)
  v_mfma_f32_32x32x16_bf16 v[100:115], v[40:43], v[8:11], v[100:115]
  s_waitcnt vmcnt(19)
  v_mfma_f32_32x32x16_bf16 v[100:115], v[44:47], v[12:15], v[100:115]
  s_waitcnt vmcnt(17)
  v_mfma_f32_32x32x16_bf16 v[100:115], v[48:51], v[16:19], v[100:115]
  s_waitcnt vmcnt(15)
  v_mfma_f32_32x32x16_bf16 v[100:115], v[52:55], v[20:23], v[100:115]
  s_waitcnt vmcnt(13)
  v_mfma_f32_32x32x16_bf16 v[100:115], v[56:59], v[24:27], v[100:115]
  s_waitcnt vmcnt(11)
  v_mfma_f32_32x32x16_bf16 v[100:115], v[60:63], v[28:31], v[100:115]
  s_waitcnt vmcnt(9)
  v_mfma_f32_32x32x16_bf16 v[100:115], v[64:67], v[32:35], v[100:115]
  v_mov_b32 v120, 44
  s_mov_b32 s38, 524288
W15:
  global_load_dword v121, v120, s[28:29] sc1
  s_waitcnt vmcnt(0)
  v_readfirstlane_b32 s39, v121
  s_cmp_ge_u32 s39, s67
  s_cbranch_scc1 WD16
  s_sleep 3
  s_sub_u32 s38, s38, 1
  s_cbranch_scc1 L_END
  s_branch W15
WD16:
  global_load_dwordx4 v[68:71], v3, s[56:57] offset:0 sc1
  global_load_dwordx4 v[72:75], v3, s[56:57] offset:256 sc1
  global_load_dwordx4 v[76:79], v3, s[56:57] offset:512 sc1
  global_load_dwordx4 v[80:83], v3, s[56:57] offset:768 sc1
  global_load_dwordx4 v[84:87], v3, s[56:57] offset:1024 sc1
  global_load_dwordx4 v[88:91], v3, s[56:57] offset:1280 sc1
  global_load_dwordx4 v[92:95], v3, s[56:57] offset:1536 sc1
  global_load_dwordx4 v[96:99], v3, s[56:57] offset:1792 sc1
  global_load_dwordx2 v[52:53], v119, s[58:59] offset:0 sc1
  global_load_dwordx2 v[54:55], v119, s[58:59] offset:512 sc1
  global_load_dwordx2 v[56:57], v119, s[58:59] offset:1024 sc1
  global_load_dwordx2 v[58:59], v119, s[58:59] offset:1536 sc1
  s_waitcnt vmcnt(11)
  v_mfma_f32_32x32x16_bf16 v[36:51], v[68:71], v[4:7], 0
  s_waitcnt vmcnt(10)
  v_mfma_f32_32x32x16_bf16 v[36:51], v[72:75], v[8:11], v[36:51]
  s_waitcnt vmcnt(9)
  v_mfma_f32_32x32x16_bf16 v[36:51], v[76:79], v[12:15], v[36:51]
  s_waitcnt vmcnt(8)
  v_mfma_f32_32x32x16_bf16 v[36:51], v[80:83], v[16:19], v[36:51]
  s_waitcnt vmcnt(7)
  v_mfma_f32_32x32x16_bf16 v[36:51], v[84:87], v[20:23], v[36:51]
  s_waitcnt vmcnt(6)
  v_mfma_f32_32x32x16_bf16 v[36:51], v[88:91], v[24:27], v[36:51]
  s_waitcnt vmcnt(5)
  v_mfma_f32_32x32x16_bf16 v[36:51], v[92:95], v[28:31], v[36:51]
  s_waitcnt vmcnt(4)
  v_mfma_f32_32x32x16_bf16 v[36:51], v[96:99], v[32:35], v[36:51]
  s_nop 5
  ds_read_b128 v[68:71], v116 offset:0
  ds_read_b128 v[72:75], v116 offset:1024
  ds_read_b128 v[76:79], v116 offset:2048
  ds_read_b128 v[80:83], v116 offset:3072
  ds_read_b128 v[84:87], v116 offset:4096
  ds_read_b128 v[88:91], v116 offset:5120
  ds_read_b128 v[92:95], v116 offset:6144
  ds_read_b128 v[96:99], v116 offset:7168
  s_waitcnt vmcnt(0)
  v_mov_b32 v4, v52
  v_mov_b32 v5, v53
  v_mov_b32 v6, 0
  v_mov_b32 v7, 0
  v_mov_b32 v8, v54
  v_mov_b32 v9, v55
  v_mov_b32 v10, 0
  v_mov_b32 v11, 0
  v_mov_b32 v12, v56
  v_mov_b32 v13, v57
  v_mov_b32 v14, 0
  v_mov_b32 v15, 0
  v_mov_b32 v16, v58
  v_mov_b32 v17, v59
  v_mov_b32 v18, 0
  v_mov_b32 v19, 0
  v_mov_b32 v120, 0xff800000
  v_cmp_ge_i32 s[68:69], v118, 0
  v_cmp_ge_i32 s[70:71], v118, 1
  v_cmp_ge_i32 s[72:73], v118, 2
  v_cndmask_b32 v100, v120, v100, s[68:69]
  v_cmp_ge_i32 s[74:75], v118, 3
  v_cndmask_b32 v101, v120, v101, s[70:71]
  v_cmp_ge_i32 s[76:77], v118, 8
  v_cndmask_b32 v102, v120, v102, s[72:73]
  v_cmp_ge_i32 s[78:79], v118, 9
  v_cndmask_b32 v103, v120, v103, s[74:75]
  v_cmp_ge_i32 s[80:81], v118, 10
  v_cndmask_b32 v104, v120, v104, s[76:77]
  v_cmp_ge_i32 s[82:83], v118, 11
  v_cndmask_b32 v105, v120, v105, s[78:79]
  v_cmp_ge_i32 s[68:69], v118, 16
  v_cndmask_b32 v106, v120, v106, s[80:81]
  v_cmp_ge_i32 s[70:71], v118, 17
  v_cndmask_b32 v107, v120, v107, s[82:83]
  v_cmp_ge_i32 s[72:73], v118, 18
  v_cndmask_b32 v108, v120, v108, s[68:69]
  v_cmp_ge_i32 s[74:75], v118, 19
  v_cndmask_b32 v109, v120, v109, s[70:71]
  v_cmp_ge_i32 s[76:77], v118, 24
  v_cndmask_b32 v110, v120, v110, s[72:73]
  v_cmp_ge_i32 s[78:79], v118, 25
  v_cndmask_b32 v111, v120, v111, s[74:75]
  v_cmp_ge_i32 s[80:81], v118, 26
  v_cndmask_b32 v112, v120, v112, s[76:77]
  v_cmp_ge_i32 s[82:83], v118, 27
  v_cndmask_b32 v113, v120, v113, s[78:79]
  s_nop 1
  v_cndmask_b32 v114, v120, v114, s[80:81]
  v_cndmask_b32 v115, v120, v115, s[82:83]
  v_max3_f32 v121, v100, v101, v102
  v_max3_f32 v121, v121, v103, v104
  v_max3_f32 v121, v121, v105, v106
  v_max3_f32 v121, v121, v107, v108
  v_max3_f32 v121, v121, v109, v110
  v_max3_f32 v121, v121, v111, v112
  v_max3_f32 v121, v121, v113, v114
  v_max3_f32 v121, v121, v115, v36
  v_max3_f32 v121, v121, v37, v38
  v_max_f32 v121, v121, v39
  v_mov_b32 v122, v121
  s_nop 1
  v_permlane32_swap_b32 v122, v121
  s_nop 1
  v_max_f32 v121, v121, v122
  s_mov_b32 s39, 0x3e0293ee
  v_mul_f32 v121, s39, v121
  v_fma_f32 v100, v100, s39, -v121
  v_fma_f32 v101, v101, s39, -v121
  v_fma_f32 v102, v102, s39, -v121
  v_fma_f32 v103, v103, s39, -v121
  v_fma_f32 v104, v104, s39, -v121
  v_fma_f32 v105, v105, s39, -v121
  v_fma_f32 v106, v106, s39, -v121
  v_fma_f32 v107, v107, s39, -v121
  v_fma_f32 v108, v108, s39, -v121
  v_fma_f32 v109, v109, s39, -v121
  v_fma_f32 v110, v110, s39, -v121
  v_fma_f32 v111, v111, s39, -v121
  v_fma_f32 v112, v112, s39, -v121
  v_fma_f32 v113, v113, s39, -v121
  v_fma_f32 v114, v114, s39, -v121
  v_fma_f32 v115, v115, s39, -v121
  v_fma_f32 v36, v36, s39, -v121
  v_fma_f32 v37, v37, s39, -v121
  v_fma_f32 v38, v38, s39, -v121
  v_fma_f32 v39, v39, s39, -v121
  v_exp_f32 v100, v100
  v_exp_f32 v101, v101
  v_exp_f32 v102, v102
  v_exp_f32 v103, v103
  v_exp_f32 v104, v104
  v_exp_f32 v105, v105
  v_exp_f32 v106, v106
  v_exp_f32 v107, v107
  v_exp_f32 v108, v108
  v_exp_f32 v109, v109
  v_exp_f32 v110, v110
  v_exp_f32 v111, v111
  v_exp_f32 v112, v112
  v_exp_f32 v113, v113
  v_exp_f32 v114, v114
  v_exp_f32 v115, v115
  v_exp_f32 v36, v36
  v_exp_f32 v37, v37
  v_exp_f32 v38, v38
  v_exp_f32 v39, v39
  s_nop 0
  v_add_f32 v121, v100, v101
  v_add_f32 v121, v121, v102
  v_add_f32 v121, v121, v103
  v_add_f32 v121, v121, v104
  v_add_f32 v121, v121, v105
  v_add_f32 v121, v121, v106
  v_add_f32 v121, v121, v107
  v_add_f32 v121, v121, v108
  v_add_f32 v121, v121, v109
  v_add_f32 v121, v121, v110
  v_add_f32 v121, v121, v111
  v_add_f32 v121, v121, v112
  v_add_f32 v121, v121, v113
  v_add_f32 v121, v121, v114
  v_add_f32 v121, v121, v115
  v_add_f32 v121, v121, v36
  v_add_f32 v121, v121, v37
  v_add_f32 v121, v121, v38
  v_add_f32 v121, v121, v39
  v_mov_b32 v122, v121
  s_nop 1
  v_permlane32_swap_b32 v122, v121
  s_nop 1
  v_add_f32 v121, v121, v122
  v_rcp_f32 v121, v121
  v_cvt_pk_bf16_f32 v100, v100, v101
  v_cvt_pk_bf16_f32 v101, v102, v103
  v_cvt_pk_bf16_f32 v102, v104, v105
  v_cvt_pk_bf16_f32 v103, v106, v107
  v_cvt_pk_bf16_f32 v104, v108, v109
  v_cvt_pk_bf16_f32 v105, v110, v111
  v_cvt_pk_bf16_f32 v106, v112, v113
  v_cvt_pk_bf16_f32 v107, v114, v115
  v_cvt_pk_bf16_f32 v108, v36, v37
  v_cvt_pk_bf16_f32 v109, v38, v39
  v_mov_b32 v110, 0
  v_mov_b32 v111, 0
  v_mul_f32 v121, v121, v117
  s_waitcnt lgkmcnt(0)
  v_mfma_f32_32x32x16_bf16 v[36:51], v[68:71], v[100:103], 0
  v_mfma_f32_32x32x16_bf16 v[36:51], v[72:75], v[104:107], v[36:51]
  v_mfma_f32_32x32x16_bf16 v[36:51], v[4:7], v[108:111], v[36:51]
  v_mfma_f32_32x32x16_bf16 v[52:67], v[76:79], v[100:103], 0
  v_mfma_f32_32x32x16_bf16 v[52:67], v[80:83], v[104:107], v[52:67]
  v_mfma_f32_32x32x16_bf16 v[52:67], v[8:11], v[108:111], v[52:67]
  s_nop 9
  v_mul_f32 v28, v121, v36
  v_mul_f32 v29, v121, v37
  v_mul_f32 v30, v121, v38
  v_mul_f32 v31, v121, v39
  v_mul_f32 v32, v121, v40
  v_mul_f32 v33, v121, v41
  v_mul_f32 v34, v121, v42
  v_mul_f32 v35, v121, v43
  v_cvt_pk_bf16_f32 v20, v28, v29
  v_cvt_pk_bf16_f32 v21, v30, v31
  v_cvt_pk_bf16_f32 v22, v32, v33
  v_cvt_pk_bf16_f32 v23, v34, v35
  v_mul_f32 v28, v121, v44
  v_mul_f32 v29, v121, v45
  v_mul_f32 v30, v121, v46
  v_mul_f32 v31, v121, v47
  v_mul_f32 v32, v121, v48
  v_mul_f32 v33, v121, v49
  v_mul_f32 v34, v121, v50
  v_mul_f32 v35, v121, v51
  v_cvt_pk_bf16_f32 v24, v28, v29
  v_cvt_pk_bf16_f32 v25, v30, v31
  v_cvt_pk_bf16_f32 v26, v32, v33
  v_cvt_pk_bf16_f32 v27, v34, v35
  s_cmp_eq_u32 s32, 0
  s_cbranch_scc1 F17
  global_store_dwordx4 v2, v[20:23], s[60:61] offset:-4096 sc1
  global_store_dwordx4 v2, v[24:27], s[60:61] offset:-3072 sc1
  s_branch E18
F17:
  global_store_dwordx4 v2, v[20:23], s[60:61] offset:-4096
  global_store_dwordx4 v2, v[24:27], s[60:61] offset:-3072
E18:
  s_nop 1
  v_mfma_f32_32x32x16_bf16 v[36:51], v[84:87], v[100:103], 0
  v_mfma_f32_32x32x16_bf16 v[36:51], v[88:91], v[104:107], v[36:51]
  v_mfma_f32_32x32x16_bf16 v[36:51], v[12:15], v[108:111], v[36:51]
  s_nop 9
  v_mul_f32 v28, v121, v52
  v_mul_f32 v29, v121, v53
  v_mul_f32 v30, v121, v54
  v_mul_f32 v31, v121, v55
  v_mul_f32 v32, v121, v56
  v_mul_f32 v33, v121, v57
  v_mul_f32 v34, v121, v58
  v_mul_f32 v35, v121, v59
  v_cvt_pk_bf16_f32 v20, v28, v29
  v_cvt_pk_bf16_f32 v21, v30, v31
  v_cvt_pk_bf16_f32 v22, v32, v33
  v_cvt_pk_bf16_f32 v23, v34, v35
  v_mul_f32 v28, v121, v60
  v_mul_f32 v29, v121, v61
  v_mul_f32 v30, v121, v62
  v_mul_f32 v31, v121, v63
  v_mul_f32 v32, v121, v64
  v_mul_f32 v33, v121, v65
  v_mul_f32 v34, v121, v66
  v_mul_f32 v35, v121, v67
  v_cvt_pk_bf16_f32 v24, v28, v29
  v_cvt_pk_bf16_f32 v25, v30, v31
  v_cvt_pk_bf16_f32 v26, v32, v33
  v_cvt_pk_bf16_f32 v27, v34, v35
  s_cmp_eq_u32 s32, 0
  s_cbranch_scc1 F19
  global_store_dwordx4 v2, v[20:23], s[60:61] offset:-2048 sc1
  global_store_dwordx4 v2, v[24:27], s[60:61] offset:-1024 sc1
  s_branch E20
F19:
  global_store_dwordx4 v2, v[20:23], s[60:61] offset:-2048
  global_store_dwordx4 v2, v[24:27], s[60:61] offset:-1024
E20:
  s_nop 1
  v_mfma_f32_32x32x16_bf16 v[52:67], v[92:95], v[100:103], 0
  v_mfma_f32_32x32x16_bf16 v[52:67], v[96:99], v[104:107], v[52:67]
  v_mfma_f32_32x32x16_bf16 v[52:67], v[16:19], v[108:111], v[52:67]
  s_nop 9
  v_mul_f32 v28, v121, v36
  v_mul_f32 v29, v121, v37
  v_mul_f32 v30, v121, v38
  v_mul_f32 v31, v121, v39
  v_mul_f32 v32, v121, v40
  v_mul_f32 v33, v121, v41
  v_mul_f32 v34, v121, v42
  v_mul_f32 v35, v121, v43
  v_cvt_pk_bf16_f32 v20, v28, v29
  v_cvt_pk_bf16_f32 v21, v30, v31
  v_cvt_pk_bf16_f32 v22, v32, v33
  v_cvt_pk_bf16_f32 v23, v34, v35
  v_mul_f32 v28, v121, v44
  v_mul_f32 v29, v121, v45
  v_mul_f32 v30, v121, v46
  v_mul_f32 v31, v121, v47
  v_mul_f32 v32, v121, v48
  v_mul_f32 v33, v121, v49
  v_mul_f32 v34, v121, v50
  v_mul_f32 v35, v121, v51
  v_cvt_pk_bf16_f32 v24, v28, v29
  v_cvt_pk_bf16_f32 v25, v30, v31
  v_cvt_pk_bf16_f32 v26, v32, v33
  v_cvt_pk_bf16_f32 v27, v34, v35
  s_cmp_eq_u32 s32, 0
  s_cbranch_scc1 F21
  global_store_dwordx4 v2, v[20:23], s[60:61] offset:0 sc1
  global_store_dwordx4 v2, v[24:27], s[60:61] offset:1024 sc1
  s_branch E22
F21:
  global_store_dwordx4 v2, v[20:23], s[60:61] offset:0
  global_store_dwordx4 v2, v[24:27], s[60:61] offset:1024
E22:
  s_nop 1
  s_nop 11
  v_mul_f32 v28, v121, v52
  v_mul_f32 v29, v121, v53
  v_mul_f32 v30, v121, v54
  v_mul_f32 v31, v121, v55
  v_mul_f32 v32, v121, v56
  v_mul_f32 v33, v121, v57
  v_mul_f32 v34, v121, v58
  v_mul_f32 v35, v121, v59
  v_cvt_pk_bf16_f32 v20, v28, v29
  v_cvt_pk_bf16_f32 v21, v30, v31
  v_cvt_pk_bf16_f32 v22, v32, v33
  v_cvt_pk_bf16_f32 v23, v34, v35
  v_mul_f32 v28, v121, v60
  v_mul_f32 v29, v121, v61
  v_mul_f32 v30, v121, v62
  v_mul_f32 v31, v121, v63
  v_mul_f32 v32, v121, v64
  v_mul_f32 v33, v121, v65
  v_mul_f32 v34, v121, v66
  v_mul_f32 v35, v121, v67
  v_cvt_pk_bf16_f32 v24, v28, v29
  v_cvt_pk_bf16_f32 v25, v30, v31
  v_cvt_pk_bf16_f32 v26, v32, v33
  v_cvt_pk_bf16_f32 v27, v34, v35
  s_cmp_eq_u32 s32, 0
  s_cbranch_scc1 F23
  global_store_dwordx4 v2, v[20:23], s[60:61] offset:2048 sc1
  global_store_dwordx4 v2, v[24:27], s[60:61] offset:3072 sc1
  s_branch E24
F23:
  global_store_dwordx4 v2, v[20:23], s[60:61] offset:2048
  global_store_dwordx4 v2, v[24:27], s[60:61] offset:3072
E24:
  s_nop 1
L_FB_X:
  s_lshl_b32 s53, s52, 2
  s_add_u32 s53, s53, s50
  s_lshl_b32 s53, s53, 2
  s_waitcnt vmcnt(0)
  s_barrier
  s_cmp_lg_u32 s34, 0
  s_cbranch_scc1 S25
  s_add_u32 s39, s53, 160
  v_mov_b32 v2, s39
  v_mov_b32 v3, 1
  s_mov_b64 exec, 1
  global_atomic_add v2, v3, s[28:29] sc1
  s_mov_b64 exec, -1
S25:
  s_cmp_lg_u32 s52, 0
  s_cbranch_scc1 L_FB_Y
  s_barrier
  s_and_b32 s43, s51, 1
  s_lshl_b32 s43, s43, 3
  s_add_u32 s43, s43, s34
  s_lshl_b32 s44, s51, 6
  s_xor_b32 s45, s44, 64
  s_lshl_b32 s55, s34, 14
  s_add_u32 s46, s55, 0x2000
  v_bfe_u32 v10, v0, 2, 2
  v_lshrrev_b32 v11, 5, v0
  v_lshl_add_u32 v10, v11, 2, v10
  v_lshlrev_b32 v10, 6, v10
  v_bfe_u32 v11, v0, 4, 1
  v_lshl_add_u32 v10, v11, 5, v10
  v_and_b32 v11, 3, v0
  v_lshl_add_u32 v10, v11, 3, v10
  v_add_u32 v11, s55, v10
  s_lshl_b32 s47, s43, 19
  s_lshl_b32 s42, s43, 17
  s_lshl_b32 s48, s34, 13
  s_and_b32 s44, s44, 0x780
  s_and_b32 s39, s51, 1
  s_lshl_b32 s39, s39, 6
  s_add_u32 s39, s39, s55
  v_and_b32 v11, 63, v10
  v_lshrrev_b32 v10, 6, v10
  v_lshl_add_u32 v10, v10, 7, v11
  v_add_u32 v11, s39, v10
  s_and_b32 s39, s34, 1
  s_lshl_b32 s39, s39, 11
  v_add_u32 v14, s39, v11
  v_subrev_u32 v11, s39, v11
  v_add_u32 v11, 2048, v11
  v_xor_b32 v13, 64, v11
  v_xor_b32 v15, 64, v14
  s_add_u32 s39, s47, s44
  s_add_u32 s58, s14, s39
  s_addc_u32 s59, s15, 0
  v_lshrrev_b32 v2, 3, v0
  v_and_b32 v3, 7, v0
  v_lshlrev_b32 v3, 4, v3
  s_mov_b32 s39, 2048
  v_mul_lo_u32 v2, v2, s39
  v_add_u32 v2, v2, v3
  v_add_u32 v3, 15360, v2
  v_add_u32 v4, 30720, v2
  v_add_u32 v5, 46080, v2
  s_mov_b64 s[94:95], s[58:59]
  s_mov_b32 m0, s55
  s_nop 0
  global_load_lds_dwordx4 v2, s[94:95] offset:0
  global_load_lds_dwordx4 v3, s[94:95] offset:1024
  global_load_lds_dwordx4 v4, s[94:95] offset:2048
  global_load_lds_dwordx4 v5, s[94:95] offset:3072
  s_add_u32 s94, s94, 65536
  s_addc_u32 s95, s95, 0
  s_add_u32 m0, m0, 4096
  s_nop 0
  global_load_lds_dwordx4 v2, s[94:95] offset:0
  global_load_lds_dwordx4 v3, s[94:95] offset:1024
  global_load_lds_dwordx4 v4, s[94:95] offset:2048
  global_load_lds_dwordx4 v5, s[94:95] offset:3072
  s_add_u32 s39, s47, s44
  s_add_u32 s58, s14, s39
  s_addc_u32 s59, s15, 0
  s_add_u32 s58, s58, 131072
  s_addc_u32 s59, s59, 0
  s_mov_b64 s[94:95], s[58:59]
  s_mov_b32 m0, s46
  s_nop 0
  global_load_lds_dwordx4 v2, s[94:95] offset:0
  global_load_lds_dwordx4 v3, s[94:95] offset:1024
  global_load_lds_dwordx4 v4, s[94:95] offset:2048
  global_load_lds_dwordx4 v5, s[94:95] offset:3072
  s_add_u32 s94, s94, 65536
  s_addc_u32 s95, s95, 0
  s_add_u32 m0, m0, 4096
  s_nop 0
  global_load_lds_dwordx4 v2, s[94:95] offset:0
  global_load_lds_dwordx4 v3, s[94:95] offset:1024
  global_load_lds_dwordx4 v4, s[94:95] offset:2048
  global_load_lds_dwordx4 v5, s[94:95] offset:3072
  s_waitcnt vmcnt(8)
  ds_read_b64_tr_b16 a[0:1], v14 offset:0
  ds_read_b64_tr_b16 a[2:3], v14 offset:1024
  ds_read_b64_tr_b16 a[4:5], v15 offset:0
  ds_read_b64_tr_b16 a[6:7], v15 offset:1024
  ds_read_b64_tr_b16 a[8:9], v11 offset:0
  ds_read_b64_tr_b16 a[10:11], v11 offset:1024
  ds_read_b64_tr_b16 a[12:13], v13 offset:0
  ds_read_b64_tr_b16 a[14:15], v13 offset:1024
  ds_read_b64_tr_b16 a[16:17], v14 offset:4096
  ds_read_b64_tr_b16 a[18:19], v14 offset:5120
  ds_read_b64_tr_b16 a[20:21], v15 offset:4096
  ds_read_b64_tr_b16 a[22:23], v15 offset:5120
  ds_read_b64_tr_b16 a[24:25], v11 offset:4096
  ds_read_b64_tr_b16 a[26:27], v11 offset:5120
  ds_read_b64_tr_b16 a[28:29], v13 offset:4096
  ds_read_b64_tr_b16 a[30:31], v13 offset:5120
  s_waitcnt lgkmcnt(0)
  s_add_u32 s39, s47, s44
  s_add_u32 s58, s14, s39
  s_addc_u32 s59, s15, 0
  s_add_u32 s58, s58, 262144
  s_addc_u32 s59, s59, 0
  s_mov_b64 s[94:95], s[58:59]
  s_mov_b32 m0, s55
  s_nop 0
  global_load_lds_dwordx4 v2, s[94:95] offset:0
  global_load_lds_dwordx4 v3, s[94:95] offset:1024
  global_load_lds_dwordx4 v4, s[94:95] offset:2048
  global_load_lds_dwordx4 v5, s[94:95] offset:3072
  s_add_u32 s94, s94, 65536
  s_addc_u32 s95, s95, 0
  s_add_u32 m0, m0, 4096
  s_nop 0
  global_load_lds_dwordx4 v2, s[94:95] offset:0
  global_load_lds_dwordx4 v3, s[94:95] offset:1024
  global_load_lds_dwordx4 v4, s[94:95] offset:2048
  global_load_lds_dwordx4 v5, s[94:95] offset:3072
  s_waitcnt vmcnt(8)
  ds_read_b64_tr_b16 a[32:33], v14 offset:8192
  ds_read_b64_tr_b16 a[34:35], v14 offset:9216
  ds_read_b64_tr_b16 a[36:37], v15 offset:8192
  ds_read_b64_tr_b16 a[38:39], v15 offset:9216
  ds_read_b64_tr_b16 a[40:41], v11 offset:8192
  ds_read_b64_tr_b16 a[42:43], v11 offset:9216
  ds_read_b64_tr_b16 a[44:45], v13 offset:8192
  ds_read_b64_tr_b16 a[46:47], v13 offset:9216
  ds_read_b64_tr_b16 a[48:49], v14 offset:12288
  ds_read_b64_tr_b16 a[50:51], v14 offset:13312
  ds_read_b64_tr_b16 a[52:53], v15 offset:12288
  ds_read_b64_tr_b16 a[54:55], v15 offset:13312
  ds_read_b64_tr_b16 a[56:57], v11 offset:12288
  ds_read_b64_tr_b16 a[58:59], v11 offset:13312
  ds_read_b64_tr_b16 a[60:61], v13 offset:12288
  ds_read_b64_tr_b16 a[62:63], v13 offset:13312
  s_waitcnt lgkmcnt(0)
  s_add_u32 s39, s47, s44
  s_add_u32 s58, s14, s39
  s_addc_u32 s59, s15, 0
  s_add_u32 s58, s58, 393216
  s_addc_u32 s59, s59, 0
  s_mov_b64 s[94:95], s[58:59]
  s_mov_b32 m0, s46
  s_nop 0
  global_load_lds_dwordx4 v2, s[94:95] offset:0
  global_load_lds_dwordx4 v3, s[94:95] offset:1024
  global_load_lds_dwordx4 v4, s[94:95] offset:2048
  global_load_lds_dwordx4 v5, s[94:95] offset:3072
  s_add_u32 s94, s94, 65536
  s_addc_u32 s95, s95, 0
  s_add_u32 m0, m0, 4096
  s_nop 0
  global_load_lds_dwordx4 v2, s[94:95] offset:0
  global_load_lds_dwordx4 v3, s[94:95] offset:1024
  global_load_lds_dwordx4 v4, s[94:95] offset:2048
  global_load_lds_dwordx4 v5, s[94:95] offset:3072
  s_waitcnt vmcnt(8)
  ds_read_b64_tr_b16 a[64:65], v14 offset:0
  ds_read_b64_tr_b16 a[66:67], v14 offset:1024
  ds_read_b64_tr_b16 a[68:69], v15 offset:0
  ds_read_b64_tr_b16 a[70:71], v15 offset:1024
  ds_read_b64_tr_b16 a[72:73], v11 offset:0
  ds_read_b64_tr_b16 a[74:75], v11 offset:1024
  ds_read_b64_tr_b16 a[76:77], v13 offset:0
  ds_read_b64_tr_b16 a[78:79], v13 offset:1024
  ds_read_b64_tr_b16 a[80:81], v14 offset:4096
  ds_read_b64_tr_b16 a[82:83], v14 offset:5120
  ds_read_b64_tr_b16 a[84:85], v15 offset:4096
  ds_read_b64_tr_b16 a[86:87], v15 offset:5120
  ds_read_b64_tr_b16 a[88:89], v11 offset:4096
  ds_read_b64_tr_b16 a[90:91], v11 offset:5120
  ds_read_b64_tr_b16 a[92:93], v13 offset:4096
  ds_read_b64_tr_b16 a[94:95], v13 offset:5120
  s_waitcnt lgkmcnt(0)
  s_add_u32 s39, s42, s44
  s_add_u32 s58, s22, s39
  s_addc_u32 s59, s23, 0
  s_mov_b64 s[94:95], s[58:59]
  s_mov_b32 m0, s55
  s_nop 0
  global_load_lds_dwordx4 v2, s[94:95] offset:0
  global_load_lds_dwordx4 v3, s[94:95] offset:1024
  global_load_lds_dwordx4 v4, s[94:95] offset:2048
  global_load_lds_dwordx4 v5, s[94:95] offset:3072
  s_add_u32 s94, s94, 65536
  s_addc_u32 s95, s95, 0
  s_add_u32 m0, m0, 4096
  s_nop 0
  global_load_lds_dwordx4 v2, s[94:95] offset:0
  global_load_lds_dwordx4 v3, s[94:95] offset:1024
  global_load_lds_dwordx4 v4, s[94:95] offset:2048
  global_load_lds_dwordx4 v5, s[94:95] offset:3072
  s_waitcnt vmcnt(8)
  ds_read_b64_tr_b16 a[96:97], v14 offset:8192
  ds_read_b64_tr_b16 a[98:99], v14 offset:9216
  ds_read_b64_tr_b16 a[100:101], v15 offset:8192
  ds_read_b64_tr_b16 a[102:103], v15 offset:9216
  ds_read_b64_tr_b16 a[104:105], v11 offset:8192
  ds_read_b64_tr_b16 a[106:107], v11 offset:9216
  ds_read_b64_tr_b16 a[108:109], v13 offset:8192
  ds_read_b64_tr_b16 a[110:111], v13 offset:9216
  ds_read_b64_tr_b16 a[112:113], v14 offset:12288
  ds_read_b64_tr_b16 a[114:115], v14 offset:13312
  ds_read_b64_tr_b16 a[116:117], v15 offset:12288
  ds_read_b64_tr_b16 a[118:119], v15 offset:13312
  ds_read_b64_tr_b16 a[120:121], v11 offset:12288
  ds_read_b64_tr_b16 a[122:123], v11 offset:13312
  ds_read_b64_tr_b16 a[124:125], v13 offset:12288
  ds_read_b64_tr_b16 a[126:127], v13 offset:13312
  s_waitcnt vmcnt(0)
  ds_read_b64_tr_b16 v[32:33], v14 offset:0
  ds_read_b64_tr_b16 v[34:35], v14 offset:1024
  ds_read_b64_tr_b16 v[36:37], v15 offset:0
  ds_read_b64_tr_b16 v[38:39], v15 offset:1024
  ds_read_b64_tr_b16 v[40:41], v11 offset:0
  ds_read_b64_tr_b16 v[42:43], v11 offset:1024
  ds_read_b64_tr_b16 v[44:45], v13 offset:0
  ds_read_b64_tr_b16 v[46:47], v13 offset:1024
  ds_read_b64_tr_b16 v[48:49], v14 offset:4096
  ds_read_b64_tr_b16 v[50:51], v14 offset:5120
  ds_read_b64_tr_b16 v[52:53], v15 offset:4096
  ds_read_b64_tr_b16 v[54:55], v15 offset:5120
  ds_read_b64_tr_b16 v[56:57], v11 offset:4096
  ds_read_b64_tr_b16 v[58:59], v11 offset:5120
  ds_read_b64_tr_b16 v[60:61], v13 offset:4096
  ds_read_b64_tr_b16 v[62:63], v13 offset:5120
  s_add_u32 s55, s48, 0x10000
  v_lshl_add_u32 v11, v0, 4, s55
  s_waitcnt lgkmcnt(0)
  s_barrier
  ds_write_b128 v11, v[32:35] offset:0
  ds_write_b128 v11, v[36:39] offset:1024
  ds_write_b128 v11, v[40:43] offset:2048
  ds_write_b128 v11, v[44:47] offset:3072
  ds_write_b128 v11, v[48:51] offset:4096
  ds_write_b128 v11, v[52:55] offset:5120
  ds_write_b128 v11, v[56:59] offset:6144
  ds_write_b128 v11, v[60:63] offset:7168
  s_cmp_lg_u32 s34, 0
  s_cbranch_scc1 L_FWD24
  v_min_u32 v2, 23, v0
  v_mov_b32 v3, 16
  v_mov_b32 v4, 128
  v_cmp_gt_u32 vcc, 8, v2
  v_lshlrev_b32 v2, 2, v2
  v_cndmask_b32 v3, v3, v4, vcc
  s_mov_b32 s38, 524288
L_FW24:
  s_sub_u32 s38, s38, 1
  s_cbranch_scc1 L_END
  global_load_dword v4, v2, s[28:29] offset:64 sc1
  s_waitcnt vmcnt(0)
  v_cmp_lt_u32 vcc, v4, v3
  s_nop 0
  s_cbranch_vccz L_FWD24
  s_sleep 2
  s_branch L_FW24
L_FWD24:
L_FB_Y:
  s_cmp_lg_u32 s34, 0
  s_cbranch_scc1 S26
  s_add_u32 s39, s53, 160
  v_mov_b32 v2, s39
  s_mov_b32 s38, 524288
W27:
  global_load_dword v3, v2, s[28:29] sc1
  s_waitcnt vmcnt(0)
  v_readfirstlane_b32 s39, v3
  s_cmp_ge_u32 s39, 32
  s_cbranch_scc1 WD28
  s_sleep 1
  s_sub_u32 s38, s38, 1
  s_cbranch_scc1 L_END
  s_branch W27
WD28:
S26:
  s_barrier
  v_lshlrev_b32 v2, 4, v0
  s_lshl_b32 s39, s34, 13
  v_add_u32 v3, s39, v2
  v_add_u32 v4, s39, v2
  v_add_u32 v3, 0x10000, v3
  s_lshl_b32 s39, s34, 10
  v_add_u32 v5, s39, v2
  v_and_b32 v6, 31, v0
  v_lshrrev_b32 v7, 5, v0
  v_lshlrev_b32 v7, 3, v7
  v_lshl_add_u32 v6, v6, 11, v7
  v_and_b32 v7, 0xfff, v5
  s_lshl_b32 s39, s34, 4
  s_lshl_b32 s43, s51, 6
  s_add_u32 s39, s39, s43
  v_add_u32 v6, s39, v6
  s_and_b32 s44, s51, 1
  s_lshl_b32 s44, s44, 3
  s_add_u32 s44, s44, s34
  s_lshl_b32 s44, s44, 14
  s_and_b32 s39, s34, 1
  s_lshl_b32 s39, s39, 10
  v_subrev_u32 v1, s39, v2
  v_add_u32 v1, 1024, v1
  v_add_u32 v2, s39, v2
  s_lshl_b32 s39, s63, 18
  s_add_u32 s39, s39, s44
  s_add_u32 s56, s30, s39
  s_addc_u32 s57, s31, 0
  s_add_u32 s56, s56, 50335744
  s_addc_u32 s57, s57, 0
  s_add_u32 s68, s56, 8192
  s_addc_u32 s69, s57, 0
  s_lshr_b32 s39, s39, 2
  s_add_u32 s58, s30, s39
  s_addc_u32 s59, s31, 0
  s_add_u32 s58, s58, 67108864
  s_addc_u32 s59, s59, 0
  global_load_dwordx4 v[48:51], v2, s[56:57] offset:-4096 sc1
  global_load_dwordx4 v[52:55], v1, s[56:57] offset:-4096 sc1
  global_load_dwordx4 v[56:59], v2, s[56:57] offset:-2048 sc1
  global_load_dwordx4 v[60:63], v1, s[56:57] offset:-2048 sc1
  global_load_dwordx4 v[64:67], v2, s[58:59] offset:0 sc1
  global_load_dwordx4 v[68:71], v2, s[56:57] offset:0 sc1
  global_load_dwordx4 v[72:75], v1, s[56:57] offset:0 sc1
  global_load_dwordx4 v[76:79], v2, s[56:57] offset:2048 sc1
  global_load_dwordx4 v[80:83], v1, s[56:57] offset:2048 sc1
  global_load_dwordx4 v[84:87], v1, s[58:59] offset:0 sc1
  global_load_dwordx4 v[88:91], v2, s[68:69] offset:-4096 sc1
  global_load_dwordx4 v[92:95], v1, s[68:69] offset:-4096 sc1
  global_load_dwordx4 v[96:99], v2, s[68:69] offset:-2048 sc1
  global_load_dwordx4 v[100:103], v1, s[68:69] offset:-2048 sc1
  global_load_dwordx4 v[104:107], v2, s[58:59] offset:2048 sc1
  global_load_dwordx4 v[108:111], v2, s[68:69] offset:0 sc1
  s_mov_b32 s64, 0
L_FS:
  s_waitcnt vmcnt(15)
  v_mfma_f32_32x32x16_bf16 v[16:31], a[0:3], v[48:51], 0
  ds_read_b128 v[112:115], v3 offset:0
  s_waitcnt vmcnt(14)
  v_mfma_f32_32x32x16_bf16 v[16:31], a[8:11], v[52:55], v[16:31]
  s_waitcnt vmcnt(13)
  v_mfma_f32_32x32x16_bf16 v[16:31], a[16:19], v[56:59], v[16:31]
  s_waitcnt vmcnt(12)
  v_mfma_f32_32x32x16_bf16 v[16:31], a[24:27], v[60:63], v[16:31]
  s_waitcnt vmcnt(11) lgkmcnt(0)
  v_mfma_f32_32x32x16_bf16 v[16:31], v[112:115], v[64:67], v[16:31]
  v_mfma_f32_32x32x16_bf16 v[32:47], a[4:7], v[48:51], 0
  global_load_dwordx4 v[48:51], v1, s[68:69] offset:0 sc1
  ds_read_b128 v[116:119], v3 offset:1024
  s_xor_b32 s39, s33, 0
  s_lshl_b32 s39, s39, 4
  s_add_u32 s39, s39, s49
  s_lshl_b32 s39, s39, 12
  s_add_u32 s46, s30, s39
  s_addc_u32 s47, s31, 0
  s_add_u32 s46, s46, 100655104
  s_addc_u32 s47, s47, 0
  global_load_dwordx4 v[120:123], v7, s[46:47] sc1
  s_waitcnt vmcnt(11)
  v_mfma_f32_32x32x16_bf16 v[16:31], a[32:35], v[68:71], v[16:31]
  v_mfma_f32_32x32x16_bf16 v[32:47], a[12:15], v[52:55], v[32:47]
  global_load_dwordx4 v[52:55], v2, s[68:69] offset:2048 sc1
  ds_read_b128 v[112:115], v3 offset:2048
  s_barrier
  s_waitcnt vmcnt(11)
  v_mfma_f32_32x32x16_bf16 v[16:31], a[40:43], v[72:75], v[16:31]
  v_mfma_f32_32x32x16_bf16 v[32:47], a[20:23], v[56:59], v[32:47]
  global_load_dwordx4 v[56:59], v1, s[68:69] offset:2048 sc1
  ds_read_b128 v[12:15], v5
  ds_read_b128 v[8:11], v5 offset:8192
  s_waitcnt vmcnt(11) lgkmcnt(0)
  v_mfma_f32_32x32x16_bf16 v[16:31], a[48:51], v[76:79], v[16:31]
  v_mfma_f32_32x32x16_bf16 v[32:47], a[28:31], v[60:63], v[32:47]
  global_load_dwordx4 v[60:63], v1, s[58:59] offset:2048 sc1
  v_pk_add_f32 v[12:13], v[12:13], v[8:9]
  v_pk_add_f32 v[14:15], v[14:15], v[10:11]
  ds_read_b128 v[8:11], v5 offset:16384
  s_waitcnt vmcnt(11) lgkmcnt(0)
  v_mfma_f32_32x32x16_bf16 v[16:31], a[56:59], v[80:83], v[16:31]
  v_mfma_f32_32x32x16_bf16 v[32:47], v[116:119], v[64:67], v[32:47]
  s_add_u32 s65, s64, 1
  s_cmp_lt_u32 s65, s62
  s_cselect_b32 s65, s65, s64
  s_add_u32 s65, s65, s63
  s_lshl_b32 s39, s65, 18
  s_add_u32 s39, s39, s44
  s_add_u32 s56, s30, s39
  s_addc_u32 s57, s31, 0
  s_add_u32 s56, s56, 50335744
  s_addc_u32 s57, s57, 0
  s_add_u32 s68, s56, 8192
  s_addc_u32 s69, s57, 0
  s_lshr_b32 s39, s39, 2
  s_add_u32 s58, s30, s39
  s_addc_u32 s59, s31, 0
  s_add_u32 s58, s58, 67108864
  s_addc_u32 s59, s59, 0
  global_load_dwordx4 v[64:67], v2, s[56:57] offset:-4096 sc1
  v_pk_add_f32 v[12:13], v[12:13], v[8:9]
  v_pk_add_f32 v[14:15], v[14:15], v[10:11]
  ds_read_b128 v[8:11], v5 offset:24576
  s_waitcnt vmcnt(11) lgkmcnt(0)
  v_mfma_f32_32x32x16_bf16 v[16:31], v[112:115], v[84:87], v[16:31]
  v_mfma_f32_32x32x16_bf16 v[32:47], a[36:39], v[68:71], v[32:47]
  global_load_dwordx4 v[68:71], v1, s[56:57] offset:-4096 sc1
  ds_read_b128 v[116:119], v3 offset:3072
  v_pk_add_f32 v[12:13], v[12:13], v[8:9]
  v_pk_add_f32 v[14:15], v[14:15], v[10:11]
  ds_read_b128 v[8:11], v5 offset:32768
  s_waitcnt vmcnt(11) lgkmcnt(0)
  v_mfma_f32_32x32x16_bf16 v[16:31], a[64:67], v[88:91], v[16:31]
  v_mfma_f32_32x32x16_bf16 v[32:47], a[44:47], v[72:75], v[32:47]
  global_load_dwordx4 v[72:75], v2, s[56:57] offset:-2048 sc1
  ds_read_b128 v[112:115], v3 offset:4096
  v_pk_add_f32 v[12:13], v[12:13], v[8:9]
  v_pk_add_f32 v[14:15], v[14:15], v[10:11]
  ds_read_b128 v[8:11], v5 offset:40960
  s_waitcnt vmcnt(11) lgkmcnt(0)
  v_mfma_f32_32x32x16_bf16 v[16:31], a[72:75], v[92:95], v[16:31]
  v_mfma_f32_32x32x16_bf16 v[32:47], a[52:55], v[76:79], v[32:47]
  global_load_dwordx4 v[76:79], v1, s[56:57] offset:-2048 sc1
  v_pk_add_f32 v[12:13], v[12:13], v[8:9]
  v_pk_add_f32 v[14:15], v[14:15], v[10:11]
  ds_read_b128 v[8:11], v5 offset:49152
  s_waitcnt vmcnt(11) lgkmcnt(0)
  v_mfma_f32_32x32x16_bf16 v[16:31], a[80:83], v[96:99], v[16:31]
  v_mfma_f32_32x32x16_bf16 v[32:47], a[60:63], v[80:83], v[32:47]
  global_load_dwordx4 v[80:83], v2, s[58:59] offset:0 sc1
  v_pk_add_f32 v[12:13], v[12:13], v[8:9]
  v_pk_add_f32 v[14:15], v[14:15], v[10:11]
  ds_read_b128 v[8:11], v5 offset:57344
  s_waitcnt vmcnt(11) lgkmcnt(0)
  v_mfma_f32_32x32x16_bf16 v[16:31], a[88:91], v[100:103], v[16:31]
  v_mfma_f32_32x32x16_bf16 v[32:47], v[116:119], v[84:87], v[32:47]
  global_load_dwordx4 v[84:87], v2, s[56:57] offset:0 sc1
  v_pk_add_f32 v[12:13], v[12:13], v[8:9]
  v_pk_add_f32 v[14:15], v[14:15], v[10:11]
  s_waitcnt vmcnt(11) lgkmcnt(0)
  v_mfma_f32_32x32x16_bf16 v[16:31], v[112:115], v[104:107], v[16:31]
  v_mfma_f32_32x32x16_bf16 v[32:47], a[68:71], v[88:91], v[32:47]
  global_load_dwordx4 v[88:91], v1, s[56:57] offset:0 sc1
  ds_read_b128 v[116:119], v3 offset:5120
  s_cmp_lt_u32 s34, 4
  s_cbranch_scc1 L_FN0
  s_cmp_eq_u32 s64, 0
  s_cbranch_scc1 L_FN0
  s_xor_b32 s39, s33, 1
  s_lshl_b32 s39, s39, 4
  s_add_u32 s39, s39, s49
  s_lshl_b32 s39, s39, 12
  s_add_u32 s60, s30, s39
  s_addc_u32 s61, s31, 0
  s_add_u32 s60, s60, 100659200
  s_addc_u32 s61, s61, 0
  s_cmp_eq_u32 s32, 0
  s_cbranch_scc1 F29
  global_store_dwordx4 v7, v[12:15], s[60:61] sc1
  s_branch E30
F29:
  global_store_dwordx4 v7, v[12:15], s[60:61]
E30:
L_FN0:
  s_waitcnt vmcnt(11)
  v_mfma_f32_32x32x16_bf16 v[16:31], a[96:99], v[108:111], v[16:31]
  v_mfma_f32_32x32x16_bf16 v[32:47], a[76:79], v[92:95], v[32:47]
  global_load_dwordx4 v[92:95], v2, s[56:57] offset:2048 sc1
  ds_read_b128 v[112:115], v3 offset:6144
  s_waitcnt vmcnt(11)
  v_mfma_f32_32x32x16_bf16 v[16:31], a[104:107], v[48:51], v[16:31]
  v_mfma_f32_32x32x16_bf16 v[32:47], a[84:87], v[96:99], v[32:47]
  global_load_dwordx4 v[96:99], v1, s[56:57] offset:2048 sc1
  s_waitcnt vmcnt(11)
  v_mfma_f32_32x32x16_bf16 v[16:31], a[112:115], v[52:55], v[16:31]
  v_mfma_f32_32x32x16_bf16 v[32:47], a[92:95], v[100:103], v[32:47]
  global_load_dwordx4 v[100:103], v1, s[58:59] offset:0 sc1
  s_barrier
  s_waitcnt vmcnt(11) lgkmcnt(0)
  v_mfma_f32_32x32x16_bf16 v[16:31], a[120:123], v[56:59], v[16:31]
  v_mfma_f32_32x32x16_bf16 v[32:47], v[116:119], v[104:107], v[32:47]
  global_load_dwordx4 v[104:107], v2, s[68:69] offset:-4096 sc1
  s_waitcnt vmcnt(11) lgkmcnt(0)
  v_mfma_f32_32x32x16_bf16 v[16:31], v[112:115], v[60:63], v[16:31]
  v_mfma_f32_32x32x16_bf16 v[32:47], a[100:103], v[108:111], v[32:47]
  global_load_dwordx4 v[108:111], v1, s[68:69] offset:-4096 sc1
  ds_read_b128 v[116:119], v3 offset:7168
  s_nop 9
  ds_write_b128 v4, v[16:19] offset:0
  ds_write_b128 v4, v[20:23] offset:1024
  ds_write_b128 v4, v[24:27] offset:2048
  ds_write_b128 v4, v[28:31] offset:3072
  v_mfma_f32_32x32x16_bf16 v[32:47], a[108:111], v[48:51], v[32:47]
  global_load_dwordx4 v[48:51], v2, s[68:69] offset:-2048 sc1
  v_mfma_f32_32x32x16_bf16 v[32:47], a[116:119], v[52:55], v[32:47]
  global_load_dwordx4 v[52:55], v1, s[68:69] offset:-2048 sc1
  v_mfma_f32_32x32x16_bf16 v[32:47], a[124:127], v[56:59], v[32:47]
  global_load_dwordx4 v[56:59], v2, s[58:59] offset:2048 sc1
  s_waitcnt lgkmcnt(4)
  v_mfma_f32_32x32x16_bf16 v[32:47], v[116:119], v[60:63], v[32:47]
  global_load_dwordx4 v[60:63], v2, s[68:69] offset:0 sc1
  s_cmp_ge_u32 s34, 4
  s_cbranch_scc1 L_FA0
  s_cmp_lt_u32 s64, 2
  s_cbranch_scc1 L_FA0
  v_max3_u32 v8, v120, v121, v122
  v_max_u32 v8, v8, v123
  v_cmp_eq_u32 vcc, -1, v8
  s_nop 0
  s_cbranch_vccz PD32
  s_mov_b32 s38, 524288
P31:
  s_sub_u32 s38, s38, 1
  s_cbranch_scc1 L_END
  global_load_dwordx4 v[120:123], v7, s[46:47] sc1
  s_waitcnt vmcnt(0)
  v_max3_u32 v8, v120, v121, v122
  v_max_u32 v8, v8, v123
  v_cmp_eq_u32 vcc, -1, v8
  s_nop 0
  s_cbranch_vccnz P31
PD32:
  s_add_u32 s39, s63, s64
  s_sub_u32 s39, s39, 2
  s_lshl_b32 s39, s39, 16
  s_add_u32 s60, s26, s39
  s_addc_u32 s61, s27, 0
  v_pk_add_f32 v[120:121], v[120:121], v[124:125]
  v_pk_add_f32 v[122:123], v[122:123], v[126:127]
  v_cvt_pk_bf16_f32 v120, v120, v121
  v_cvt_pk_bf16_f32 v121, v122, v123
  global_store_dwordx2 v6, v[120:121], s[60:61]
L_FA0:
  s_add_u32 s64, s64, 1
  s_add_u32 s49, s49, 1
  s_waitcnt lgkmcnt(0)
  s_nop 8
  ds_write_b128 v4, v[32:35] offset:4096
  ds_write_b128 v4, v[36:39] offset:5120
  ds_write_b128 v4, v[40:43] offset:6144
  ds_write_b128 v4, v[44:47] offset:7168
  s_cmp_ge_u32 s64, s62
  s_cbranch_scc1 L_FD
  s_waitcnt vmcnt(15)
  v_mfma_f32_32x32x16_bf16 v[16:31], a[0:3], v[64:67], 0
  ds_read_b128 v[112:115], v3 offset:0
  s_waitcnt vmcnt(14)
  v_mfma_f32_32x32x16_bf16 v[16:31], a[8:11], v[68:71], v[16:31]
  s_waitcnt vmcnt(13)
  v_mfma_f32_32x32x16_bf16 v[16:31], a[16:19], v[72:75], v[16:31]
  s_waitcnt vmcnt(12)
  v_mfma_f32_32x32x16_bf16 v[16:31], a[24:27], v[76:79], v[16:31]
  s_waitcnt vmcnt(11) lgkmcnt(0)
  v_mfma_f32_32x32x16_bf16 v[16:31], v[112:115], v[80:83], v[16:31]
  v_mfma_f32_32x32x16_bf16 v[32:47], a[4:7], v[64:67], 0
  global_load_dwordx4 v[64:67], v1, s[68:69] offset:0 sc1
  ds_read_b128 v[116:119], v3 offset:1024
  s_xor_b32 s39, s33, 0
  s_lshl_b32 s39, s39, 4
  s_add_u32 s39, s39, s49
  s_lshl_b32 s39, s39, 12
  s_add_u32 s46, s30, s39
  s_addc_u32 s47, s31, 0
  s_add_u32 s46, s46, 100655104
  s_addc_u32 s47, s47, 0
  global_load_dwordx4 v[120:123], v7, s[46:47] sc1
  s_waitcnt vmcnt(11)
  v_mfma_f32_32x32x16_bf16 v[16:31], a[32:35], v[84:87], v[16:31]
  v_mfma_f32_32x32x16_bf16 v[32:47], a[12:15], v[68:71], v[32:47]
  global_load_dwordx4 v[68:71], v2, s[68:69] offset:2048 sc1
  ds_read_b128 v[112:115], v3 offset:2048
  s_barrier
  s_waitcnt vmcnt(11)
  v_mfma_f32_32x32x16_bf16 v[16:31], a[40:43], v[88:91], v[16:31]
  v_mfma_f32_32x32x16_bf16 v[32:47], a[20:23], v[72:75], v[32:47]
  global_load_dwordx4 v[72:75], v1, s[68:69] offset:2048 sc1
  ds_read_b128 v[124:127], v5
  ds_read_b128 v[8:11], v5 offset:8192
  s_waitcnt vmcnt(11) lgkmcnt(0)
  v_mfma_f32_32x32x16_bf16 v[16:31], a[48:51], v[92:95], v[16:31]
  v_mfma_f32_32x32x16_bf16 v[32:47], a[28:31], v[76:79], v[32:47]
  global_load_dwordx4 v[76:79], v1, s[58:59] offset:2048 sc1
  v_pk_add_f32 v[124:125], v[124:125], v[8:9]
  v_pk_add_f32 v[126:127], v[126:127], v[10:11]
  ds_read_b128 v[8:11], v5 offset:16384
  s_waitcnt vmcnt(11) lgkmcnt(0)
  v_mfma_f32_32x32x16_bf16 v[16:31], a[56:59], v[96:99], v[16:31]
  v_mfma_f32_32x32x16_bf16 v[32:47], v[116:119], v[80:83], v[32:47]
  s_add_u32 s65, s64, 1
  s_cmp_lt_u32 s65, s62
  s_cselect_b32 s65, s65, s64
  s_add_u32 s65, s65, s63
  s_lshl_b32 s39, s65, 18
  s_add_u32 s39, s39, s44
  s_add_u32 s56, s30, s39
  s_addc_u32 s57, s31, 0
  s_add_u32 s56, s56, 50335744
  s_addc_u32 s57, s57, 0
  s_add_u32 s68, s56, 8192
  s_addc_u32 s69, s57, 0
  s_lshr_b32 s39, s39, 2
  s_add_u32 s58, s30, s39
  s_addc_u32 s59, s31, 0
  s_add_u32 s58, s58, 67108864
  s_addc_u32 s59, s59, 0
  global_load_dwordx4 v[80:83], v2, s[56:57] offset:-4096 sc1
  v_pk_add_f32 v[124:125], v[124:125], v[8:9]
  v_pk_add_f32 v[126:127], v[126:127], v[10:11]
  ds_read_b128 v[8:11], v5 offset:24576
  s_waitcnt vmcnt(11) lgkmcnt(0)
  v_mfma_f32_32x32x16_bf16 v[16:31], v[112:115], v[100:103], v[16:31]
  v_mfma_f32_32x32x16_bf16 v[32:47], a[36:39], v[84:87], v[32:47]
  global_load_dwordx4 v[84:87], v1, s[56:57] offset:-4096 sc1
  ds_read_b128 v[116:119], v3 offset:3072
  v_pk_add_f32 v[124:125], v[124:125], v[8:9]
  v_pk_add_f32 v[126:127], v[126:127], v[10:11]
  ds_read_b128 v[8:11], v5 offset:32768
  s_waitcnt vmcnt(11) lgkmcnt(0)
  v_mfma_f32_32x32x16_bf16 v[16:31], a[64:67], v[104:107], v[16:31]
  v_mfma_f32_32x32x16_bf16 v[32:47], a[44:47], v[88:91], v[32:47]
  global_load_dwordx4 v[88:91], v2, s[56:57] offset:-2048 sc1
  ds_read_b128 v[112:115], v3 offset:4096
  v_pk_add_f32 v[124:125], v[124:125], v[8:9]
  v_pk_add_f32 v[126:127], v[126:127], v[10:11]
  ds_read_b128 v[8:11], v5 offset:40960
  s_waitcnt vmcnt(11) lgkmcnt(0)
  v_mfma_f32_32x32x16_bf16 v[16:31], a[72:75], v[108:111], v[16:31]
  v_mfma_f32_32x32x16_bf16 v[32:47], a[52:55], v[92:95], v[32:47]
  global_load_dwordx4 v[92:95], v1, s[56:57] offset:-2048 sc1
  v_pk_add_f32 v[124:125], v[124:125], v[8:9]
  v_pk_add_f32 v[126:127], v[126:127], v[10:11]
  ds_read_b128 v[8:11], v5 offset:49152
  s_waitcnt vmcnt(11) lgkmcnt(0)
  v_mfma_f32_32x32x16_bf16 v[16:31], a[80:83], v[48:51], v[16:31]
  v_mfma_f32_32x32x16_bf16 v[32:47], a[60:63], v[96:99], v[32:47]
  global_load_dwordx4 v[96:99], v2, s[58:59] offset:0 sc1
  v_pk_add_f32 v[124:125], v[124:125], v[8:9]
  v_pk_add_f32 v[126:127], v[126:127], v[10:11]
  ds_read_b128 v[8:11], v5 offset:57344
  s_waitcnt vmcnt(11) lgkmcnt(0)
  v_mfma_f32_32x32x16_bf16 v[16:31], a[88:91], v[52:55], v[16:31]
  v_mfma_f32_32x32x16_bf16 v[32:47], v[116:119], v[100:103], v[32:47]
  global_load_dwordx4 v[100:103], v2, s[56:57] offset:0 sc1
  v_pk_add_f32 v[124:125], v[124:125], v[8:9]
  v_pk_add_f32 v[126:127], v[126:127], v[10:11]
  s_waitcnt vmcnt(11) lgkmcnt(0)
  v_mfma_f32_32x32x16_bf16 v[16:31], v[112:115], v[56:59], v[16:31]
  v_mfma_f32_32x32x16_bf16 v[32:47], a[68:71], v[104:107], v[32:47]
  global_load_dwordx4 v[104:107], v1, s[56:57] offset:0 sc1
  ds_read_b128 v[116:119], v3 offset:5120
  s_cmp_lt_u32 s34, 4
  s_cbranch_scc1 L_FN1
  s_cmp_eq_u32 s64, 0
  s_cbranch_scc1 L_FN1
  s_xor_b32 s39, s33, 1
  s_lshl_b32 s39, s39, 4
  s_add_u32 s39, s39, s49
  s_lshl_b32 s39, s39, 12
  s_add_u32 s60, s30, s39
  s_addc_u32 s61, s31, 0
  s_add_u32 s60, s60, 100659200
  s_addc_u32 s61, s61, 0
  s_cmp_eq_u32 s32, 0
  s_cbranch_scc1 F33
  global_store_dwordx4 v7, v[124:127], s[60:61] sc1
  s_branch E34
F33:
  global_store_dwordx4 v7, v[124:127], s[60:61]
E34:
L_FN1:
  s_waitcnt vmcnt(11)
  v_mfma_f32_32x32x16_bf16 v[16:31], a[96:99], v[60:63], v[16:31]
  v_mfma_f32_32x32x16_bf16 v[32:47], a[76:79], v[108:111], v[32:47]
  global_load_dwordx4 v[108:111], v2, s[56:57] offset:2048 sc1
  ds_read_b128 v[112:115], v3 offset:6144
  s_waitcnt vmcnt(11)
  v_mfma_f32_32x32x16_bf16 v[16:31], a[104:107], v[64:67], v[16:31]
  v_mfma_f32_32x32x16_bf16 v[32:47], a[84:87], v[48:51], v[32:47]
  global_load_dwordx4 v[48:51], v1, s[56:57] offset:2048 sc1
  s_waitcnt vmcnt(11)
  v_mfma_f32_32x32x16_bf16 v[16:31], a[112:115], v[68:71], v[16:31]
  v_mfma_f32_32x32x16_bf16 v[32:47], a[92:95], v[52:55], v[32:47]
  global_load_dwordx4 v[52:55], v1, s[58:59] offset:0 sc1
  s_barrier
  s_waitcnt vmcnt(11) lgkmcnt(0)
  v_mfma_f32_32x32x16_bf16 v[16:31], a[120:123], v[72:75], v[16:31]
  v_mfma_f32_32x32x16_bf16 v[32:47], v[116:119], v[56:59], v[32:47]
  global_load_dwordx4 v[56:59], v2, s[68:69] offset:-4096 sc1
  s_waitcnt vmcnt(11) lgkmcnt(0)
  v_mfma_f32_32x32x16_bf16 v[16:31], v[112:115], v[76:79], v[16:31]
  v_mfma_f32_32x32x16_bf16 v[32:47], a[100:103], v[60:63], v[32:47]
  global_load_dwordx4 v[60:63], v1, s[68:69] offset:-4096 sc1
  ds_read_b128 v[116:119], v3 offset:7168
  s_nop 9
  ds_write_b128 v4, v[16:19] offset:0
  ds_write_b128 v4, v[20:23] offset:1024
  ds_write_b128 v4, v[24:27] offset:2048
  ds_write_b128 v4, v[28:31] offset:3072
  v_mfma_f32_32x32x16_bf16 v[32:47], a[108:111], v[64:67], v[32:47]
  global_load_dwordx4 v[64:67], v2, s[68:69] offset:-2048 sc1
  v_mfma_f32_32x32x16_bf16 v[32:47], a[116:119], v[68:71], v[32:47]
  global_load_dwordx4 v[68:71], v1, s[68:69] offset:-2048 sc1
  v_mfma_f32_32x32x16_bf16 v[32:47], a[124:127], v[72:75], v[32:47]
  global_load_dwordx4 v[72:75], v2, s[58:59] offset:2048 sc1
  s_waitcnt lgkmcnt(4)
  v_mfma_f32_32x32x16_bf16 v[32:47], v[116:119], v[76:79], v[32:47]
  global_load_dwordx4 v[76:79], v2, s[68:69] offset:0 sc1
  s_cmp_ge_u32 s34, 4
  s_cbranch_scc1 L_FA1
  s_cmp_lt_u32 s64, 2
  s_cbranch_scc1 L_FA1
  v_max3_u32 v8, v120, v121, v122
  v_max_u32 v8, v8, v123
  v_cmp_eq_u32 vcc, -1, v8
  s_nop 0
  s_cbranch_vccz PD36
  s_mov_b32 s38, 524288
P35:
  s_sub_u32 s38, s38, 1
  s_cbranch_scc1 L_END
  global_load_dwordx4 v[120:123], v7, s[46:47] sc1
  s_waitcnt vmcnt(0)
  v_max3_u32 v8, v120, v121, v122
  v_max_u32 v8, v8, v123
  v_cmp_eq_u32 vcc, -1, v8
  s_nop 0
  s_cbranch_vccnz P35
PD36:
  s_add_u32 s39, s63, s64
  s_sub_u32 s39, s39, 2
  s_lshl_b32 s39, s39, 16
  s_add_u32 s60, s26, s39
  s_addc_u32 s61, s27, 0
  v_pk_add_f32 v[120:121], v[120:121], v[12:13]
  v_pk_add_f32 v[122:123], v[122:123], v[14:15]
  v_cvt_pk_bf16_f32 v120, v120, v121
  v_cvt_pk_bf16_f32 v121, v122, v123
  global_store_dwordx2 v6, v[120:121], s[60:61]
L_FA1:
  s_add_u32 s64, s64, 1
  s_add_u32 s49, s49, 1
  s_waitcnt lgkmcnt(0)
  s_nop 8
  ds_write_b128 v4, v[32:35] offset:4096
  ds_write_b128 v4, v[36:39] offset:5120
  ds_write_b128 v4, v[40:43] offset:6144
  ds_write_b128 v4, v[44:47] offset:7168
  s_cmp_lt_u32 s64, s62
  s_cbranch_scc1 L_FC
  v_mov_b32 v12, v124
  v_mov_b32 v13, v125
  v_mov_b32 v14, v126
  v_mov_b32 v15, v127
  s_branch L_FD
L_FC:
  s_waitcnt vmcnt(15)
  v_mfma_f32_32x32x16_bf16 v[16:31], a[0:3], v[80:83], 0
  ds_read_b128 v[112:115], v3 offset:0
  s_waitcnt vmcnt(14)
  v_mfma_f32_32x32x16_bf16 v[16:31], a[8:11], v[84:87], v[16:31]
  s_waitcnt vmcnt(13)
  v_mfma_f32_32x32x16_bf16 v[16:31], a[16:19], v[88:91], v[16:31]
  s_waitcnt vmcnt(12)
  v_mfma_f32_32x32x16_bf16 v[16:31], a[24:27], v[92:95], v[16:31]
  s_waitcnt vmcnt(11) lgkmcnt(0)
  v_mfma_f32_32x32x16_bf16 v[16:31], v[112:115], v[96:99], v[16:31]
  v_mfma_f32_32x32x16_bf16 v[32:47], a[4:7], v[80:83], 0
  global_load_dwordx4 v[80:83], v1, s[68:69] offset:0 sc1
  ds_read_b128 v[116:119], v3 offset:1024
  s_xor_b32 s39, s33, 0
  s_lshl_b32 s39, s39, 4
  s_add_u32 s39, s39, s49
  s_lshl_b32 s39, s39, 12
  s_add_u32 s46, s30, s39
  s_addc_u32 s47, s31, 0
  s_add_u32 s46, s46, 100655104
  s_addc_u32 s47, s47, 0
  global_load_dwordx4 v[120:123], v7, s[46:47] sc1
  s_waitcnt vmcnt(11)
  v_mfma_f32_32x32x16_bf16 v[16:31], a[32:35], v[100:103], v[16:31]
  v_mfma_f32_32x32x16_bf16 v[32:47], a[12:15], v[84:87], v[32:47]
  global_load_dwordx4 v[84:87], v2, s[68:69] offset:2048 sc1
  ds_read_b128 v[112:115], v3 offset:2048
  s_barrier
  s_waitcnt vmcnt(11)
  v_mfma_f32_32x32x16_bf16 v[16:31], a[40:43], v[104:107], v[16:31]
  v_mfma_f32_32x32x16_bf16 v[32:47], a[20:23], v[88:91], v[32:47]
  global_load_dwordx4 v[88:91], v1, s[68:69] offset:2048 sc1
  ds_read_b128 v[12:15], v5
  ds_read_b128 v[8:11], v5 offset:8192
  s_waitcnt vmcnt(11) lgkmcnt(0)
  v_mfma_f32_32x32x16_bf16 v[16:31], a[48:51], v[108:111], v[16:31]
  v_mfma_f32_32x32x16_bf16 v[32:47], a[28:31], v[92:95], v[32:47]
  global_load_dwordx4 v[92:95], v1, s[58:59] offset:2048 sc1
  v_pk_add_f32 v[12:13], v[12:13], v[8:9]
  v_pk_add_f32 v[14:15], v[14:15], v[10:11]
  ds_read_b128 v[8:11], v5 offset:16384
  s_waitcnt vmcnt(11) lgkmcnt(0)
  v_mfma_f32_32x32x16_bf16 v[16:31], a[56:59], v[48:51], v[16:31]
  v_mfma_f32_32x32x16_bf16 v[32:47], v[116:119], v[96:99], v[32:47]
  s_add_u32 s65, s64, 1
  s_cmp_lt_u32 s65, s62
  s_cselect_b32 s65, s65, s64
  s_add_u32 s65, s65, s63
  s_lshl_b32 s39, s65, 18
  s_add_u32 s39, s39, s44
  s_add_u32 s56, s30, s39
  s_addc_u32 s57, s31, 0
  s_add_u32 s56, s56, 50335744
  s_addc_u32 s57, s57, 0
  s_add_u32 s68, s56, 8192
  s_addc_u32 s69, s57, 0
  s_lshr_b32 s39, s39, 2
  s_add_u32 s58, s30, s39
  s_addc_u32 s59, s31, 0
  s_add_u32 s58, s58, 67108864
  s_addc_u32 s59, s59, 0
  global_load_dwordx4 v[96:99], v2, s[56:57] offset:-4096 sc1
  v_pk_add_f32 v[12:13], v[12:13], v[8:9]
  v_pk_add_f32 v[14:15], v[14:15], v[10:11]
  ds_read_b128 v[8:11], v5 offset:24576
  s_waitcnt vmcnt(11) lgkmcnt(0)
  v_mfma_f32_32x32x16_bf16 v[16:31], v[112:115], v[52:55], v[16:31]
  v_mfma_f32_32x32x16_bf16 v[32:47], a[36:39], v[100:103], v[32:47]
  global_load_dwordx4 v[100:103], v1, s[56:57] offset:-4096 sc1
  ds_read_b128 v[116:119], v3 offset:3072
  v_pk_add_f32 v[12:13], v[12:13], v[8:9]
  v_pk_add_f32 v[14:15], v[14:15], v[10:11]
  ds_read_b128 v[8:11], v5 offset:32768
  s_waitcnt vmcnt(11) lgkmcnt(0)
  v_mfma_f32_32x32x16_bf16 v[16:31], a[64:67], v[56:59], v[16:31]
  v_mfma_f32_32x32x16_bf16 v[32:47], a[44:47], v[104:107], v[32:47]
  global_load_dwordx4 v[104:107], v2, s[56:57] offset:-2048 sc1
  ds_read_b128 v[112:115], v3 offset:4096
  v_pk_add_f32 v[12:13], v[12:13], v[8:9]
  v_pk_add_f32 v[14:15], v[14:15], v[10:11]
  ds_read_b128 v[8:11], v5 offset:40960
  s_waitcnt vmcnt(11) lgkmcnt(0)
  v_mfma_f32_32x32x16_bf16 v[16:31], a[72:75], v[60:63], v[16:31]
  v_mfma_f32_32x32x16_bf16 v[32:47], a[52:55], v[108:111], v[32:47]
  global_load_dwordx4 v[108:111], v1, s[56:57] offset:-2048 sc1
  v_pk_add_f32 v[12:13], v[12:13], v[8:9]
  v_pk_add_f32 v[14:15], v[14:15], v[10:11]
  ds_read_b128 v[8:11], v5 offset:49152
  s_waitcnt vmcnt(11) lgkmcnt(0)
  v_mfma_f32_32x32x16_bf16 v[16:31], a[80:83], v[64:67], v[16:31]
  v_mfma_f32_32x32x16_bf16 v[32:47], a[60:63], v[48:51], v[32:47]
  global_load_dwordx4 v[48:51], v2, s[58:59] offset:0 sc1
  v_pk_add_f32 v[12:13], v[12:13], v[8:9]
  v_pk_add_f32 v[14:15], v[14:15], v[10:11]
  ds_read_b128 v[8:11], v5 offset:57344
  s_waitcnt vmcnt(11) lgkmcnt(0)
  v_mfma_f32_32x32x16_bf16 v[16:31], a[88:91], v[68:71], v[16:31]
  v_mfma_f32_32x32x16_bf16 v[32:47], v[116:119], v[52:55], v[32:47]
  global_load_dwordx4 v[52:55], v2, s[56:57] offset:0 sc1
  v_pk_add_f32 v[12:13], v[12:13], v[8:9]
  v_pk_add_f32 v[14:15], v[14:15], v[10:11]
  s_waitcnt vmcnt(11) lgkmcnt(0)
  v_mfma_f32_32x32x16_bf16 v[16:31], v[112:115], v[72:75], v[16:31]
  v_mfma_f32_32x32x16_bf16 v[32:47], a[68:71], v[56:59], v[32:47]
  global_load_dwordx4 v[56:59], v1, s[56:57] offset:0 sc1
  ds_read_b128 v[116:119], v3 offset:5120
  s_cmp_lt_u32 s34, 4
  s_cbranch_scc1 L_FN2
  s_cmp_eq_u32 s64, 0
  s_cbranch_scc1 L_FN2
  s_xor_b32 s39, s33, 1
  s_lshl_b32 s39, s39, 4
  s_add_u32 s39, s39, s49
  s_lshl_b32 s39, s39, 12
  s_add_u32 s60, s30, s39
  s_addc_u32 s61, s31, 0
  s_add_u32 s60, s60, 100659200
  s_addc_u32 s61, s61, 0
  s_cmp_eq_u32 s32, 0
  s_cbranch_scc1 F37
  global_store_dwordx4 v7, v[12:15], s[60:61] sc1
  s_branch E38
F37:
  global_store_dwordx4 v7, v[12:15], s[60:61]
E38:
L_FN2:
  s_waitcnt vmcnt(11)
  v_mfma_f32_32x32x16_bf16 v[16:31], a[96:99], v[76:79], v[16:31]
  v_mfma_f32_32x32x16_bf16 v[32:47], a[76:79], v[60:63], v[32:47]
  global_load_dwordx4 v[60:63], v2, s[56:57] offset:2048 sc1
  ds_read_b128 v[112:115], v3 offset:6144
  s_waitcnt vmcnt(11)
  v_mfma_f32_32x32x16_bf16 v[16:31], a[104:107], v[80:83], v[16:31]
  v_mfma_f32_32x32x16_bf16 v[32:47], a[84:87], v[64:67], v[32:47]
  global_load_dwordx4 v[64:67], v1, s[56:57] offset:2048 sc1
  s_waitcnt vmcnt(11)
  v_mfma_f32_32x32x16_bf16 v[16:31], a[112:115], v[84:87], v[16:31]
  v_mfma_f32_32x32x16_bf16 v[32:47], a[92:95], v[68:71], v[32:47]
  global_load_dwordx4 v[68:71], v1, s[58:59] offset:0 sc1
  s_barrier
  s_waitcnt vmcnt(11) lgkmcnt(0)
  v_mfma_f32_32x32x16_bf16 v[16:31], a[120:123], v[88:91], v[16:31]
  v_mfma_f32_32x32x16_bf16 v[32:47], v[116:119], v[72:75], v[32:47]
  global_load_dwordx4 v[72:75], v2, s[68:69] offset:-4096 sc1
  s_waitcnt vmcnt(11) lgkmcnt(0)
  v_mfma_f32_32x32x16_bf16 v[16:31], v[112:115], v[92:95], v[16:31]
  v_mfma_f32_32x32x16_bf16 v[32:47], a[100:103], v[76:79], v[32:47]
  global_load_dwordx4 v[76:79], v1, s[68:69] offset:-4096 sc1
  ds_read_b128 v[116:119], v3 offset:7168
  s_nop 9
  ds_write_b128 v4, v[16:19] offset:0
  ds_write_b128 v4, v[20:23] offset:1024
  ds_write_b128 v4, v[24:27] offset:2048
  ds_write_b128 v4, v[28:31] offset:3072
  v_mfma_f32_32x32x16_bf16 v[32:47], a[108:111], v[80:83], v[32:47]
  global_load_dwordx4 v[80:83], v2, s[68:69] offset:-2048 sc1
  v_mfma_f32_32x32x16_bf16 v[32:47], a[116:119], v[84:87], v[32:47]
  global_load_dwordx4 v[84:87], v1, s[68:69] offset:-2048 sc1
  v_mfma_f32_32x32x16_bf16 v[32:47], a[124:127], v[88:91], v[32:47]
  global_load_dwordx4 v[88:91], v2, s[58:59] offset:2048 sc1
  s_waitcnt lgkmcnt(4)
  v_mfma_f32_32x32x16_bf16 v[32:47], v[116:119], v[92:95], v[32:47]
  global_load_dwordx4 v[92:95], v2, s[68:69] offset:0 sc1
  s_cmp_ge_u32 s34, 4
  s_cbranch_scc1 L_FA2
  s_cmp_lt_u32 s64, 2
  s_cbranch_scc1 L_FA2
  v_max3_u32 v8, v120, v121, v122
  v_max_u32 v8, v8, v123
  v_cmp_eq_u32 vcc, -1, v8
  s_nop 0
  s_cbranch_vccz PD40
  s_mov_b32 s38, 524288
P39:
  s_sub_u32 s38, s38, 1
  s_cbranch_scc1 L_END
  global_load_dwordx4 v[120:123], v7, s[46:47] sc1
  s_waitcnt vmcnt(0)
  v_max3_u32 v8, v120, v121, v122
  v_max_u32 v8, v8, v123
  v_cmp_eq_u32 vcc, -1, v8
  s_nop 0
  s_cbranch_vccnz P39
PD40:
  s_add_u32 s39, s63, s64
  s_sub_u32 s39, s39, 2
  s_lshl_b32 s39, s39, 16
  s_add_u32 s60, s26, s39
  s_addc_u32 s61, s27, 0
  v_pk_add_f32 v[120:121], v[120:121], v[124:125]
  v_pk_add_f32 v[122:123], v[122:123], v[126:127]
  v_cvt_pk_bf16_f32 v120, v120, v121
  v_cvt_pk_bf16_f32 v121, v122, v123
  global_store_dwordx2 v6, v[120:121], s[60:61]
L_FA2:
  s_add_u32 s64, s64, 1
  s_add_u32 s49, s49, 1
  s_waitcnt lgkmcnt(0)
  s_nop 8
  ds_write_b128 v4, v[32:35] offset:4096
  ds_write_b128 v4, v[36:39] offset:5120
  ds_write_b128 v4, v[40:43] offset:6144
  ds_write_b128 v4, v[44:47] offset:7168
  s_cmp_ge_u32 s64, s62
  s_cbranch_scc1 L_FD
  s_waitcnt vmcnt(15)
  v_mfma_f32_32x32x16_bf16 v[16:31], a[0:3], v[96:99], 0
  ds_read_b128 v[112:115], v3 offset:0
  s_waitcnt vmcnt(14)
  v_mfma_f32_32x32x16_bf16 v[16:31], a[8:11], v[100:103], v[16:31]
  s_waitcnt vmcnt(13)
  v_mfma_f32_32x32x16_bf16 v[16:31], a[16:19], v[104:107], v[16:31]
  s_waitcnt vmcnt(12)
  v_mfma_f32_32x32x16_bf16 v[16:31], a[24:27], v[108:111], v[16:31]
  s_waitcnt vmcnt(11) lgkmcnt(0)
  v_mfma_f32_32x32x16_bf16 v[16:31], v[112:115], v[48:51], v[16:31]
  v_mfma_f32_32x32x16_bf16 v[32:47], a[4:7], v[96:99], 0
  global_load_dwordx4 v[96:99], v1, s[68:69] offset:0 sc1
  ds_read_b128 v[116:119], v3 offset:1024
  s_xor_b32 s39, s33, 0
  s_lshl_b32 s39, s39, 4
  s_add_u32 s39, s39, s49
  s_lshl_b32 s39, s39, 12
  s_add_u32 s46, s30, s39
  s_addc_u32 s47, s31, 0
  s_add_u32 s46, s46, 100655104
  s_addc_u32 s47, s47, 0
  global_load_dwordx4 v[120:123], v7, s[46:47] sc1
  s_waitcnt vmcnt(11)
  v_mfma_f32_32x32x16_bf16 v[16:31], a[32:35], v[52:55], v[16:31]
  v_mfma_f32_32x32x16_bf16 v[32:47], a[12:15], v[100:103], v[32:47]
  global_load_dwordx4 v[100:103], v2, s[68:69] offset:2048 sc1
  ds_read_b128 v[112:115], v3 offset:2048
  s_barrier
  s_waitcnt vmcnt(11)
  v_mfma_f32_32x32x16_bf16 v[16:31], a[40:43], v[56:59], v[16:31]
  v_mfma_f32_32x32x16_bf16 v[32:47], a[20:23], v[104:107], v[32:47]
  global_load_dwordx4 v[104:107], v1, s[68:69] offset:2048 sc1
  ds_read_b128 v[124:127], v5
  ds_read_b128 v[8:11], v5 offset:8192
  s_waitcnt vmcnt(11) lgkmcnt(0)
  v_mfma_f32_32x32x16_bf16 v[16:31], a[48:51], v[60:63], v[16:31]
  v_mfma_f32_32x32x16_bf16 v[32:47], a[28:31], v[108:111], v[32:47]
  global_load_dwordx4 v[108:111], v1, s[58:59] offset:2048 sc1
  v_pk_add_f32 v[124:125], v[124:125], v[8:9]
  v_pk_add_f32 v[126:127], v[126:127], v[10:11]
  ds_read_b128 v[8:11], v5 offset:16384
  s_waitcnt vmcnt(11) lgkmcnt(0)
  v_mfma_f32_32x32x16_bf16 v[16:31], a[56:59], v[64:67], v[16:31]
  v_mfma_f32_32x32x16_bf16 v[32:47], v[116:119], v[48:51], v[32:47]
  s_add_u32 s65, s64, 1
  s_cmp_lt_u32 s65, s62
  s_cselect_b32 s65, s65, s64
  s_add_u32 s65, s65, s63
  s_lshl_b32 s39, s65, 18
  s_add_u32 s39, s39, s44
  s_add_u32 s56, s30, s39
  s_addc_u32 s57, s31, 0
  s_add_u32 s56, s56, 50335744
  s_addc_u32 s57, s57, 0
  s_add_u32 s68, s56, 8192
  s_addc_u32 s69, s57, 0
  s_lshr_b32 s39, s39, 2
  s_add_u32 s58, s30, s39
  s_addc_u32 s59, s31, 0
  s_add_u32 s58, s58, 67108864
  s_addc_u32 s59, s59, 0
  global_load_dwordx4 v[48:51], v2, s[56:57] offset:-4096 sc1
  v_pk_add_f32 v[124:125], v[124:125], v[8:9]
  v_pk_add_f32 v[126:127], v[126:127], v[10:11]
  ds_read_b128 v[8:11], v5 offset:24576
  s_waitcnt vmcnt(11) lgkmcnt(0)
  v_mfma_f32_32x32x16_bf16 v[16:31], v[112:115], v[68:71], v[16:31]
  v_mfma_f32_32x32x16_bf16 v[32:47], a[36:39], v[52:55], v[32:47]
  global_load_dwordx4 v[52:55], v1, s[56:57] offset:-4096 sc1
  ds_read_b128 v[116:119], v3 offset:3072
  v_pk_add_f32 v[124:125], v[124:125], v[8:9]
  v_pk_add_f32 v[126:127], v[126:127], v[10:11]
  ds_read_b128 v[8:11], v5 offset:32768
  s_waitcnt vmcnt(11) lgkmcnt(0)
  v_mfma_f32_32x32x16_bf16 v[16:31], a[64:67], v[72:75], v[16:31]
  v_mfma_f32_32x32x16_bf16 v[32:47], a[44:47], v[56:59], v[32:47]
  global_load_dwordx4 v[56:59], v2, s[56:57] offset:-2048 sc1
  ds_read_b128 v[112:115], v3 offset:4096
  v_pk_add_f32 v[124:125], v[124:125], v[8:9]
  v_pk_add_f32 v[126:127], v[126:127], v[10:11]
  ds_read_b128 v[8:11], v5 offset:40960
  s_waitcnt vmcnt(11) lgkmcnt(0)
  v_mfma_f32_32x32x16_bf16 v[16:31], a[72:75], v[76:79], v[16:31]
  v_mfma_f32_32x32x16_bf16 v[32:47], a[52:55], v[60:63], v[32:47]
  global_load_dwordx4 v[60:63], v1, s[56:57] offset:-2048 sc1
  v_pk_add_f32 v[124:125], v[124:125], v[8:9]
  v_pk_add_f32 v[126:127], v[126:127], v[10:11]
  ds_read_b128 v[8:11], v5 offset:49152
  s_waitcnt vmcnt(11) lgkmcnt(0)
  v_mfma_f32_32x32x16_bf16 v[16:31], a[80:83], v[80:83], v[16:31]
  v_mfma_f32_32x32x16_bf16 v[32:47], a[60:63], v[64:67], v[32:47]
  global_load_dwordx4 v[64:67], v2, s[58:59] offset:0 sc1
  v_pk_add_f32 v[124:125], v[124:125], v[8:9]
  v_pk_add_f32 v[126:127], v[126:127], v[10:11]
  ds_read_b128 v[8:11], v5 offset:57344
  s_waitcnt vmcnt(11) lgkmcnt(0)
  v_mfma_f32_32x32x16_bf16 v[16:31], a[88:91], v[84:87], v[16:31]
  v_mfma_f32_32x32x16_bf16 v[32:47], v[116:119], v[68:71], v[32:47]
  global_load_dwordx4 v[68:71], v2, s[56:57] offset:0 sc1
  v_pk_add_f32 v[124:125], v[124:125], v[8:9]
  v_pk_add_f32 v[126:127], v[126:127], v[10:11]
  s_waitcnt vmcnt(11) lgkmcnt(0)
  v_mfma_f32_32x32x16_bf16 v[16:31], v[112:115], v[88:91], v[16:31]
  v_mfma_f32_32x32x16_bf16 v[32:47], a[68:71], v[72:75], v[32:47]
  global_load_dwordx4 v[72:75], v1, s[56:57] offset:0 sc1
  ds_read_b128 v[116:119], v3 offset:5120
  s_cmp_lt_u32 s34, 4
  s_cbranch_scc1 L_FN3
  s_cmp_eq_u32 s64, 0
  s_cbranch_scc1 L_FN3
  s_xor_b32 s39, s33, 1
  s_lshl_b32 s39, s39, 4
  s_add_u32 s39, s39, s49
  s_lshl_b32 s39, s39, 12
  s_add_u32 s60, s30, s39
  s_addc_u32 s61, s31, 0
  s_add_u32 s60, s60, 100659200
  s_addc_u32 s61, s61, 0
  s_cmp_eq_u32 s32, 0
  s_cbranch_scc1 F41
  global_store_dwordx4 v7, v[124:127], s[60:61] sc1
  s_branch E42
F41:
  global_store_dwordx4 v7, v[124:127], s[60:61]
E42:
L_FN3:
  s_waitcnt vmcnt(11)
  v_mfma_f32_32x32x16_bf16 v[16:31], a[96:99], v[92:95], v[16:31]
  v_mfma_f32_32x32x16_bf16 v[32:47], a[76:79], v[76:79], v[32:47]
  global_load_dwordx4 v[76:79], v2, s[56:57] offset:2048 sc1
  ds_read_b128 v[112:115], v3 offset:6144
  s_waitcnt vmcnt(11)
  v_mfma_f32_32x32x16_bf16 v[16:31], a[104:107], v[96:99], v[16:31]
  v_mfma_f32_32x32x16_bf16 v[32:47], a[84:87], v[80:83], v[32:47]
  global_load_dwordx4 v[80:83], v1, s[56:57] offset:2048 sc1
  s_waitcnt vmcnt(11)
  v_mfma_f32_32x32x16_bf16 v[16:31], a[112:115], v[100:103], v[16:31]
  v_mfma_f32_32x32x16_bf16 v[32:47], a[92:95], v[84:87], v[32:47]
  global_load_dwordx4 v[84:87], v1, s[58:59] offset:0 sc1
  s_barrier
  s_waitcnt vmcnt(11) lgkmcnt(0)
  v_mfma_f32_32x32x16_bf16 v[16:31], a[120:123], v[104:107], v[16:31]
  v_mfma_f32_32x32x16_bf16 v[32:47], v[116:119], v[88:91], v[32:47]
  global_load_dwordx4 v[88:91], v2, s[68:69] offset:-4096 sc1
  s_waitcnt vmcnt(11) lgkmcnt(0)
  v_mfma_f32_32x32x16_bf16 v[16:31], v[112:115], v[108:111], v[16:31]
  v_mfma_f32_32x32x16_bf16 v[32:47], a[100:103], v[92:95], v[32:47]
  global_load_dwordx4 v[92:95], v1, s[68:69] offset:-4096 sc1
  ds_read_b128 v[116:119], v3 offset:7168
  s_nop 9
  ds_write_b128 v4, v[16:19] offset:0
  ds_write_b128 v4, v[20:23] offset:1024
  ds_write_b128 v4, v[24:27] offset:2048
  ds_write_b128 v4, v[28:31] offset:3072
  v_mfma_f32_32x32x16_bf16 v[32:47], a[108:111], v[96:99], v[32:47]
  global_load_dwordx4 v[96:99], v2, s[68:69] offset:-2048 sc1
  v_mfma_f32_32x32x16_bf16 v[32:47], a[116:119], v[100:103], v[32:47]
  global_load_dwordx4 v[100:103], v1, s[68:69] offset:-2048 sc1
  v_mfma_f32_32x32x16_bf16 v[32:47], a[124:127], v[104:107], v[32:47]
  global_load_dwordx4 v[104:107], v2, s[58:59] offset:2048 sc1
  s_waitcnt lgkmcnt(4)
  v_mfma_f32_32x32x16_bf16 v[32:47], v[116:119], v[108:111], v[32:47]
  global_load_dwordx4 v[108:111], v2, s[68:69] offset:0 sc1
  s_cmp_ge_u32 s34, 4
  s_cbranch_scc1 L_FA3
  s_cmp_lt_u32 s64, 2
  s_cbranch_scc1 L_FA3
  v_max3_u32 v8, v120, v121, v122
  v_max_u32 v8, v8, v123
  v_cmp_eq_u32 vcc, -1, v8
  s_nop 0
  s_cbranch_vccz PD44
  s_mov_b32 s38, 524288
P43:
  s_sub_u32 s38, s38, 1
  s_cbranch_scc1 L_END
  global_load_dwordx4 v[120:123], v7, s[46:47] sc1
  s_waitcnt vmcnt(0)
  v_max3_u32 v8, v120, v121, v122
  v_max_u32 v8, v8, v123
  v_cmp_eq_u32 vcc, -1, v8
  s_nop 0
  s_cbranch_vccnz P43
PD44:
  s_add_u32 s39, s63, s64
  s_sub_u32 s39, s39, 2
  s_lshl_b32 s39, s39, 16
  s_add_u32 s60, s26, s39
  s_addc_u32 s61, s27, 0
  v_pk_add_f32 v[120:121], v[120:121], v[12:13]
  v_pk_add_f32 v[122:123], v[122:123], v[14:15]
  v_cvt_pk_bf16_f32 v120, v120, v121
  v_cvt_pk_bf16_f32 v121, v122, v123
  global_store_dwordx2 v6, v[120:121], s[60:61]
L_FA3:
  s_add_u32 s64, s64, 1
  s_add_u32 s49, s49, 1
  s_waitcnt lgkmcnt(0)
  s_nop 8
  ds_write_b128 v4, v[32:35] offset:4096
  ds_write_b128 v4, v[36:39] offset:5120
  ds_write_b128 v4, v[40:43] offset:6144
  ds_write_b128 v4, v[44:47] offset:7168
  s_cmp_lt_u32 s64, s62
  s_cbranch_scc1 L_FS
  v_mov_b32 v12, v124
  v_mov_b32 v13, v125
  v_mov_b32 v14, v126
  v_mov_b32 v15, v127
L_FD:
  s_waitcnt lgkmcnt(0)
  s_barrier
  ds_read_b128 v[16:19], v5 offset:0
  ds_read_b128 v[20:23], v5 offset:8192
  ds_read_b128 v[24:27], v5 offset:16384
  ds_read_b128 v[28:31], v5 offset:24576
  ds_read_b128 v[32:35], v5 offset:32768
  ds_read_b128 v[36:39], v5 offset:40960
  ds_read_b128 v[40:43], v5 offset:49152
  ds_read_b128 v[44:47], v5 offset:57344
  s_xor_b32 s39, s33, 1
  s_lshl_b32 s39, s39, 4
  s_add_u32 s39, s39, s49
  s_lshl_b32 s39, s39, 12
  s_add_u32 s60, s30, s39
  s_addc_u32 s61, s31, 0
  s_add_u32 s60, s60, 100659200
  s_addc_u32 s61, s61, 0
  s_waitcnt lgkmcnt(0)
  v_pk_add_f32 v[16:17], v[16:17], v[32:33]
  v_pk_add_f32 v[18:19], v[18:19], v[34:35]
  v_pk_add_f32 v[20:21], v[20:21], v[36:37]
  v_pk_add_f32 v[22:23], v[22:23], v[38:39]
  v_pk_add_f32 v[24:25], v[24:25], v[40:41]
  v_pk_add_f32 v[26:27], v[26:27], v[42:43]
  v_pk_add_f32 v[28:29], v[28:29], v[44:45]
  v_pk_add_f32 v[30:31], v[30:31], v[46:47]
  v_pk_add_f32 v[16:17], v[16:17], v[24:25]
  v_pk_add_f32 v[18:19], v[18:19], v[26:27]
  v_pk_add_f32 v[20:21], v[20:21], v[28:29]
  v_pk_add_f32 v[22:23], v[22:23], v[30:31]
  v_pk_add_f32 v[16:17], v[16:17], v[20:21]
  v_pk_add_f32 v[18:19], v[18:19], v[22:23]
  s_cmp_lt_u32 s34, 4
  s_cbranch_scc1 L_FG
  s_cmp_eq_u32 s32, 0
  s_cbranch_scc1 F45
  global_store_dwordx4 v7, v[16:19], s[60:61] sc1
  s_branch E46
F45:
  global_store_dwordx4 v7, v[16:19], s[60:61]
E46:
  s_branch L_FE
L_FG:
  s_cmp_lt_u32 s64, 2
  s_cbranch_scc1 L_FH
  s_xor_b32 s39, s33, 0
  s_lshl_b32 s39, s39, 4
  s_add_u32 s39, s39, s49
  s_lshl_b32 s39, s39, 12
  s_add_u32 s46, s30, s39
  s_addc_u32 s47, s31, 0
  s_add_u32 s46, s46, 100655104
  s_addc_u32 s47, s47, 0
  s_mov_b32 s38, 524288
P47:
  s_sub_u32 s38, s38, 1
  s_cbranch_scc1 L_END
  global_load_dwordx4 v[120:123], v7, s[46:47] sc1
  s_waitcnt vmcnt(0)
  v_max3_u32 v8, v120, v121, v122
  v_max_u32 v8, v8, v123
  v_cmp_eq_u32 vcc, -1, v8
  s_nop 0
  s_cbranch_vccnz P47
PD48:
  s_add_u32 s39, s63, s64
  s_sub_u32 s39, s39, 2
  s_lshl_b32 s39, s39, 16
  s_add_u32 s60, s26, s39
  s_addc_u32 s61, s27, 0
  v_pk_add_f32 v[120:121], v[120:121], v[12:13]
  v_pk_add_f32 v[122:123], v[122:123], v[14:15]
  v_cvt_pk_bf16_f32 v120, v120, v121
  v_cvt_pk_bf16_f32 v121, v122, v123
  global_store_dwordx2 v6, v[120:121], s[60:61]
L_FH:
  s_xor_b32 s39, s33, 0
  s_lshl_b32 s39, s39, 4
  s_add_u32 s39, s39, s49
  s_lshl_b32 s39, s39, 12
  s_add_u32 s46, s30, s39
  s_addc_u32 s47, s31, 0
  s_add_u32 s46, s46, 100659200
  s_addc_u32 s47, s47, 0
  s_mov_b32 s38, 524288
P49:
  s_sub_u32 s38, s38, 1
  s_cbranch_scc1 L_END
  global_load_dwordx4 v[120:123], v7, s[46:47] sc1
  s_waitcnt vmcnt(0)
  v_max3_u32 v8, v120, v121, v122
  v_max_u32 v8, v8, v123
  v_cmp_eq_u32 vcc, -1, v8
  s_nop 0
  s_cbranch_vccnz P49
PD50:
  s_add_u32 s39, s63, s64
  s_sub_u32 s39, s39, 1
  s_lshl_b32 s39, s39, 16
  s_add_u32 s60, s26, s39
  s_addc_u32 s61, s27, 0
  v_pk_add_f32 v[120:121], v[120:121], v[16:17]
  v_pk_add_f32 v[122:123], v[122:123], v[18:19]
  v_cvt_pk_bf16_f32 v120, v120, v121
  v_cvt_pk_bf16_f32 v121, v122, v123
  global_store_dwordx2 v6, v[120:121], s[60:61]
L_FE:
  s_waitcnt vmcnt(0)
  s_add_u32 s52, s52, 1
  s_cmp_lt_u32 s49, 16
  s_cbranch_scc1 L_FB
  s_branch L_END
L_CHAIN:
  s_setprio 3
  s_cmp_lt_u32 s34, 4
  s_cbranch_scc1 L_MI
  s_lshl_b32 s70, s33, 11
  s_lshl_b32 s71, s33, 9
  s_lshl_b32 s72, s33, 10
  s_and_b32 s60, s34, 3
  v_lshlrev_b32 v1, 4, v0
  v_mov_b32 v4, -1
  v_mov_b32 v5, -1
  v_mov_b32 v6, -1
  v_mov_b32 v7, -1
  v_and_b32 v2, 0x1ff, v1
  s_add_u32 s39, s60, 0
  s_and_b32 s39, s39, 3
  s_lshl_b32 s39, s39, 19
  s_add_u32 s39, s39, s70
  s_add_u32 s56, s30, s39
  s_addc_u32 s57, s31, 0
  s_add_u32 s56, s56, 83886080
  s_addc_u32 s57, s57, 0
  global_store_dwordx4 v1, v[4:7], s[56:57] sc1
  global_store_dwordx4 v2, v[4:7], s[56:57] offset:1024 sc1
  s_add_u32 s39, s60, 0
  s_and_b32 s39, s39, 3
  s_lshl_b32 s39, s39, 19
  s_add_u32 s39, s39, s71
  s_add_u32 s56, s30, s39
  s_addc_u32 s57, s31, 0
  s_add_u32 s56, s56, 84148224
  s_addc_u32 s57, s57, 0
  global_store_dwordx4 v2, v[4:7], s[56:57] sc1
  s_add_u32 s39, s60, 0
  s_and_b32 s39, s39, 3
  s_lshl_b32 s39, s39, 19
  s_add_u32 s39, s39, s72
  s_add_u32 s56, s30, s39
  s_addc_u32 s57, s31, 0
  s_add_u32 s56, s56, 84213760
  s_addc_u32 s57, s57, 0
  global_store_dwordx4 v1, v[4:7], s[56:57] sc1
  s_add_u32 s39, s60, 0
  s_and_b32 s39, s39, 3
  s_lshl_b32 s39, s39, 19
  s_add_u32 s39, s39, s71
  s_add_u32 s56, s30, s39
  s_addc_u32 s57, s31, 0
  s_add_u32 s56, s56, 84344832
  s_addc_u32 s57, s57, 0
  global_store_dwordx4 v2, v[4:7], s[56:57] sc1
  s_nop 1
L_MI:
  s_and_b32 s53, s33, 1
  s_and_b32 s54, s33, 2
  s_lshl_b32 s54, s54, 4
  s_lshr_b32 s55, s33, 2
  s_mov_b32 s60, 16777216
  s_cmp_ge_u32 s54, 32
  s_cselect_b64 s[58:59], s[12:13], s[10:11]
  s_cselect_b32 s60, 33554432, s60
  s_lshl_b32 s39, s55, 8
  s_add_u32 s58, s58, s39
  s_addc_u32 s59, s59, 0
  s_lshl_b32 s39, s53, 18
  s_add_u32 s56, s4, s39
  s_addc_u32 s57, s5, 0
  s_mov_b64 s[64:65], s[58:59]
  s_cmp_ge_u32 s54, 32
  s_cbranch_scc1 L_K0V
  s_and_b32 s41, s34, 3
  s_lshr_b32 s42, s34, 2
  v_lshrrev_b32 v16, 3, v0
  s_mul_i32 s43, s34, 16
  v_add_u32 v16, s43, v16
  v_and_b32 v17, 7, v0
  v_add_u32 v18, 0, v16
  v_bfe_u32 v19, v18, 1, 3
  v_xor_b32 v19, v19, v17
  v_lshlrev_b32 v19, 4, v19
  v_lshl_add_u32 v2, v18, 11, v19
  v_add_u32 v18, 8, v16
  v_bfe_u32 v19, v18, 1, 3
  v_xor_b32 v19, v19, v17
  v_lshlrev_b32 v19, 4, v19
  v_lshl_add_u32 v3, v18, 11, v19
  v_subrev_u32 v3, 1024, v3
  v_lshrrev_b32 v16, 4, v0
  s_add_u32 s43, s34, s34
  s_lshl_b32 s43, s43, 2
  v_add_u32 v16, s43, v16
  v_and_b32 v17, 15, v0
  s_mov_b32 s44, 8192
  s_lshl_b32 s48, s44, 6
  v_add_u32 v18, 0, v16
  v_and_b32 v19, 3, v18
  v_lshlrev_b32 v19, 2, v19
  v_xor_b32 v19, v19, v17
  v_lshlrev_b32 v19, 4, v19
  v_mul_lo_u32 v18, v18, s44
  v_add_u32 v6, v18, v19
  v_add_u32 v18, 4, v16
  v_and_b32 v19, 3, v18
  v_lshlrev_b32 v19, 2, v19
  v_xor_b32 v19, v19, v17
  v_lshlrev_b32 v19, 4, v19
  v_mul_lo_u32 v18, v18, s44
  v_add_u32 v7, v18, v19
  v_subrev_u32 v7, 1024, v7
  v_and_b32 v16, 31, v0
  v_lshrrev_b32 v17, 5, v0
  v_bfe_u32 v18, v16, 1, 3
  s_mul_i32 s43, s41, 4096
  v_lshl_add_u32 v16, v16, 7, s43
  v_add_u32 v19, 0, v17
  v_xor_b32 v19, v19, v18
  v_lshl_add_u32 v10, v19, 4, v16
  v_add_u32 v19, 2, v17
  v_xor_b32 v19, v19, v18
  v_lshl_add_u32 v11, v19, 4, v16
  v_add_u32 v19, 4, v17
  v_xor_b32 v19, v19, v18
  v_lshl_add_u32 v12, v19, 4, v16
  v_add_u32 v19, 6, v17
  v_xor_b32 v19, v19, v18
  v_lshl_add_u32 v13, v19, 4, v16
  v_bfe_u32 v16, v0, 2, 2
  v_lshrrev_b32 v17, 5, v0
  v_lshl_add_u32 v17, v17, 3, v16
  v_mul_u32_u24 v17, 256, v17
  v_bfe_u32 v18, v0, 4, 1
  v_lshlrev_b32 v18, 5, v18
  v_and_b32 v19, 3, v0
  v_lshl_add_u32 v18, v19, 3, v18
  v_add_u32 v17, v17, v18
  v_add_u32 v17, 16384, v17
  s_mul_i32 s43, s42, 2
  s_add_u32 s43, s43, 0
  v_xor_b32 v19, s43, v16
  v_lshl_add_u32 v14, v19, 6, v17
  s_mul_i32 s43, s42, 2
  s_add_u32 s43, s43, 1
  v_xor_b32 v19, s43, v16
  v_lshl_add_u32 v15, v19, 6, v17
  s_mul_i32 s45, s34, 2048
  s_mul_i32 s46, s34, 2048
  s_add_u32 s46, s46, 16384
  s_barrier
  s_mov_b32 m0, s45
  s_nop 0
  global_load_lds_dwordx4 v2, s[56:57] offset:0
  global_load_lds_dwordx4 v3, s[56:57] offset:1024
  s_mov_b32 m0, s46
  s_nop 0
  global_load_lds_dwordx4 v6, s[58:59] offset:0
  global_load_lds_dwordx4 v7, s[58:59] offset:1024
  s_add_u32 s56, s56, 128
  s_addc_u32 s57, s57, 0
  s_add_u32 s58, s58, s48
  s_addc_u32 s59, s59, 0
  s_add_u32 s45, s45, 0x8000
  s_add_u32 s46, s46, 0x8000
  s_and_b32 s45, s45, 0x1ffff
  s_and_b32 s46, s46, 0x1ffff
  s_mov_b32 m0, s45
  s_nop 0
  global_load_lds_dwordx4 v2, s[56:57] offset:0
  global_load_lds_dwordx4 v3, s[56:57] offset:1024
  s_mov_b32 m0, s46
  s_nop 0
  global_load_lds_dwordx4 v6, s[58:59] offset:0
  global_load_lds_dwordx4 v7, s[58:59] offset:1024
  s_add_u32 s56, s56, 128
  s_addc_u32 s57, s57, 0
  s_add_u32 s58, s58, s48
  s_addc_u32 s59, s59, 0
  s_add_u32 s45, s45, 0x8000
  s_add_u32 s46, s46, 0x8000
  s_and_b32 s45, s45, 0x1ffff
  s_and_b32 s46, s46, 0x1ffff
  s_mov_b32 m0, s45
  s_nop 0
  global_load_lds_dwordx4 v2, s[56:57] offset:0
  global_load_lds_dwordx4 v3, s[56:57] offset:1024
  s_mov_b32 m0, s46
  s_nop 0
  global_load_lds_dwordx4 v6, s[58:59] offset:0
  global_load_lds_dwordx4 v7, s[58:59] offset:1024
  s_add_u32 s56, s56, 128
  s_addc_u32 s57, s57, 0
  s_add_u32 s58, s58, s48
  s_addc_u32 s59, s59, 0
  s_add_u32 s45, s45, 0x8000
  s_add_u32 s46, s46, 0x8000
  s_and_b32 s45, s45, 0x1ffff
  s_and_b32 s46, s46, 0x1ffff
  s_mov_b32 m0, s45
  s_nop 0
  global_load_lds_dwordx4 v2, s[56:57] offset:0
  global_load_lds_dwordx4 v3, s[56:57] offset:1024
  s_mov_b32 m0, s46
  s_nop 0
  global_load_lds_dwordx4 v6, s[58:59] offset:0
  global_load_lds_dwordx4 v7, s[58:59] offset:1024
  s_add_u32 s56, s56, 128
  s_addc_u32 s57, s57, 0
  s_add_u32 s58, s58, s48
  s_addc_u32 s59, s59, 0
  s_add_u32 s45, s45, 0x8000
  s_add_u32 s46, s46, 0x8000
  s_and_b32 s45, s45, 0x1ffff
  s_and_b32 s46, s46, 0x1ffff
  s_waitcnt vmcnt(12)
  s_barrier
  ds_read_b64_tr_b16 v[36:37], v14 offset:0
  ds_read_b64_tr_b16 v[38:39], v14 offset:1024
  ds_read_b64_tr_b16 v[40:41], v15 offset:0
  ds_read_b64_tr_b16 v[42:43], v15 offset:1024
  ds_read_b128 v[32:35], v10 offset:0
  s_waitcnt lgkmcnt(0)
  v_mfma_f32_32x32x16_bf16 a[0:15], v[36:39], v[32:35], 0
  ds_read_b64_tr_b16 v[48:49], v14 offset:4096
  ds_read_b64_tr_b16 v[50:51], v14 offset:5120
  ds_read_b64_tr_b16 v[52:53], v15 offset:4096
  v_mfma_f32_32x32x16_bf16 a[16:31], v[40:43], v[32:35], 0
  ds_read_b64_tr_b16 v[54:55], v15 offset:5120
  ds_read_b128 v[44:47], v11 offset:0
  s_waitcnt lgkmcnt(0)
  v_mfma_f32_32x32x16_bf16 a[0:15], v[48:51], v[44:47], a[0:15]
  ds_read_b64_tr_b16 v[36:37], v14 offset:8192
  ds_read_b64_tr_b16 v[38:39], v14 offset:9216
  ds_read_b64_tr_b16 v[40:41], v15 offset:8192
  v_mfma_f32_32x32x16_bf16 a[16:31], v[52:55], v[44:47], a[16:31]
  ds_read_b64_tr_b16 v[42:43], v15 offset:9216
  ds_read_b128 v[32:35], v12 offset:0
  s_waitcnt lgkmcnt(0)
  v_mfma_f32_32x32x16_bf16 a[0:15], v[36:39], v[32:35], a[0:15]
  ds_read_b64_tr_b16 v[48:49], v14 offset:12288
  ds_read_b64_tr_b16 v[50:51], v14 offset:13312
  ds_read_b64_tr_b16 v[52:53], v15 offset:12288
  v_mfma_f32_32x32x16_bf16 a[16:31], v[40:43], v[32:35], a[16:31]
  ds_read_b64_tr_b16 v[54:55], v15 offset:13312
  ds_read_b128 v[44:47], v13 offset:0
  s_waitcnt lgkmcnt(0)
  s_waitcnt vmcnt(8)
  s_barrier
  v_add_u32 v10, 0x8000, v10
  v_add_u32 v11, 0x8000, v11
  v_add_u32 v12, 0x8000, v12
  v_add_u32 v13, 0x8000, v13
  v_add_u32 v14, 0x8000, v14
  v_add_u32 v15, 0x8000, v15
  v_and_b32 v10, 0x1ffff, v10
  v_and_b32 v11, 0x1ffff, v11
  v_and_b32 v12, 0x1ffff, v12
  v_and_b32 v13, 0x1ffff, v13
  v_and_b32 v14, 0x1ffff, v14
  v_and_b32 v15, 0x1ffff, v15
  ds_read_b64_tr_b16 v[36:37], v14 offset:0
  ds_read_b64_tr_b16 v[38:39], v14 offset:1024
  ds_read_b64_tr_b16 v[40:41], v15 offset:0
  ds_read_b64_tr_b16 v[42:43], v15 offset:1024
  ds_read_b128 v[32:35], v10 offset:0
  s_mov_b32 m0, s45
  s_nop 0
  global_load_lds_dwordx4 v2, s[56:57] offset:0
  global_load_lds_dwordx4 v3, s[56:57] offset:1024
  s_mov_b32 m0, s46
  s_nop 0
  global_load_lds_dwordx4 v6, s[58:59] offset:0
  global_load_lds_dwordx4 v7, s[58:59] offset:1024
  s_add_u32 s56, s56, 128
  s_addc_u32 s57, s57, 0
  s_add_u32 s58, s58, s48
  s_addc_u32 s59, s59, 0
  s_add_u32 s45, s45, 0x8000
  s_add_u32 s46, s46, 0x8000
  s_and_b32 s45, s45, 0x1ffff
  s_and_b32 s46, s46, 0x1ffff
  v_mfma_f32_32x32x16_bf16 a[0:15], v[48:51], v[44:47], a[0:15]
  v_mfma_f32_32x32x16_bf16 a[16:31], v[52:55], v[44:47], a[16:31]
  s_mov_b32 s47, 11
G51:
  s_waitcnt lgkmcnt(0)
  v_mfma_f32_32x32x16_bf16 a[0:15], v[36:39], v[32:35], a[0:15]
  ds_read_b64_tr_b16 v[48:49], v14 offset:4096
  ds_read_b64_tr_b16 v[50:51], v14 offset:5120
  ds_read_b64_tr_b16 v[52:53], v15 offset:4096
  v_mfma_f32_32x32x16_bf16 a[16:31], v[40:43], v[32:35], a[16:31]
  ds_read_b64_tr_b16 v[54:55], v15 offset:5120
  ds_read_b128 v[44:47], v11 offset:0
  s_waitcnt lgkmcnt(0)
  v_mfma_f32_32x32x16_bf16 a[0:15], v[48:51], v[44:47], a[0:15]
  ds_read_b64_tr_b16 v[36:37], v14 offset:8192
  ds_read_b64_tr_b16 v[38:39], v14 offset:9216
  ds_read_b64_tr_b16 v[40:41], v15 offset:8192
  v_mfma_f32_32x32x16_bf16 a[16:31], v[52:55], v[44:47], a[16:31]
  ds_read_b64_tr_b16 v[42:43], v15 offset:9216
  ds_read_b128 v[32:35], v12 offset:0
  s_waitcnt lgkmcnt(0)
  v_mfma_f32_32x32x16_bf16 a[0:15], v[36:39], v[32:35], a[0:15]
  ds_read_b64_tr_b16 v[48:49], v14 offset:12288
  ds_read_b64_tr_b16 v[50:51], v14 offset:13312
  ds_read_b64_tr_b16 v[52:53], v15 offset:12288
  v_mfma_f32_32x32x16_bf16 a[16:31], v[40:43], v[32:35], a[16:31]
  ds_read_b64_tr_b16 v[54:55], v15 offset:13312
  ds_read_b128 v[44:47], v13 offset:0
  s_waitcnt lgkmcnt(0)
  s_waitcnt vmcnt(8)
  s_barrier
  v_add_u32 v10, 0x8000, v10
  v_add_u32 v11, 0x8000, v11
  v_add_u32 v12, 0x8000, v12
  v_add_u32 v13, 0x8000, v13
  v_add_u32 v14, 0x8000, v14
  v_add_u32 v15, 0x8000, v15
  v_and_b32 v10, 0x1ffff, v10
  v_and_b32 v11, 0x1ffff, v11
  v_and_b32 v12, 0x1ffff, v12
  v_and_b32 v13, 0x1ffff, v13
  v_and_b32 v14, 0x1ffff, v14
  v_and_b32 v15, 0x1ffff, v15
  ds_read_b64_tr_b16 v[36:37], v14 offset:0
  ds_read_b64_tr_b16 v[38:39], v14 offset:1024
  ds_read_b64_tr_b16 v[40:41], v15 offset:0
  ds_read_b64_tr_b16 v[42:43], v15 offset:1024
  ds_read_b128 v[32:35], v10 offset:0
  s_mov_b32 m0, s45
  s_nop 0
  global_load_lds_dwordx4 v2, s[56:57] offset:0
  global_load_lds_dwordx4 v3, s[56:57] offset:1024
  s_mov_b32 m0, s46
  s_nop 0
  global_load_lds_dwordx4 v6, s[58:59] offset:0
  global_load_lds_dwordx4 v7, s[58:59] offset:1024
  s_add_u32 s56, s56, 128
  s_addc_u32 s57, s57, 0
  s_add_u32 s58, s58, s48
  s_addc_u32 s59, s59, 0
  s_add_u32 s45, s45, 0x8000
  s_add_u32 s46, s46, 0x8000
  s_and_b32 s45, s45, 0x1ffff
  s_and_b32 s46, s46, 0x1ffff
  v_mfma_f32_32x32x16_bf16 a[0:15], v[48:51], v[44:47], a[0:15]
  v_mfma_f32_32x32x16_bf16 a[16:31], v[52:55], v[44:47], a[16:31]
  s_sub_u32 s47, s47, 1
  s_cmp_lg_u32 s47, 0
  s_cbranch_scc1 G51
  s_waitcnt lgkmcnt(0)
  v_mfma_f32_32x32x16_bf16 a[0:15], v[36:39], v[32:35], a[0:15]
  ds_read_b64_tr_b16 v[48:49], v14 offset:4096
  ds_read_b64_tr_b16 v[50:51], v14 offset:5120
  ds_read_b64_tr_b16 v[52:53], v15 offset:4096
  v_mfma_f32_32x32x16_bf16 a[16:31], v[40:43], v[32:35], a[16:31]
  ds_read_b64_tr_b16 v[54:55], v15 offset:5120
  ds_read_b128 v[44:47], v11 offset:0
  s_waitcnt lgkmcnt(0)
  v_mfma_f32_32x32x16_bf16 a[0:15], v[48:51], v[44:47], a[0:15]
  ds_read_b64_tr_b16 v[36:37], v14 offset:8192
  ds_read_b64_tr_b16 v[38:39], v14 offset:9216
  ds_read_b64_tr_b16 v[40:41], v15 offset:8192
  v_mfma_f32_32x32x16_bf16 a[16:31], v[52:55], v[44:47], a[16:31]
  ds_read_b64_tr_b16 v[42:43], v15 offset:9216
  ds_read_b128 v[32:35], v12 offset:0
  s_waitcnt lgkmcnt(0)
  v_mfma_f32_32x32x16_bf16 a[0:15], v[36:39], v[32:35], a[0:15]
  ds_read_b64_tr_b16 v[48:49], v14 offset:12288
  ds_read_b64_tr_b16 v[50:51], v14 offset:13312
  ds_read_b64_tr_b16 v[52:53], v15 offset:12288
  v_mfma_f32_32x32x16_bf16 a[16:31], v[40:43], v[32:35], a[16:31]
  ds_read_b64_tr_b16 v[54:55], v15 offset:13312
  ds_read_b128 v[44:47], v13 offset:0
  s_waitcnt lgkmcnt(0)
  s_waitcnt vmcnt(8)
  s_barrier
  v_add_u32 v10, 0x8000, v10
  v_add_u32 v11, 0x8000, v11
  v_add_u32 v12, 0x8000, v12
  v_add_u32 v13, 0x8000, v13
  v_add_u32 v14, 0x8000, v14
  v_add_u32 v15, 0x8000, v15
  v_and_b32 v10, 0x1ffff, v10
  v_and_b32 v11, 0x1ffff, v11
  v_and_b32 v12, 0x1ffff, v12
  v_and_b32 v13, 0x1ffff, v13
  v_and_b32 v14, 0x1ffff, v14
  v_and_b32 v15, 0x1ffff, v15
  ds_read_b64_tr_b16 v[36:37], v14 offset:0
  ds_read_b64_tr_b16 v[38:39], v14 offset:1024
  ds_read_b64_tr_b16 v[40:41], v15 offset:0
  ds_read_b64_tr_b16 v[42:43], v15 offset:1024
  ds_read_b128 v[32:35], v10 offset:0
  v_mfma_f32_32x32x16_bf16 a[0:15], v[48:51], v[44:47], a[0:15]
  v_mfma_f32_32x32x16_bf16 a[16:31], v[52:55], v[44:47], a[16:31]
  s_waitcnt lgkmcnt(0)
  v_mfma_f32_32x32x16_bf16 a[0:15], v[36:39], v[32:35], a[0:15]
  ds_read_b64_tr_b16 v[48:49], v14 offset:4096
  ds_read_b64_tr_b16 v[50:51], v14 offset:5120
  ds_read_b64_tr_b16 v[52:53], v15 offset:4096
  v_mfma_f32_32x32x16_bf16 a[16:31], v[40:43], v[32:35], a[16:31]
  ds_read_b64_tr_b16 v[54:55], v15 offset:5120
  ds_read_b128 v[44:47], v11 offset:0
  s_waitcnt lgkmcnt(0)
  v_mfma_f32_32x32x16_bf16 a[0:15], v[48:51], v[44:47], a[0:15]
  ds_read_b64_tr_b16 v[36:37], v14 offset:8192
  ds_read_b64_tr_b16 v[38:39], v14 offset:9216
  ds_read_b64_tr_b16 v[40:41], v15 offset:8192
  v_mfma_f32_32x32x16_bf16 a[16:31], v[52:55], v[44:47], a[16:31]
  ds_read_b64_tr_b16 v[42:43], v15 offset:9216
  ds_read_b128 v[32:35], v12 offset:0
  s_waitcnt lgkmcnt(0)
  v_mfma_f32_32x32x16_bf16 a[0:15], v[36:39], v[32:35], a[0:15]
  ds_read_b64_tr_b16 v[48:49], v14 offset:12288
  ds_read_b64_tr_b16 v[50:51], v14 offset:13312
  ds_read_b64_tr_b16 v[52:53], v15 offset:12288
  v_mfma_f32_32x32x16_bf16 a[16:31], v[40:43], v[32:35], a[16:31]
  ds_read_b64_tr_b16 v[54:55], v15 offset:13312
  ds_read_b128 v[44:47], v13 offset:0
  s_waitcnt lgkmcnt(0)
  s_waitcnt vmcnt(4)
  s_barrier
  v_add_u32 v10, 0x8000, v10
  v_add_u32 v11, 0x8000, v11
  v_add_u32 v12, 0x8000, v12
  v_add_u32 v13, 0x8000, v13
  v_add_u32 v14, 0x8000, v14
  v_add_u32 v15, 0x8000, v15
  v_and_b32 v10, 0x1ffff, v10
  v_and_b32 v11, 0x1ffff, v11
  v_and_b32 v12, 0x1ffff, v12
  v_and_b32 v13, 0x1ffff, v13
  v_and_b32 v14, 0x1ffff, v14
  v_and_b32 v15, 0x1ffff, v15
  ds_read_b64_tr_b16 v[36:37], v14 offset:0
  ds_read_b64_tr_b16 v[38:39], v14 offset:1024
  ds_read_b64_tr_b16 v[40:41], v15 offset:0
  ds_read_b64_tr_b16 v[42:43], v15 offset:1024
  ds_read_b128 v[32:35], v10 offset:0
  v_mfma_f32_32x32x16_bf16 a[0:15], v[48:51], v[44:47], a[0:15]
  v_mfma_f32_32x32x16_bf16 a[16:31], v[52:55], v[44:47], a[16:31]
  s_waitcnt lgkmcnt(0)
  v_mfma_f32_32x32x16_bf16 a[0:15], v[36:39], v[32:35], a[0:15]
  ds_read_b64_tr_b16 v[48:49], v14 offset:4096
  ds_read_b64_tr_b16 v[50:51], v14 offset:5120
  ds_read_b64_tr_b16 v[52:53], v15 offset:4096
  v_mfma_f32_32x32x16_bf16 a[16:31], v[40:43], v[32:35], a[16:31]
  ds_read_b64_tr_b16 v[54:55], v15 offset:5120
  ds_read_b128 v[44:47], v11 offset:0
  s_waitcnt lgkmcnt(0)
  v_mfma_f32_32x32x16_bf16 a[0:15], v[48:51], v[44:47], a[0:15]
  ds_read_b64_tr_b16 v[36:37], v14 offset:8192
  ds_read_b64_tr_b16 v[38:39], v14 offset:9216
  ds_read_b64_tr_b16 v[40:41], v15 offset:8192
  v_mfma_f32_32x32x16_bf16 a[16:31], v[52:55], v[44:47], a[16:31]
  ds_read_b64_tr_b16 v[42:43], v15 offset:9216
  ds_read_b128 v[32:35], v12 offset:0
  s_waitcnt lgkmcnt(0)
  v_mfma_f32_32x32x16_bf16 a[0:15], v[36:39], v[32:35], a[0:15]
  ds_read_b64_tr_b16 v[48:49], v14 offset:12288
  ds_read_b64_tr_b16 v[50:51], v14 offset:13312
  ds_read_b64_tr_b16 v[52:53], v15 offset:12288
  v_mfma_f32_32x32x16_bf16 a[16:31], v[40:43], v[32:35], a[16:31]
  ds_read_b64_tr_b16 v[54:55], v15 offset:13312
  ds_read_b128 v[44:47], v13 offset:0
  s_waitcnt lgkmcnt(0)
  s_waitcnt vmcnt(0)
  s_barrier
  v_add_u32 v10, 0x8000, v10
  v_add_u32 v11, 0x8000, v11
  v_add_u32 v12, 0x8000, v12
  v_add_u32 v13, 0x8000, v13
  v_add_u32 v14, 0x8000, v14
  v_add_u32 v15, 0x8000, v15
  v_and_b32 v10, 0x1ffff, v10
  v_and_b32 v11, 0x1ffff, v11
  v_and_b32 v12, 0x1ffff, v12
  v_and_b32 v13, 0x1ffff, v13
  v_and_b32 v14, 0x1ffff, v14
  v_and_b32 v15, 0x1ffff, v15
  ds_read_b64_tr_b16 v[36:37], v14 offset:0
  ds_read_b64_tr_b16 v[38:39], v14 offset:1024
  ds_read_b64_tr_b16 v[40:41], v15 offset:0
  ds_read_b64_tr_b16 v[42:43], v15 offset:1024
  ds_read_b128 v[32:35], v10 offset:0
  v_mfma_f32_32x32x16_bf16 a[0:15], v[48:51], v[44:47], a[0:15]
  v_mfma_f32_32x32x16_bf16 a[16:31], v[52:55], v[44:47], a[16:31]
  s_waitcnt lgkmcnt(0)
  v_mfma_f32_32x32x16_bf16 a[0:15], v[36:39], v[32:35], a[0:15]
  ds_read_b64_tr_b16 v[48:49], v14 offset:4096
  ds_read_b64_tr_b16 v[50:51], v14 offset:5120
  ds_read_b64_tr_b16 v[52:53], v15 offset:4096
  v_mfma_f32_32x32x16_bf16 a[16:31], v[40:43], v[32:35], a[16:31]
  ds_read_b64_tr_b16 v[54:55], v15 offset:5120
  ds_read_b128 v[44:47], v11 offset:0
  s_waitcnt lgkmcnt(0)
  v_mfma_f32_32x32x16_bf16 a[0:15], v[48:51], v[44:47], a[0:15]
  ds_read_b64_tr_b16 v[36:37], v14 offset:8192
  ds_read_b64_tr_b16 v[38:39], v14 offset:9216
  ds_read_b64_tr_b16 v[40:41], v15 offset:8192
  v_mfma_f32_32x32x16_bf16 a[16:31], v[52:55], v[44:47], a[16:31]
  ds_read_b64_tr_b16 v[42:43], v15 offset:9216
  ds_read_b128 v[32:35], v12 offset:0
  s_waitcnt lgkmcnt(0)
  v_mfma_f32_32x32x16_bf16 a[0:15], v[36:39], v[32:35], a[0:15]
  ds_read_b64_tr_b16 v[48:49], v14 offset:12288
  ds_read_b64_tr_b16 v[50:51], v14 offset:13312
  ds_read_b64_tr_b16 v[52:53], v15 offset:12288
  v_mfma_f32_32x32x16_bf16 a[16:31], v[40:43], v[32:35], a[16:31]
  ds_read_b64_tr_b16 v[54:55], v15 offset:13312
  ds_read_b128 v[44:47], v13 offset:0
  s_waitcnt lgkmcnt(0)
  v_mfma_f32_32x32x16_bf16 a[0:15], v[48:51], v[44:47], a[0:15]
  v_mfma_f32_32x32x16_bf16 a[16:31], v[52:55], v[44:47], a[16:31]
  s_nop 11
  s_branch L_K0E
L_K0V:
  s_and_b32 s41, s34, 3
  s_lshr_b32 s42, s34, 2
  v_lshrrev_b32 v16, 3, v0
  s_mul_i32 s43, s34, 16
  v_add_u32 v16, s43, v16
  v_and_b32 v17, 7, v0
  v_add_u32 v18, 0, v16
  v_bfe_u32 v19, v18, 1, 3
  v_xor_b32 v19, v19, v17
  v_lshlrev_b32 v19, 4, v19
  v_lshl_add_u32 v2, v18, 11, v19
  v_add_u32 v18, 8, v16
  v_bfe_u32 v19, v18, 1, 3
  v_xor_b32 v19, v19, v17
  v_lshlrev_b32 v19, 4, v19
  v_lshl_add_u32 v3, v18, 11, v19
  v_subrev_u32 v3, 1024, v3
  v_lshrrev_b32 v16, 4, v0
  s_add_u32 s43, s34, s34
  s_lshl_b32 s43, s43, 2
  v_add_u32 v16, s43, v16
  v_and_b32 v17, 15, v0
  s_mov_b32 s44, 8192
  s_lshl_b32 s48, s44, 6
  v_add_u32 v18, 0, v16
  v_and_b32 v19, 3, v18
  v_lshlrev_b32 v19, 2, v19
  v_xor_b32 v19, v19, v17
  v_lshlrev_b32 v19, 4, v19
  v_mul_lo_u32 v18, v18, s44
  v_add_u32 v6, v18, v19
  v_add_u32 v18, 4, v16
  v_and_b32 v19, 3, v18
  v_lshlrev_b32 v19, 2, v19
  v_xor_b32 v19, v19, v17
  v_lshlrev_b32 v19, 4, v19
  v_mul_lo_u32 v18, v18, s44
  v_add_u32 v7, v18, v19
  v_subrev_u32 v7, 1024, v7
  v_and_b32 v16, 31, v0
  v_lshrrev_b32 v17, 5, v0
  v_bfe_u32 v18, v16, 1, 3
  s_mul_i32 s43, s41, 4096
  v_lshl_add_u32 v16, v16, 7, s43
  v_add_u32 v19, 0, v17
  v_xor_b32 v19, v19, v18
  v_lshl_add_u32 v10, v19, 4, v16
  v_add_u32 v19, 2, v17
  v_xor_b32 v19, v19, v18
  v_lshl_add_u32 v11, v19, 4, v16
  v_add_u32 v19, 4, v17
  v_xor_b32 v19, v19, v18
  v_lshl_add_u32 v12, v19, 4, v16
  v_add_u32 v19, 6, v17
  v_xor_b32 v19, v19, v18
  v_lshl_add_u32 v13, v19, 4, v16
  v_bfe_u32 v16, v0, 2, 2
  v_lshrrev_b32 v17, 5, v0
  v_lshl_add_u32 v17, v17, 3, v16
  v_mul_u32_u24 v17, 256, v17
  v_bfe_u32 v18, v0, 4, 1
  v_lshlrev_b32 v18, 5, v18
  v_and_b32 v19, 3, v0
  v_lshl_add_u32 v18, v19, 3, v18
  v_add_u32 v17, v17, v18
  v_add_u32 v17, 16384, v17
  s_mul_i32 s43, s42, 2
  s_add_u32 s43, s43, 0
  v_xor_b32 v19, s43, v16
  v_lshl_add_u32 v14, v19, 6, v17
  s_mul_i32 s43, s42, 2
  s_add_u32 s43, s43, 1
  v_xor_b32 v19, s43, v16
  v_lshl_add_u32 v15, v19, 6, v17
  s_mul_i32 s45, s34, 2048
  s_mul_i32 s46, s34, 2048
  s_add_u32 s46, s46, 16384
  s_barrier
  s_mov_b32 m0, s45
  s_nop 0
  global_load_lds_dwordx4 v2, s[56:57] offset:0
  global_load_lds_dwordx4 v3, s[56:57] offset:1024
  s_mov_b32 m0, s46
  s_nop 0
  global_load_lds_dwordx4 v6, s[58:59] offset:0
  global_load_lds_dwordx4 v7, s[58:59] offset:1024
  s_add_u32 s56, s56, 128
  s_addc_u32 s57, s57, 0
  s_add_u32 s58, s58, s48
  s_addc_u32 s59, s59, 0
  s_add_u32 s45, s45, 0x8000
  s_add_u32 s46, s46, 0x8000
  s_and_b32 s45, s45, 0x1ffff
  s_and_b32 s46, s46, 0x1ffff
  s_mov_b32 m0, s45
  s_nop 0
  global_load_lds_dwordx4 v2, s[56:57] offset:0
  global_load_lds_dwordx4 v3, s[56:57] offset:1024
  s_mov_b32 m0, s46
  s_nop 0
  global_load_lds_dwordx4 v6, s[58:59] offset:0
  global_load_lds_dwordx4 v7, s[58:59] offset:1024
  s_add_u32 s56, s56, 128
  s_addc_u32 s57, s57, 0
  s_add_u32 s58, s58, s48
  s_addc_u32 s59, s59, 0
  s_add_u32 s45, s45, 0x8000
  s_add_u32 s46, s46, 0x8000
  s_and_b32 s45, s45, 0x1ffff
  s_and_b32 s46, s46, 0x1ffff
  s_mov_b32 m0, s45
  s_nop 0
  global_load_lds_dwordx4 v2, s[56:57] offset:0
  global_load_lds_dwordx4 v3, s[56:57] offset:1024
  s_mov_b32 m0, s46
  s_nop 0
  global_load_lds_dwordx4 v6, s[58:59] offset:0
  global_load_lds_dwordx4 v7, s[58:59] offset:1024
  s_add_u32 s56, s56, 128
  s_addc_u32 s57, s57, 0
  s_add_u32 s58, s58, s48
  s_addc_u32 s59, s59, 0
  s_add_u32 s45, s45, 0x8000
  s_add_u32 s46, s46, 0x8000
  s_and_b32 s45, s45, 0x1ffff
  s_and_b32 s46, s46, 0x1ffff
  s_mov_b32 m0, s45
  s_nop 0
  global_load_lds_dwordx4 v2, s[56:57] offset:0
  global_load_lds_dwordx4 v3, s[56:57] offset:1024
  s_mov_b32 m0, s46
  s_nop 0
  global_load_lds_dwordx4 v6, s[58:59] offset:0
  global_load_lds_dwordx4 v7, s[58:59] offset:1024
  s_add_u32 s56, s56, 128
  s_addc_u32 s57, s57, 0
  s_add_u32 s58, s58, s48
  s_addc_u32 s59, s59, 0
  s_add_u32 s45, s45, 0x8000
  s_add_u32 s46, s46, 0x8000
  s_and_b32 s45, s45, 0x1ffff
  s_and_b32 s46, s46, 0x1ffff
  s_waitcnt vmcnt(12)
  s_barrier
  ds_read_b64_tr_b16 v[36:37], v14 offset:0
  ds_read_b64_tr_b16 v[38:39], v14 offset:1024
  ds_read_b64_tr_b16 v[40:41], v15 offset:0
  ds_read_b64_tr_b16 v[42:43], v15 offset:1024
  ds_read_b128 v[32:35], v10 offset:0
  s_waitcnt lgkmcnt(0)
  v_mfma_f32_32x32x16_bf16 a[0:15], v[32:35], v[36:39], 0
  ds_read_b64_tr_b16 v[48:49], v14 offset:4096
  ds_read_b64_tr_b16 v[50:51], v14 offset:5120
  ds_read_b64_tr_b16 v[52:53], v15 offset:4096
  v_mfma_f32_32x32x16_bf16 a[16:31], v[32:35], v[40:43], 0
  ds_read_b64_tr_b16 v[54:55], v15 offset:5120
  ds_read_b128 v[44:47], v11 offset:0
  s_waitcnt lgkmcnt(0)
  v_mfma_f32_32x32x16_bf16 a[0:15], v[44:47], v[48:51], a[0:15]
  ds_read_b64_tr_b16 v[36:37], v14 offset:8192
  ds_read_b64_tr_b16 v[38:39], v14 offset:9216
  ds_read_b64_tr_b16 v[40:41], v15 offset:8192
  v_mfma_f32_32x32x16_bf16 a[16:31], v[44:47], v[52:55], a[16:31]
  ds_read_b64_tr_b16 v[42:43], v15 offset:9216
  ds_read_b128 v[32:35], v12 offset:0
  s_waitcnt lgkmcnt(0)
  v_mfma_f32_32x32x16_bf16 a[0:15], v[32:35], v[36:39], a[0:15]
  ds_read_b64_tr_b16 v[48:49], v14 offset:12288
  ds_read_b64_tr_b16 v[50:51], v14 offset:13312
  ds_read_b64_tr_b16 v[52:53], v15 offset:12288
  v_mfma_f32_32x32x16_bf16 a[16:31], v[32:35], v[40:43], a[16:31]
  ds_read_b64_tr_b16 v[54:55], v15 offset:13312
  ds_read_b128 v[44:47], v13 offset:0
  s_waitcnt lgkmcnt(0)
  s_waitcnt vmcnt(8)
  s_barrier
  v_add_u32 v10, 0x8000, v10
  v_add_u32 v11, 0x8000, v11
  v_add_u32 v12, 0x8000, v12
  v_add_u32 v13, 0x8000, v13
  v_add_u32 v14, 0x8000, v14
  v_add_u32 v15, 0x8000, v15
  v_and_b32 v10, 0x1ffff, v10
  v_and_b32 v11, 0x1ffff, v11
  v_and_b32 v12, 0x1ffff, v12
  v_and_b32 v13, 0x1ffff, v13
  v_and_b32 v14, 0x1ffff, v14
  v_and_b32 v15, 0x1ffff, v15
  ds_read_b64_tr_b16 v[36:37], v14 offset:0
  ds_read_b64_tr_b16 v[38:39], v14 offset:1024
  ds_read_b64_tr_b16 v[40:41], v15 offset:0
  ds_read_b64_tr_b16 v[42:43], v15 offset:1024
  ds_read_b128 v[32:35], v10 offset:0
  s_mov_b32 m0, s45
  s_nop 0
  global_load_lds_dwordx4 v2, s[56:57] offset:0
  global_load_lds_dwordx4 v3, s[56:57] offset:1024
  s_mov_b32 m0, s46
  s_nop 0
  global_load_lds_dwordx4 v6, s[58:59] offset:0
  global_load_lds_dwordx4 v7, s[58:59] offset:1024
  s_add_u32 s56, s56, 128
  s_addc_u32 s57, s57, 0
  s_add_u32 s58, s58, s48
  s_addc_u32 s59, s59, 0
  s_add_u32 s45, s45, 0x8000
  s_add_u32 s46, s46, 0x8000
  s_and_b32 s45, s45, 0x1ffff
  s_and_b32 s46, s46, 0x1ffff
  v_mfma_f32_32x32x16_bf16 a[0:15], v[44:47], v[48:51], a[0:15]
  v_mfma_f32_32x32x16_bf16 a[16:31], v[44:47], v[52:55], a[16:31]
  s_mov_b32 s47, 11
G52:
  s_waitcnt lgkmcnt(0)
  v_mfma_f32_32x32x16_bf16 a[0:15], v[32:35], v[36:39], a[0:15]
  ds_read_b64_tr_b16 v[48:49], v14 offset:4096
  ds_read_b64_tr_b16 v[50:51], v14 offset:5120
  ds_read_b64_tr_b16 v[52:53], v15 offset:4096
  v_mfma_f32_32x32x16_bf16 a[16:31], v[32:35], v[40:43], a[16:31]
  ds_read_b64_tr_b16 v[54:55], v15 offset:5120
  ds_read_b128 v[44:47], v11 offset:0
  s_waitcnt lgkmcnt(0)
  v_mfma_f32_32x32x16_bf16 a[0:15], v[44:47], v[48:51], a[0:15]
  ds_read_b64_tr_b16 v[36:37], v14 offset:8192
  ds_read_b64_tr_b16 v[38:39], v14 offset:9216
  ds_read_b64_tr_b16 v[40:41], v15 offset:8192
  v_mfma_f32_32x32x16_bf16 a[16:31], v[44:47], v[52:55], a[16:31]
  ds_read_b64_tr_b16 v[42:43], v15 offset:9216
  ds_read_b128 v[32:35], v12 offset:0
  s_waitcnt lgkmcnt(0)
  v_mfma_f32_32x32x16_bf16 a[0:15], v[32:35], v[36:39], a[0:15]
  ds_read_b64_tr_b16 v[48:49], v14 offset:12288
  ds_read_b64_tr_b16 v[50:51], v14 offset:13312
  ds_read_b64_tr_b16 v[52:53], v15 offset:12288
  v_mfma_f32_32x32x16_bf16 a[16:31], v[32:35], v[40:43], a[16:31]
  ds_read_b64_tr_b16 v[54:55], v15 offset:13312
  ds_read_b128 v[44:47], v13 offset:0
  s_waitcnt lgkmcnt(0)
  s_waitcnt vmcnt(8)
  s_barrier
  v_add_u32 v10, 0x8000, v10
  v_add_u32 v11, 0x8000, v11
  v_add_u32 v12, 0x8000, v12
  v_add_u32 v13, 0x8000, v13
  v_add_u32 v14, 0x8000, v14
  v_add_u32 v15, 0x8000, v15
  v_and_b32 v10, 0x1ffff, v10
  v_and_b32 v11, 0x1ffff, v11
  v_and_b32 v12, 0x1ffff, v12
  v_and_b32 v13, 0x1ffff, v13
  v_and_b32 v14, 0x1ffff, v14
  v_and_b32 v15, 0x1ffff, v15
  ds_read_b64_tr_b16 v[36:37], v14 offset:0
  ds_read_b64_tr_b16 v[38:39], v14 offset:1024
  ds_read_b64_tr_b16 v[40:41], v15 offset:0
  ds_read_b64_tr_b16 v[42:43], v15 offset:1024
  ds_read_b128 v[32:35], v10 offset:0
  s_mov_b32 m0, s45
  s_nop 0
  global_load_lds_dwordx4 v2, s[56:57] offset:0
  global_load_lds_dwordx4 v3, s[56:57] offset:1024
  s_mov_b32 m0, s46
  s_nop 0
  global_load_lds_dwordx4 v6, s[58:59] offset:0
  global_load_lds_dwordx4 v7, s[58:59] offset:1024
  s_add_u32 s56, s56, 128
  s_addc_u32 s57, s57, 0
  s_add_u32 s58, s58, s48
  s_addc_u32 s59, s59, 0
  s_add_u32 s45, s45, 0x8000
  s_add_u32 s46, s46, 0x8000
  s_and_b32 s45, s45, 0x1ffff
  s_and_b32 s46, s46, 0x1ffff
  v_mfma_f32_32x32x16_bf16 a[0:15], v[44:47], v[48:51], a[0:15]
  v_mfma_f32_32x32x16_bf16 a[16:31], v[44:47], v[52:55], a[16:31]
  s_sub_u32 s47, s47, 1
  s_cmp_lg_u32 s47, 0
  s_cbranch_scc1 G52
  s_waitcnt lgkmcnt(0)
  v_mfma_f32_32x32x16_bf16 a[0:15], v[32:35], v[36:39], a[0:15]
  ds_read_b64_tr_b16 v[48:49], v14 offset:4096
  ds_read_b64_tr_b16 v[50:51], v14 offset:5120
  ds_read_b64_tr_b16 v[52:53], v15 offset:4096
  v_mfma_f32_32x32x16_bf16 a[16:31], v[32:35], v[40:43], a[16:31]
  ds_read_b64_tr_b16 v[54:55], v15 offset:5120
  ds_read_b128 v[44:47], v11 offset:0
  s_waitcnt lgkmcnt(0)
  v_mfma_f32_32x32x16_bf16 a[0:15], v[44:47], v[48:51], a[0:15]
  ds_read_b64_tr_b16 v[36:37], v14 offset:8192
  ds_read_b64_tr_b16 v[38:39], v14 offset:9216
  ds_read_b64_tr_b16 v[40:41], v15 offset:8192
  v_mfma_f32_32x32x16_bf16 a[16:31], v[44:47], v[52:55], a[16:31]
  ds_read_b64_tr_b16 v[42:43], v15 offset:9216
  ds_read_b128 v[32:35], v12 offset:0
  s_waitcnt lgkmcnt(0)
  v_mfma_f32_32x32x16_bf16 a[0:15], v[32:35], v[36:39], a[0:15]
  ds_read_b64_tr_b16 v[48:49], v14 offset:12288
  ds_read_b64_tr_b16 v[50:51], v14 offset:13312
  ds_read_b64_tr_b16 v[52:53], v15 offset:12288
  v_mfma_f32_32x32x16_bf16 a[16:31], v[32:35], v[40:43], a[16:31]
  ds_read_b64_tr_b16 v[54:55], v15 offset:13312
  ds_read_b128 v[44:47], v13 offset:0
  s_waitcnt lgkmcnt(0)
  s_waitcnt vmcnt(8)
  s_barrier
  v_add_u32 v10, 0x8000, v10
  v_add_u32 v11, 0x8000, v11
  v_add_u32 v12, 0x8000, v12
  v_add_u32 v13, 0x8000, v13
  v_add_u32 v14, 0x8000, v14
  v_add_u32 v15, 0x8000, v15
  v_and_b32 v10, 0x1ffff, v10
  v_and_b32 v11, 0x1ffff, v11
  v_and_b32 v12, 0x1ffff, v12
  v_and_b32 v13, 0x1ffff, v13
  v_and_b32 v14, 0x1ffff, v14
  v_and_b32 v15, 0x1ffff, v15
  ds_read_b64_tr_b16 v[36:37], v14 offset:0
  ds_read_b64_tr_b16 v[38:39], v14 offset:1024
  ds_read_b64_tr_b16 v[40:41], v15 offset:0
  ds_read_b64_tr_b16 v[42:43], v15 offset:1024
  ds_read_b128 v[32:35], v10 offset:0
  v_mfma_f32_32x32x16_bf16 a[0:15], v[44:47], v[48:51], a[0:15]
  v_mfma_f32_32x32x16_bf16 a[16:31], v[44:47], v[52:55], a[16:31]
  s_waitcnt lgkmcnt(0)
  v_mfma_f32_32x32x16_bf16 a[0:15], v[32:35], v[36:39], a[0:15]
  ds_read_b64_tr_b16 v[48:49], v14 offset:4096
  ds_read_b64_tr_b16 v[50:51], v14 offset:5120
  ds_read_b64_tr_b16 v[52:53], v15 offset:4096
  v_mfma_f32_32x32x16_bf16 a[16:31], v[32:35], v[40:43], a[16:31]
  ds_read_b64_tr_b16 v[54:55], v15 offset:5120
  ds_read_b128 v[44:47], v11 offset:0
  s_waitcnt lgkmcnt(0)
  v_mfma_f32_32x32x16_bf16 a[0:15], v[44:47], v[48:51], a[0:15]
  ds_read_b64_tr_b16 v[36:37], v14 offset:8192
  ds_read_b64_tr_b16 v[38:39], v14 offset:9216
  ds_read_b64_tr_b16 v[40:41], v15 offset:8192
  v_mfma_f32_32x32x16_bf16 a[16:31], v[44:47], v[52:55], a[16:31]
  ds_read_b64_tr_b16 v[42:43], v15 offset:9216
  ds_read_b128 v[32:35], v12 offset:0
  s_waitcnt lgkmcnt(0)
  v_mfma_f32_32x32x16_bf16 a[0:15], v[32:35], v[36:39], a[0:15]
  ds_read_b64_tr_b16 v[48:49], v14 offset:12288
  ds_read_b64_tr_b16 v[50:51], v14 offset:13312
  ds_read_b64_tr_b16 v[52:53], v15 offset:12288
  v_mfma_f32_32x32x16_bf16 a[16:31], v[32:35], v[40:43], a[16:31]
  ds_read_b64_tr_b16 v[54:55], v15 offset:13312
  ds_read_b128 v[44:47], v13 offset:0
  s_waitcnt lgkmcnt(0)
  s_waitcnt vmcnt(4)
  s_barrier
  v_add_u32 v10, 0x8000, v10
  v_add_u32 v11, 0x8000, v11
  v_add_u32 v12, 0x8000, v12
  v_add_u32 v13, 0x8000, v13
  v_add_u32 v14, 0x8000, v14
  v_add_u32 v15, 0x8000, v15
  v_and_b32 v10, 0x1ffff, v10
  v_and_b32 v11, 0x1ffff, v11
  v_and_b32 v12, 0x1ffff, v12
  v_and_b32 v13, 0x1ffff, v13
  v_and_b32 v14, 0x1ffff, v14
  v_and_b32 v15, 0x1ffff, v15
  ds_read_b64_tr_b16 v[36:37], v14 offset:0
  ds_read_b64_tr_b16 v[38:39], v14 offset:1024
  ds_read_b64_tr_b16 v[40:41], v15 offset:0
  ds_read_b64_tr_b16 v[42:43], v15 offset:1024
  ds_read_b128 v[32:35], v10 offset:0
  v_mfma_f32_32x32x16_bf16 a[0:15], v[44:47], v[48:51], a[0:15]
  v_mfma_f32_32x32x16_bf16 a[16:31], v[44:47], v[52:55], a[16:31]
  s_waitcnt lgkmcnt(0)
  v_mfma_f32_32x32x16_bf16 a[0:15], v[32:35], v[36:39], a[0:15]
  ds_read_b64_tr_b16 v[48:49], v14 offset:4096
  ds_read_b64_tr_b16 v[50:51], v14 offset:5120
  ds_read_b64_tr_b16 v[52:53], v15 offset:4096
  v_mfma_f32_32x32x16_bf16 a[16:31], v[32:35], v[40:43], a[16:31]
  ds_read_b64_tr_b16 v[54:55], v15 offset:5120
  ds_read_b128 v[44:47], v11 offset:0
  s_waitcnt lgkmcnt(0)
  v_mfma_f32_32x32x16_bf16 a[0:15], v[44:47], v[48:51], a[0:15]
  ds_read_b64_tr_b16 v[36:37], v14 offset:8192
  ds_read_b64_tr_b16 v[38:39], v14 offset:9216
  ds_read_b64_tr_b16 v[40:41], v15 offset:8192
  v_mfma_f32_32x32x16_bf16 a[16:31], v[44:47], v[52:55], a[16:31]
  ds_read_b64_tr_b16 v[42:43], v15 offset:9216
  ds_read_b128 v[32:35], v12 offset:0
  s_waitcnt lgkmcnt(0)
  v_mfma_f32_32x32x16_bf16 a[0:15], v[32:35], v[36:39], a[0:15]
  ds_read_b64_tr_b16 v[48:49], v14 offset:12288
  ds_read_b64_tr_b16 v[50:51], v14 offset:13312
  ds_read_b64_tr_b16 v[52:53], v15 offset:12288
  v_mfma_f32_32x32x16_bf16 a[16:31], v[32:35], v[40:43], a[16:31]
  ds_read_b64_tr_b16 v[54:55], v15 offset:13312
  ds_read_b128 v[44:47], v13 offset:0
  s_waitcnt lgkmcnt(0)
  s_waitcnt vmcnt(0)
  s_barrier
  v_add_u32 v10, 0x8000, v10
  v_add_u32 v11, 0x8000, v11
  v_add_u32 v12, 0x8000, v12
  v_add_u32 v13, 0x8000, v13
  v_add_u32 v14, 0x8000, v14
  v_add_u32 v15, 0x8000, v15
  v_and_b32 v10, 0x1ffff, v10
  v_and_b32 v11, 0x1ffff, v11
  v_and_b32 v12, 0x1ffff, v12
  v_and_b32 v13, 0x1ffff, v13
  v_and_b32 v14, 0x1ffff, v14
  v_and_b32 v15, 0x1ffff, v15
  ds_read_b64_tr_b16 v[36:37], v14 offset:0
  ds_read_b64_tr_b16 v[38:39], v14 offset:1024
  ds_read_b64_tr_b16 v[40:41], v15 offset:0
  ds_read_b64_tr_b16 v[42:43], v15 offset:1024
  ds_read_b128 v[32:35], v10 offset:0
  v_mfma_f32_32x32x16_bf16 a[0:15], v[44:47], v[48:51], a[0:15]
  v_mfma_f32_32x32x16_bf16 a[16:31], v[44:47], v[52:55], a[16:31]
  s_waitcnt lgkmcnt(0)
  v_mfma_f32_32x32x16_bf16 a[0:15], v[32:35], v[36:39], a[0:15]
  ds_read_b64_tr_b16 v[48:49], v14 offset:4096
  ds_read_b64_tr_b16 v[50:51], v14 offset:5120
  ds_read_b64_tr_b16 v[52:53], v15 offset:4096
  v_mfma_f32_32x32x16_bf16 a[16:31], v[32:35], v[40:43], a[16:31]
  ds_read_b64_tr_b16 v[54:55], v15 offset:5120
  ds_read_b128 v[44:47], v11 offset:0
  s_waitcnt lgkmcnt(0)
  v_mfma_f32_32x32x16_bf16 a[0:15], v[44:47], v[48:51], a[0:15]
  ds_read_b64_tr_b16 v[36:37], v14 offset:8192
  ds_read_b64_tr_b16 v[38:39], v14 offset:9216
  ds_read_b64_tr_b16 v[40:41], v15 offset:8192
  v_mfma_f32_32x32x16_bf16 a[16:31], v[44:47], v[52:55], a[16:31]
  ds_read_b64_tr_b16 v[42:43], v15 offset:9216
  ds_read_b128 v[32:35], v12 offset:0
  s_waitcnt lgkmcnt(0)
  v_mfma_f32_32x32x16_bf16 a[0:15], v[32:35], v[36:39], a[0:15]
  ds_read_b64_tr_b16 v[48:49], v14 offset:12288
  ds_read_b64_tr_b16 v[50:51], v14 offset:13312
  ds_read_b64_tr_b16 v[52:53], v15 offset:12288
  v_mfma_f32_32x32x16_bf16 a[16:31], v[32:35], v[40:43], a[16:31]
  ds_read_b64_tr_b16 v[54:55], v15 offset:13312
  ds_read_b128 v[44:47], v13 offset:0
  s_waitcnt lgkmcnt(0)
  v_mfma_f32_32x32x16_bf16 a[0:15], v[44:47], v[48:51], a[0:15]
  v_mfma_f32_32x32x16_bf16 a[16:31], v[44:47], v[52:55], a[16:31]
  s_nop 11
L_K0E:
  s_barrier
  s_lshl_b32 s68, s34, 14
  s_cmp_ge_u32 s34, 4
  s_cbranch_scc1 L_K0O
  s_lshl_b32 s39, s34, 21
  s_lshl_b32 s43, s33, 6
  s_add_u32 s43, s43, s39
  s_add_u32 s66, s10, s43
  s_addc_u32 s67, s11, 0
  v_lshrrev_b32 v4, 2, v0
  v_and_b32 v5, 3, v0
  v_lshlrev_b32 v5, 4, v5
  s_mov_b32 s39, 8192
  v_mul_lo_u32 v4, v4, s39
  v_add_u32 v4, v4, v5
  v_add_u32 v5, 130048, v4
  v_add_u32 v6, 260096, v4
  v_add_u32 v7, 390144, v4
  s_mov_b64 s[94:95], s[66:67]
  s_mov_b32 m0, s68
  s_nop 0
  global_load_lds_dwordx4 v4, s[94:95] offset:0
  global_load_lds_dwordx4 v5, s[94:95] offset:1024
  global_load_lds_dwordx4 v6, s[94:95] offset:2048
  global_load_lds_dwordx4 v7, s[94:95] offset:3072
  s_add_u32 s94, s94, 524288
  s_addc_u32 s95, s95, 0
  s_add_u32 m0, m0, 4096
  s_nop 0
  global_load_lds_dwordx4 v4, s[94:95] offset:0
  global_load_lds_dwordx4 v5, s[94:95] offset:1024
  global_load_lds_dwordx4 v6, s[94:95] offset:2048
  global_load_lds_dwordx4 v7, s[94:95] offset:3072
  s_add_u32 s94, s94, 524288
  s_addc_u32 s95, s95, 0
  s_add_u32 m0, m0, 4096
  s_nop 0
  global_load_lds_dwordx4 v4, s[94:95] offset:0
  global_load_lds_dwordx4 v5, s[94:95] offset:1024
  global_load_lds_dwordx4 v6, s[94:95] offset:2048
  global_load_lds_dwordx4 v7, s[94:95] offset:3072
  s_add_u32 s94, s94, 524288
  s_addc_u32 s95, s95, 0
  s_add_u32 m0, m0, 4096
  s_nop 0
  global_load_lds_dwordx4 v4, s[94:95] offset:0
  global_load_lds_dwordx4 v5, s[94:95] offset:1024
  global_load_lds_dwordx4 v6, s[94:95] offset:2048
  global_load_lds_dwordx4 v7, s[94:95] offset:3072
  s_branch L_K0W
L_K0O:
  s_lshr_b32 s39, s33, 5
  s_lshl_b32 s39, s39, 21
  s_and_b32 s43, s34, 3
  s_lshl_b32 s43, s43, 19
  s_add_u32 s39, s39, s43
  s_and_b32 s43, s33, 31
  s_lshl_b32 s43, s43, 6
  s_add_u32 s43, s39, s43
  s_add_u32 s66, s14, s43
  s_addc_u32 s67, s15, 0
  v_lshrrev_b32 v4, 2, v0
  v_and_b32 v5, 3, v0
  v_lshlrev_b32 v5, 4, v5
  s_mov_b32 s39, 2048
  v_mul_lo_u32 v4, v4, s39
  v_add_u32 v4, v4, v5
  v_add_u32 v5, 31744, v4
  v_add_u32 v6, 63488, v4
  v_add_u32 v7, 95232, v4
  s_mov_b64 s[94:95], s[66:67]
  s_mov_b32 m0, s68
  s_nop 0
  global_load_lds_dwordx4 v4, s[94:95] offset:0
  global_load_lds_dwordx4 v5, s[94:95] offset:1024
  global_load_lds_dwordx4 v6, s[94:95] offset:2048
  global_load_lds_dwordx4 v7, s[94:95] offset:3072
  s_add_u32 s94, s94, 131072
  s_addc_u32 s95, s95, 0
  s_add_u32 m0, m0, 4096
  s_nop 0
  global_load_lds_dwordx4 v4, s[94:95] offset:0
  global_load_lds_dwordx4 v5, s[94:95] offset:1024
  global_load_lds_dwordx4 v6, s[94:95] offset:2048
  global_load_lds_dwordx4 v7, s[94:95] offset:3072
  s_add_u32 s94, s94, 131072
  s_addc_u32 s95, s95, 0
  s_add_u32 m0, m0, 4096
  s_nop 0
  global_load_lds_dwordx4 v4, s[94:95] offset:0
  global_load_lds_dwordx4 v5, s[94:95] offset:1024
  global_load_lds_dwordx4 v6, s[94:95] offset:2048
  global_load_lds_dwordx4 v7, s[94:95] offset:3072
  s_add_u32 s94, s94, 131072
  s_addc_u32 s95, s95, 0
  s_add_u32 m0, m0, 4096
  s_nop 0
  global_load_lds_dwordx4 v4, s[94:95] offset:0
  global_load_lds_dwordx4 v5, s[94:95] offset:1024
  global_load_lds_dwordx4 v6, s[94:95] offset:2048
  global_load_lds_dwordx4 v7, s[94:95] offset:3072
  s_cmp_lg_u32 s34, 4
  s_cbranch_scc1 L_K0W
  v_mov_b32 v8, 36
  v_mov_b32 v9, 1
  s_mov_b64 exec, 1
  global_atomic_add v8, v9, s[28:29] sc1
  s_mov_b64 exec, -1
L_K0W:
  s_lshl_b32 s43, s53, 2
  s_add_u32 s43, s43, s41
  s_lshl_b32 s43, s43, 18
  s_lshl_b32 s39, s55, 13
  s_add_u32 s43, s43, s39
  s_lshl_b32 s39, s42, 12
  s_add_u32 s43, s43, s39
  s_add_u32 s43, s43, s60
  s_add_u32 s66, s30, s43
  s_addc_u32 s67, s31, 0
  v_lshlrev_b32 v80, 4, v0
  v_accvgpr_read_b32 v84, a0
  v_accvgpr_read_b32 v85, a1
  v_accvgpr_read_b32 v86, a2
  v_accvgpr_read_b32 v87, a3
  v_accvgpr_read_b32 v88, a4
  v_accvgpr_read_b32 v89, a5
  v_accvgpr_read_b32 v90, a6
  v_accvgpr_read_b32 v91, a7
  v_cvt_pk_bf16_f32 v92, v84, v85
  v_cvt_pk_bf16_f32 v93, v86, v87
  v_cvt_pk_bf16_f32 v94, v88, v89
  v_cvt_pk_bf16_f32 v95, v90, v91
  global_store_dwordx4 v80, v[92:95], s[66:67] offset:0 sc1
  v_accvgpr_read_b32 v84, a8
  v_accvgpr_read_b32 v85, a9
  v_accvgpr_read_b32 v86, a10
  v_accvgpr_read_b32 v87, a11
  v_accvgpr_read_b32 v88, a12
  v_accvgpr_read_b32 v89, a13
  v_accvgpr_read_b32 v90, a14
  v_accvgpr_read_b32 v91, a15
  v_cvt_pk_bf16_f32 v96, v84, v85
  v_cvt_pk_bf16_f32 v97, v86, v87
  v_cvt_pk_bf16_f32 v98, v88, v89
  v_cvt_pk_bf16_f32 v99, v90, v91
  global_store_dwordx4 v80, v[96:99], s[66:67] offset:1024 sc1
  v_accvgpr_read_b32 v84, a16
  v_accvgpr_read_b32 v85, a17
  v_accvgpr_read_b32 v86, a18
  v_accvgpr_read_b32 v87, a19
  v_accvgpr_read_b32 v88, a20
  v_accvgpr_read_b32 v89, a21
  v_accvgpr_read_b32 v90, a22
  v_accvgpr_read_b32 v91, a23
  v_cvt_pk_bf16_f32 v100, v84, v85
  v_cvt_pk_bf16_f32 v101, v86, v87
  v_cvt_pk_bf16_f32 v102, v88, v89
  v_cvt_pk_bf16_f32 v103, v90, v91
  global_store_dwordx4 v80, v[100:103], s[66:67] offset:2048 sc1
  v_accvgpr_read_b32 v84, a24
  v_accvgpr_read_b32 v85, a25
  v_accvgpr_read_b32 v86, a26
  v_accvgpr_read_b32 v87, a27
  v_accvgpr_read_b32 v88, a28
  v_accvgpr_read_b32 v89, a29
  v_accvgpr_read_b32 v90, a30
  v_accvgpr_read_b32 v91, a31
  v_cvt_pk_bf16_f32 v104, v84, v85
  v_cvt_pk_bf16_f32 v105, v86, v87
  v_cvt_pk_bf16_f32 v106, v88, v89
  v_cvt_pk_bf16_f32 v107, v90, v91
  global_store_dwordx4 v80, v[104:107], s[66:67] offset:3072 sc1
  s_waitcnt vmcnt(0)
  s_barrier
  s_cmp_lg_u32 s34, 0
  s_cbranch_scc1 S53
  v_mov_b32 v2, 64
  v_mov_b32 v3, 1
  s_mov_b64 exec, 1
  global_atomic_add v2, v3, s[28:29] sc1
  s_mov_b64 exec, -1
S53:
  s_lshr_b32 s50, s33, 5
  s_and_b32 s51, s33, 31
  s_lshl_b32 s55, s34, 14
  s_lshl_b32 s70, s33, 11
  s_lshl_b32 s71, s33, 9
  s_lshl_b32 s72, s33, 10
  s_lshl_b32 s73, s50, 14
  s_mov_b32 s74, 16711935
  s_mov_b32 s75, 16711935
  s_mov_b32 s76, 4278255360
  s_mov_b32 s77, 4278255360
  s_mov_b32 s78, 0
  s_mov_b32 s79, -1
  s_mov_b32 s60, 0
  v_bfe_u32 v58, v0, 2, 2
  v_lshrrev_b32 v59, 4, v0
  v_lshl_add_u32 v58, v59, 2, v58
  v_lshlrev_b32 v58, 6, v58
  v_add_u32 v58, s55, v58
  v_and_b32 v60, 3, v0
  v_lshl_add_u32 v61, v60, 3, v58
  v_and_b32 v60, 1, v0
  v_lshl_add_u32 v58, v60, 3, v58
  v_bfe_u32 v60, v0, 1, 1
  v_lshl_add_u32 v58, v60, 5, v58
  v_and_b32 v60, 7, v0
  v_lshlrev_b32 v60, 4, v60
  v_lshl_add_u32 v55, v59, 7, v60
  v_bfe_u32 v62, v0, 3, 1
  v_lshl_add_u32 v56, v62, 9, v55
  s_and_b32 s54, s34, 3
  s_lshl_b32 s39, s54, 12
  v_add_u32 v56, s39, v56
  s_cmp_ge_u32 s34, 4
  s_cbranch_scc1 L_C_B
  s_lshl_b32 s39, s34, 21
  s_lshl_b32 s43, s33, 6
  s_add_u32 s43, s43, s39
  ds_read_b64_tr_b16 a[64:65], v58 offset:0
  ds_read_b64_tr_b16 a[66:67], v58 offset:1024
  ds_read_b64_tr_b16 a[68:69], v58 offset:2048
  ds_read_b64_tr_b16 a[70:71], v58 offset:3072
  ds_read_b64_tr_b16 a[72:73], v58 offset:4096
  ds_read_b64_tr_b16 a[74:75], v58 offset:5120
  ds_read_b64_tr_b16 a[76:77], v58 offset:6144
  ds_read_b64_tr_b16 a[78:79], v58 offset:7168
  ds_read_b64_tr_b16 a[80:81], v58 offset:8192
  ds_read_b64_tr_b16 a[82:83], v58 offset:9216
  ds_read_b64_tr_b16 a[84:85], v58 offset:10240
  ds_read_b64_tr_b16 a[86:87], v58 offset:11264
  ds_read_b64_tr_b16 a[88:89], v58 offset:12288
  ds_read_b64_tr_b16 a[90:91], v58 offset:13312
  ds_read_b64_tr_b16 a[92:93], v58 offset:14336
  ds_read_b64_tr_b16 a[94:95], v58 offset:15360
  ds_read_b64_tr_b16 a[96:97], v58 offset:16
  ds_read_b64_tr_b16 a[98:99], v58 offset:1040
  ds_read_b64_tr_b16 a[100:101], v58 offset:2064
  ds_read_b64_tr_b16 a[102:103], v58 offset:3088
  ds_read_b64_tr_b16 a[104:105], v58 offset:4112
  ds_read_b64_tr_b16 a[106:107], v58 offset:5136
  ds_read_b64_tr_b16 a[108:109], v58 offset:6160
  ds_read_b64_tr_b16 a[110:111], v58 offset:7184
  ds_read_b64_tr_b16 a[112:113], v58 offset:8208
  ds_read_b64_tr_b16 a[114:115], v58 offset:9232
  ds_read_b64_tr_b16 a[116:117], v58 offset:10256
  ds_read_b64_tr_b16 a[118:119], v58 offset:11280
  ds_read_b64_tr_b16 a[120:121], v58 offset:12304
  ds_read_b64_tr_b16 a[122:123], v58 offset:13328
  ds_read_b64_tr_b16 a[124:125], v58 offset:14352
  ds_read_b64_tr_b16 a[126:127], v58 offset:15376
  s_waitcnt lgkmcnt(0)
  s_add_u32 s56, s8, s43
  s_addc_u32 s57, s9, 0
  v_lshrrev_b32 v2, 2, v0
  v_and_b32 v3, 3, v0
  v_lshlrev_b32 v3, 4, v3
  s_mov_b32 s39, 8192
  v_mul_lo_u32 v2, v2, s39
  v_add_u32 v2, v2, v3
  v_add_u32 v3, 130048, v2
  v_add_u32 v4, 260096, v2
  v_add_u32 v5, 390144, v2
  s_mov_b64 s[94:95], s[56:57]
  s_mov_b32 m0, s55
  s_nop 0
  global_load_lds_dwordx4 v2, s[94:95] offset:0
  global_load_lds_dwordx4 v3, s[94:95] offset:1024
  global_load_lds_dwordx4 v4, s[94:95] offset:2048
  global_load_lds_dwordx4 v5, s[94:95] offset:3072
  s_add_u32 s94, s94, 524288
  s_addc_u32 s95, s95, 0
  s_add_u32 m0, m0, 4096
  s_nop 0
  global_load_lds_dwordx4 v2, s[94:95] offset:0
  global_load_lds_dwordx4 v3, s[94:95] offset:1024
  global_load_lds_dwordx4 v4, s[94:95] offset:2048
  global_load_lds_dwordx4 v5, s[94:95] offset:3072
  s_add_u32 s94, s94, 524288
  s_addc_u32 s95, s95, 0
  s_add_u32 m0, m0, 4096
  s_nop 0
  global_load_lds_dwordx4 v2, s[94:95] offset:0
  global_load_lds_dwordx4 v3, s[94:95] offset:1024
  global_load_lds_dwordx4 v4, s[94:95] offset:2048
  global_load_lds_dwordx4 v5, s[94:95] offset:3072
  s_add_u32 s94, s94, 524288
  s_addc_u32 s95, s95, 0
  s_add_u32 m0, m0, 4096
  s_nop 0
  global_load_lds_dwordx4 v2, s[94:95] offset:0
  global_load_lds_dwordx4 v3, s[94:95] offset:1024
  global_load_lds_dwordx4 v4, s[94:95] offset:2048
  global_load_lds_dwordx4 v5, s[94:95] offset:3072
  v_add_u32 v61, 0x10000, v61
  s_waitcnt vmcnt(0)
  ds_read_b64_tr_b16 a[0:1], v58 offset:0
  ds_read_b64_tr_b16 a[2:3], v58 offset:1024
  ds_read_b64_tr_b16 a[4:5], v58 offset:2048
  ds_read_b64_tr_b16 a[6:7], v58 offset:3072
  ds_read_b64_tr_b16 a[8:9], v58 offset:4096
  ds_read_b64_tr_b16 a[10:11], v58 offset:5120
  ds_read_b64_tr_b16 a[12:13], v58 offset:6144
  ds_read_b64_tr_b16 a[14:15], v58 offset:7168
  ds_read_b64_tr_b16 a[16:17], v58 offset:8192
  ds_read_b64_tr_b16 a[18:19], v58 offset:9216
  ds_read_b64_tr_b16 a[20:21], v58 offset:10240
  ds_read_b64_tr_b16 a[22:23], v58 offset:11264
  ds_read_b64_tr_b16 a[24:25], v58 offset:12288
  ds_read_b64_tr_b16 a[26:27], v58 offset:13312
  ds_read_b64_tr_b16 a[28:29], v58 offset:14336
  ds_read_b64_tr_b16 a[30:31], v58 offset:15360
  ds_read_b64_tr_b16 a[32:33], v58 offset:16
  ds_read_b64_tr_b16 a[34:35], v58 offset:1040
  ds_read_b64_tr_b16 a[36:37], v58 offset:2064
  ds_read_b64_tr_b16 a[38:39], v58 offset:3088
  ds_read_b64_tr_b16 a[40:41], v58 offset:4112
  ds_read_b64_tr_b16 a[42:43], v58 offset:5136
  ds_read_b64_tr_b16 a[44:45], v58 offset:6160
  ds_read_b64_tr_b16 a[46:47], v58 offset:7184
  ds_read_b64_tr_b16 a[48:49], v58 offset:8208
  ds_read_b64_tr_b16 a[50:51], v58 offset:9232
  ds_read_b64_tr_b16 a[52:53], v58 offset:10256
  ds_read_b64_tr_b16 a[54:55], v58 offset:11280
  ds_read_b64_tr_b16 a[56:57], v58 offset:12304
  ds_read_b64_tr_b16 a[58:59], v58 offset:13328
  ds_read_b64_tr_b16 a[60:61], v58 offset:14352
  ds_read_b64_tr_b16 a[62:63], v58 offset:15376
  s_waitcnt lgkmcnt(0)
  v_and_b32 v60, 7, v0
  v_lshlrev_b32 v60, 11, v60
  v_lshl_add_u32 v60, v59, 3, v60
  v_lshl_add_u32 v63, v62, 6, v60
  s_lshl_b32 s39, s34, 9
  s_add_u32 s56, s6, s39
  s_addc_u32 s57, s7, 0
  s_mul_i32 s39, s34, 3072
  v_lshl_add_u32 v57, v0, 4, s39
  s_barrier
  ds_read_b64_tr_b16 v[64:65], v61 offset:0
  ds_read_b64_tr_b16 v[66:67], v61 offset:1024
  ds_read_b64_tr_b16 v[68:69], v61 offset:2048
  ds_read_b64_tr_b16 v[70:71], v61 offset:3072
  ds_read_b64_tr_b16 v[72:73], v61 offset:4096
  ds_read_b64_tr_b16 v[74:75], v61 offset:5120
  ds_read_b64_tr_b16 v[76:77], v61 offset:6144
  ds_read_b64_tr_b16 v[78:79], v61 offset:7168
  ds_read_b64_tr_b16 v[80:81], v61 offset:8192
  ds_read_b64_tr_b16 v[82:83], v61 offset:9216
  ds_read_b64_tr_b16 v[84:85], v61 offset:10240
  ds_read_b64_tr_b16 v[86:87], v61 offset:11264
  ds_read_b64_tr_b16 v[88:89], v61 offset:12288
  ds_read_b64_tr_b16 v[90:91], v61 offset:13312
  ds_read_b64_tr_b16 v[92:93], v61 offset:14336
  ds_read_b64_tr_b16 v[94:95], v61 offset:15360
  ds_read_b64_tr_b16 v[96:97], v61 offset:32
  ds_read_b64_tr_b16 v[98:99], v61 offset:1056
  ds_read_b64_tr_b16 v[100:101], v61 offset:2080
  ds_read_b64_tr_b16 v[102:103], v61 offset:3104
  ds_read_b64_tr_b16 v[104:105], v61 offset:4128
  ds_read_b64_tr_b16 v[106:107], v61 offset:5152
  ds_read_b64_tr_b16 v[108:109], v61 offset:6176
  ds_read_b64_tr_b16 v[110:111], v61 offset:7200
  ds_read_b64_tr_b16 v[112:113], v61 offset:8224
  ds_read_b64_tr_b16 v[114:115], v61 offset:9248
  ds_read_b64_tr_b16 v[116:117], v61 offset:10272
  ds_read_b64_tr_b16 v[118:119], v61 offset:11296
  ds_read_b64_tr_b16 v[120:121], v61 offset:12320
  ds_read_b64_tr_b16 v[122:123], v61 offset:13344
  ds_read_b64_tr_b16 v[124:125], v61 offset:14368
  ds_read_b64_tr_b16 v[126:127], v61 offset:15392
  s_waitcnt lgkmcnt(0)
  s_barrier
  global_load_dwordx2 v[0:1], v63, s[56:57] offset:0
  global_load_dwordx2 v[2:3], v63, s[56:57] offset:32
  global_load_dwordx2 v[4:5], v63, s[56:57] offset:128
  global_load_dwordx2 v[6:7], v63, s[56:57] offset:160
  global_load_dwordx2 v[8:9], v63, s[56:57] offset:256
  global_load_dwordx2 v[10:11], v63, s[56:57] offset:288
  global_load_dwordx2 v[12:13], v63, s[56:57] offset:384
  global_load_dwordx2 v[14:15], v63, s[56:57] offset:416
  s_waitcnt vmcnt(0)
  s_branch L_CQ_M
L_CQ:
  s_sleep 3
  s_mov_b32 s38, 524288
P54:
  s_sub_u32 s38, s38, 1
  s_cbranch_scc1 L_END
  global_load_dwordx4 v[0:3], v56, s[56:57] offset:0 sc1
  global_load_dwordx4 v[4:7], v56, s[56:57] offset:1024 sc1
  global_load_dwordx4 v[8:11], v56, s[56:57] offset:2048 sc1
  global_load_dwordx4 v[12:15], v56, s[56:57] offset:3072 sc1
  s_waitcnt vmcnt(0)
  v_max3_u32 v58, v0, v1, v2
  v_max3_u32 v59, v8, v9, v10
  v_max3_u32 v58, v58, v3, v4
  v_max3_u32 v59, v59, v11, v12
  v_max3_u32 v58, v58, v5, v6
  v_max3_u32 v59, v59, v13, v14
  v_max_u32 v58, v58, v7
  v_max_u32 v59, v59, v15
  v_max_u32 v58, v58, v59
  v_cmp_eq_u32 vcc, -1, v58
  s_nop 0
  s_cbranch_vccnz P54
PD55:
L_CQ_M:
  v_mfma_f32_16x16x32_bf16 v[16:19], a[0:3], v[0:3], 0
  v_mfma_f32_16x16x32_bf16 v[24:27], a[32:35], v[0:3], 0
  v_mfma_f32_16x16x32_bf16 v[32:35], a[64:67], v[0:3], 0
  v_mfma_f32_16x16x32_bf16 v[40:43], a[96:99], v[0:3], 0
  v_mfma_f32_16x16x32_bf16 v[20:23], a[4:7], v[0:3], 0
  v_mfma_f32_16x16x32_bf16 v[28:31], a[36:39], v[0:3], 0
  v_mfma_f32_16x16x32_bf16 v[36:39], a[68:71], v[0:3], 0
  v_mfma_f32_16x16x32_bf16 v[44:47], a[100:103], v[0:3], 0
  v_mfma_f32_16x16x32_bf16 v[16:19], a[8:11], v[4:7], v[16:19]
  v_mfma_f32_16x16x32_bf16 v[24:27], a[40:43], v[4:7], v[24:27]
  v_mfma_f32_16x16x32_bf16 v[32:35], a[72:75], v[4:7], v[32:35]
  v_mfma_f32_16x16x32_bf16 v[40:43], a[104:107], v[4:7], v[40:43]
  v_mfma_f32_16x16x32_bf16 v[20:23], a[12:15], v[4:7], v[20:23]
  v_mfma_f32_16x16x32_bf16 v[28:31], a[44:47], v[4:7], v[28:31]
  v_mfma_f32_16x16x32_bf16 v[36:39], a[76:79], v[4:7], v[36:39]
  v_mfma_f32_16x16x32_bf16 v[44:47], a[108:111], v[4:7], v[44:47]
  v_mfma_f32_16x16x32_bf16 v[16:19], a[16:19], v[8:11], v[16:19]
  v_mfma_f32_16x16x32_bf16 v[24:27], a[48:51], v[8:11], v[24:27]
  v_mfma_f32_16x16x32_bf16 v[32:35], a[80:83], v[8:11], v[32:35]
  v_mfma_f32_16x16x32_bf16 v[40:43], a[112:115], v[8:11], v[40:43]
  v_mfma_f32_16x16x32_bf16 v[20:23], a[20:23], v[8:11], v[20:23]
  v_mfma_f32_16x16x32_bf16 v[28:31], a[52:55], v[8:11], v[28:31]
  v_mfma_f32_16x16x32_bf16 v[36:39], a[84:87], v[8:11], v[36:39]
  v_mfma_f32_16x16x32_bf16 v[44:47], a[116:119], v[8:11], v[44:47]
  v_mfma_f32_16x16x32_bf16 v[16:19], a[24:27], v[12:15], v[16:19]
  v_mfma_f32_16x16x32_bf16 v[24:27], a[56:59], v[12:15], v[24:27]
  v_mfma_f32_16x16x32_bf16 v[32:35], a[88:91], v[12:15], v[32:35]
  v_mfma_f32_16x16x32_bf16 v[40:43], a[120:123], v[12:15], v[40:43]
  v_mfma_f32_16x16x32_bf16 v[20:23], a[28:31], v[12:15], v[20:23]
  v_mfma_f32_16x16x32_bf16 v[28:31], a[60:63], v[12:15], v[28:31]
  v_mfma_f32_16x16x32_bf16 v[36:39], a[92:95], v[12:15], v[36:39]
  v_mfma_f32_16x16x32_bf16 v[44:47], a[124:127], v[12:15], v[44:47]
  s_nop 5
  v_add_f32_dpp v16, v20, v16 row_shl:8 row_mask:0xf bank_mask:0x3
  v_add_f32_dpp v17, v21, v17 row_shl:8 row_mask:0xf bank_mask:0x3
  v_add_f32_dpp v18, v22, v18 row_shl:8 row_mask:0xf bank_mask:0x3
  v_add_f32_dpp v19, v23, v19 row_shl:8 row_mask:0xf bank_mask:0x3
  v_add_f32_dpp v16, v24, v28 row_shr:8 row_mask:0xf bank_mask:0xc
  v_add_f32_dpp v17, v25, v29 row_shr:8 row_mask:0xf bank_mask:0xc
  v_add_f32_dpp v18, v26, v30 row_shr:8 row_mask:0xf bank_mask:0xc
  v_add_f32_dpp v19, v27, v31 row_shr:8 row_mask:0xf bank_mask:0xc
  ds_write_b128 v57, v[16:19]
  v_add_f32_dpp v32, v36, v32 row_shl:8 row_mask:0xf bank_mask:0x3
  v_add_f32_dpp v33, v37, v33 row_shl:8 row_mask:0xf bank_mask:0x3
  v_add_f32_dpp v34, v38, v34 row_shl:8 row_mask:0xf bank_mask:0x3
  v_add_f32_dpp v35, v39, v35 row_shl:8 row_mask:0xf bank_mask:0x3
  v_add_f32_dpp v32, v40, v44 row_shr:8 row_mask:0xf bank_mask:0xc
  v_add_f32_dpp v33, v41, v45 row_shr:8 row_mask:0xf bank_mask:0xc
  v_add_f32_dpp v34, v42, v46 row_shr:8 row_mask:0xf bank_mask:0xc
  v_add_f32_dpp v35, v43, v47 row_shr:8 row_mask:0xf bank_mask:0xc
  ds_write_b128 v57, v[32:35] offset:1024
  s_waitcnt lgkmcnt(0)
  s_barrier
  v_mfma_f32_16x16x32_bf16 v[16:19], v[0:3], v[64:67], 0
  v_mfma_f32_16x16x32_bf16 v[24:27], v[0:3], v[96:99], 0
  v_mfma_f32_16x16x32_bf16 v[20:23], v[0:3], v[68:71], 0
  v_mfma_f32_16x16x32_bf16 v[28:31], v[0:3], v[100:103], 0
  v_mfma_f32_16x16x32_bf16 v[16:19], v[4:7], v[72:75], v[16:19]
  v_mfma_f32_16x16x32_bf16 v[24:27], v[4:7], v[104:107], v[24:27]
  v_mfma_f32_16x16x32_bf16 v[20:23], v[4:7], v[76:79], v[20:23]
  v_mfma_f32_16x16x32_bf16 v[28:31], v[4:7], v[108:111], v[28:31]
  v_mfma_f32_16x16x32_bf16 v[16:19], v[8:11], v[80:83], v[16:19]
  v_mfma_f32_16x16x32_bf16 v[24:27], v[8:11], v[112:115], v[24:27]
  v_mfma_f32_16x16x32_bf16 v[20:23], v[8:11], v[84:87], v[20:23]
  v_mfma_f32_16x16x32_bf16 v[28:31], v[8:11], v[116:119], v[28:31]
  v_mfma_f32_16x16x32_bf16 v[16:19], v[12:15], v[88:91], v[16:19]
  v_mfma_f32_16x16x32_bf16 v[24:27], v[12:15], v[120:123], v[24:27]
  v_mfma_f32_16x16x32_bf16 v[20:23], v[12:15], v[92:95], v[20:23]
  v_mfma_f32_16x16x32_bf16 v[28:31], v[12:15], v[124:127], v[28:31]
  s_nop 7
  v_permlane32_swap_b32 v20, v24
  v_permlane32_swap_b32 v21, v25
  v_permlane32_swap_b32 v22, v26
  v_permlane32_swap_b32 v23, v27
  v_cndmask_b32 v16, v16, v28, s[78:79]
  v_cndmask_b32 v17, v17, v29, s[78:79]
  v_cndmask_b32 v18, v18, v30, s[78:79]
  v_cndmask_b32 v19, v19, v31, s[78:79]
  v_cndmask_b32 v24, v24, v20, s[78:79]
  v_cndmask_b32 v25, v25, v21, s[78:79]
  v_cndmask_b32 v26, v26, v22, s[78:79]
  v_cndmask_b32 v27, v27, v23, s[78:79]
  v_pk_add_f32 v[16:17], v[16:17], v[24:25]
  v_pk_add_f32 v[18:19], v[18:19], v[26:27]
  ds_write_b128 v57, v[16:19] offset:2048
  s_waitcnt lgkmcnt(0)
  s_barrier
  s_cmp_eq_u32 s60, 63
  s_cbranch_scc1 L_END
  s_add_u32 s60, s60, 1
  s_add_u32 s39, s60, 0
  s_and_b32 s39, s39, 3
  s_lshl_b32 s39, s39, 19
  s_add_u32 s39, s39, s73
  s_add_u32 s56, s30, s39
  s_addc_u32 s57, s31, 0
  s_add_u32 s56, s56, 84344832
  s_addc_u32 s57, s57, 0
  s_barrier
  s_barrier
  s_barrier
  s_branch L_CQ
L_C_B:
  ds_read_b64_tr_b16 a[0:1], v61 offset:0
  ds_read_b64_tr_b16 a[2:3], v61 offset:1024
  ds_read_b64_tr_b16 a[4:5], v61 offset:2048
  ds_read_b64_tr_b16 a[6:7], v61 offset:3072
  ds_read_b64_tr_b16 a[8:9], v61 offset:4096
  ds_read_b64_tr_b16 a[10:11], v61 offset:5120
  ds_read_b64_tr_b16 a[12:13], v61 offset:6144
  ds_read_b64_tr_b16 a[14:15], v61 offset:7168
  ds_read_b64_tr_b16 a[16:17], v61 offset:8192
  ds_read_b64_tr_b16 a[18:19], v61 offset:9216
  ds_read_b64_tr_b16 a[20:21], v61 offset:10240
  ds_read_b64_tr_b16 a[22:23], v61 offset:11264
  ds_read_b64_tr_b16 a[24:25], v61 offset:12288
  ds_read_b64_tr_b16 a[26:27], v61 offset:13312
  ds_read_b64_tr_b16 a[28:29], v61 offset:14336
  ds_read_b64_tr_b16 a[30:31], v61 offset:15360
  ds_read_b64_tr_b16 a[32:33], v61 offset:32
  ds_read_b64_tr_b16 a[34:35], v61 offset:1056
  ds_read_b64_tr_b16 a[36:37], v61 offset:2080
  ds_read_b64_tr_b16 a[38:39], v61 offset:3104
  ds_read_b64_tr_b16 a[40:41], v61 offset:4128
  ds_read_b64_tr_b16 a[42:43], v61 offset:5152
  ds_read_b64_tr_b16 a[44:45], v61 offset:6176
  ds_read_b64_tr_b16 a[46:47], v61 offset:7200
  ds_read_b64_tr_b16 a[48:49], v61 offset:8224
  ds_read_b64_tr_b16 a[50:51], v61 offset:9248
  ds_read_b64_tr_b16 a[52:53], v61 offset:10272
  ds_read_b64_tr_b16 a[54:55], v61 offset:11296
  ds_read_b64_tr_b16 a[56:57], v61 offset:12320
  ds_read_b64_tr_b16 a[58:59], v61 offset:13344
  ds_read_b64_tr_b16 a[60:61], v61 offset:14368
  ds_read_b64_tr_b16 a[62:63], v61 offset:15392
  s_lshl_b32 s39, s54, 21
  s_lshl_b32 s43, s33, 6
  s_add_u32 s43, s43, s39
  s_waitcnt lgkmcnt(0)
  s_add_u32 s56, s12, s43
  s_addc_u32 s57, s13, 0
  v_lshrrev_b32 v2, 2, v0
  v_and_b32 v3, 3, v0
  v_lshlrev_b32 v3, 4, v3
  s_mov_b32 s39, 8192
  v_mul_lo_u32 v2, v2, s39
  v_add_u32 v2, v2, v3
  v_add_u32 v3, 130048, v2
  v_add_u32 v4, 260096, v2
  v_add_u32 v5, 390144, v2
  s_mov_b64 s[94:95], s[56:57]
  s_mov_b32 m0, s55
  s_nop 0
  global_load_lds_dwordx4 v2, s[94:95] offset:0
  global_load_lds_dwordx4 v3, s[94:95] offset:1024
  global_load_lds_dwordx4 v4, s[94:95] offset:2048
  global_load_lds_dwordx4 v5, s[94:95] offset:3072
  s_add_u32 s94, s94, 524288
  s_addc_u32 s95, s95, 0
  s_add_u32 m0, m0, 4096
  s_nop 0
  global_load_lds_dwordx4 v2, s[94:95] offset:0
  global_load_lds_dwordx4 v3, s[94:95] offset:1024
  global_load_lds_dwordx4 v4, s[94:95] offset:2048
  global_load_lds_dwordx4 v5, s[94:95] offset:3072
  s_add_u32 s94, s94, 524288
  s_addc_u32 s95, s95, 0
  s_add_u32 m0, m0, 4096
  s_nop 0
  global_load_lds_dwordx4 v2, s[94:95] offset:0
  global_load_lds_dwordx4 v3, s[94:95] offset:1024
  global_load_lds_dwordx4 v4, s[94:95] offset:2048
  global_load_lds_dwordx4 v5, s[94:95] offset:3072
  s_add_u32 s94, s94, 524288
  s_addc_u32 s95, s95, 0
  s_add_u32 m0, m0, 4096
  s_nop 0
  global_load_lds_dwordx4 v2, s[94:95] offset:0
  global_load_lds_dwordx4 v3, s[94:95] offset:1024
  global_load_lds_dwordx4 v4, s[94:95] offset:2048
  global_load_lds_dwordx4 v5, s[94:95] offset:3072
  v_and_b32 v16, 7, v0
  v_lshlrev_b32 v16, 2, v16
  s_mov_b32 s38, 524288
R56:
  s_sub_u32 s38, s38, 1
  s_cbranch_scc1 L_END
  global_load_dword v17, v16, s[28:29] sc1
  s_waitcnt vmcnt(0)
  s_mov_b32 s32, 0
  v_cmp_ne_u32 vcc, 32, v17
  s_nop 0
  s_cbranch_vccz RD57
  s_mov_b32 s32, 1
  v_cmp_lt_u32 vcc, 32, v17
  s_nop 0
  s_cbranch_vccz R56
RD57:
  v_lshlrev_b32 v1, 4, v0
  v_mov_b32 v4, -1
  v_mov_b32 v5, -1
  v_mov_b32 v6, -1
  v_mov_b32 v7, -1
  v_and_b32 v2, 0x1ff, v1
  s_mov_b32 s60, s54
  s_mov_b32 s60, 0
  s_waitcnt lgkmcnt(0)
  v_mov_b32 v8, v55
  v_mov_b32 v9, v56
  s_lshl_b32 s39, s54, 10
  s_add_u32 s39, s39, 0x4000
  v_add_u32 v10, s39, v1
  v_lshrrev_b32 v13, 5, v0
  v_lshlrev_b32 v13, 10, v13
  v_bfe_u32 v14, v0, 4, 1
  v_lshl_add_u32 v13, v14, 9, v13
  v_and_b32 v14, 7, v0
  v_lshl_add_u32 v14, v62, 4, v14
  v_lshl_add_u32 v11, v14, 4, v13
  v_and_b32 v14, 15, v0
  v_lshl_add_u32 v12, v14, 4, v13
  v_lshlrev_b32 v14, 4, v14
  v_bfe_u32 v13, v0, 4, 1
  v_lshl_add_u32 v13, v13, 3, v14
  v_lshrrev_b32 v14, 5, v0
  v_lshl_add_u32 v13, v14, 8, v13
  v_lshl_add_u32 v14, v62, 3, v55
  v_lshlrev_b32 v15, 3, v0
  v_mov_b32 v3, 0xff800000
  s_waitcnt vmcnt(0)
  s_barrier
  s_cmp_lg_u32 s54, 0
  s_cbranch_scc1 L_C_I
  v_mov_b32 v16, 36
  s_mov_b32 s38, 524288
W58:
  global_load_dword v17, v16, s[28:29] sc1
  s_waitcnt vmcnt(0)
  v_readfirstlane_b32 s39, v17
  s_cmp_ge_u32 s39, 128
  s_cbranch_scc1 WD59
  s_sleep 1
  s_sub_u32 s38, s38, 1
  s_cbranch_scc1 L_END
  s_branch W58
WD59:
  s_mov_b32 s61, 0
  s_and_b32 s39, s61, 7
  s_cmp_lg_u32 s39, 0
  s_cbranch_scc1 K60
  s_lshr_b32 s62, s61, 1
  s_add_u32 s39, s62, 64
  v_mov_b32 v16, s39
  s_mov_b32 s38, 524288
W61:
  global_load_dword v17, v16, s[28:29] sc1
  s_waitcnt vmcnt(0)
  v_readfirstlane_b32 s39, v17
  s_cmp_ge_u32 s39, 128
  s_cbranch_scc1 WD62
  s_sleep 1
  s_sub_u32 s38, s38, 1
  s_cbranch_scc1 L_END
  s_branch W61
WD62:
K60:
  s_lshl_b32 s39, s61, 18
  s_add_u32 s43, s70, s39
  s_add_u32 s56, s30, s43
  s_addc_u32 s57, s31, 0
  s_add_u32 s56, s56, 16777216
  s_addc_u32 s57, s57, 0
  s_add_u32 s58, s30, s43
  s_addc_u32 s59, s31, 0
  s_add_u32 s58, s58, 33554432
  s_addc_u32 s59, s59, 0
  global_load_dwordx4 v[64:67], v11, s[56:57] sc1
  global_load_dwordx4 v[68:71], v11, s[56:57] offset:128 sc1
  global_load_dwordx4 v[72:75], v12, s[58:59] sc1
  global_load_dwordx4 v[76:79], v12, s[58:59] offset:256 sc1
L_C_I:
  s_add_u32 s39, s60, 0
  s_and_b32 s39, s39, 3
  s_lshl_b32 s39, s39, 19
  s_add_u32 s39, s39, s70
  s_add_u32 s56, s30, s39
  s_addc_u32 s57, s31, 0
  s_add_u32 s56, s56, 83886080
  s_addc_u32 s57, s57, 0
  s_add_u32 s39, s60, 0
  s_and_b32 s39, s39, 3
  s_lshl_b32 s39, s39, 19
  s_add_u32 s39, s39, s71
  s_add_u32 s58, s30, s39
  s_addc_u32 s59, s31, 0
  s_add_u32 s58, s58, 84148224
  s_addc_u32 s59, s59, 0
  s_xor_b32 s43, s33, 1
  s_lshl_b32 s43, s43, 11
  s_add_u32 s39, s60, 0
  s_and_b32 s39, s39, 3
  s_lshl_b32 s39, s39, 19
  s_add_u32 s39, s39, s43
  s_add_u32 s64, s30, s39
  s_addc_u32 s65, s31, 0
  s_add_u32 s64, s64, 83886080
  s_addc_u32 s65, s65, 0
  s_xor_b32 s43, s33, 2
  s_lshl_b32 s43, s43, 11
  s_add_u32 s39, s60, 0
  s_and_b32 s39, s39, 3
  s_lshl_b32 s39, s39, 19
  s_add_u32 s39, s39, s43
  s_add_u32 s66, s30, s39
  s_addc_u32 s67, s31, 0
  s_add_u32 s66, s66, 83886080
  s_addc_u32 s67, s67, 0
  s_xor_b32 s43, s33, 3
  s_lshl_b32 s43, s43, 11
  s_add_u32 s39, s60, 0
  s_and_b32 s39, s39, 3
  s_lshl_b32 s39, s39, 19
  s_add_u32 s39, s39, s43
  s_add_u32 s68, s30, s39
  s_addc_u32 s69, s31, 0
  s_add_u32 s68, s68, 83886080
  s_addc_u32 s69, s69, 0
  s_barrier
L_CW:
  s_barrier
  s_cmp_eq_u32 s54, 0
  s_cbranch_scc1 L_CW_A
  s_cmp_eq_u32 s54, 2
  s_cbranch_scc1 L_CW_K
  s_barrier
  s_branch L_CW_O
L_CW_K:
  ds_read_b128 v[20:23], v1 offset:1024
  ds_read_b128 v[28:31], v1 offset:4096
  ds_read_b128 v[36:39], v1 offset:7168
  ds_read_b128 v[44:47], v1 offset:10240
  s_lshl_b32 s39, s60, 16
  s_add_u32 s43, s39, s71
  s_add_u32 s64, s30, s43
  s_addc_u32 s65, s31, 0
  s_add_u32 s64, s64, 75497472
  s_addc_u32 s65, s65, 0
  s_add_u32 s66, s30, s43
  s_addc_u32 s67, s31, 0
  s_add_u32 s66, s66, 79691776
  s_addc_u32 s67, s67, 0
  s_waitcnt lgkmcnt(0)
  v_pk_add_f32 v[20:21], v[20:21], v[28:29]
  v_pk_add_f32 v[22:23], v[22:23], v[30:31]
  v_pk_add_f32 v[36:37], v[36:37], v[44:45]
  v_pk_add_f32 v[38:39], v[38:39], v[46:47]
  v_pk_add_f32 v[20:21], v[20:21], v[36:37]
  v_pk_add_f32 v[22:23], v[22:23], v[38:39]
  v_cvt_pk_bf16_f32 v28, v20, v21
  v_cvt_pk_bf16_f32 v29, v22, v23
  v_mov_b32 v40, v28
  v_mov_b32 v41, v29
  s_barrier
  ds_read_b128 v[48:51], v1 offset:2048
  ds_read_b128 v[52:55], v1 offset:5120
  ds_read_b128 v[56:59], v1 offset:8192
  ds_read_b128 v[60:63], v1 offset:11264
  s_waitcnt lgkmcnt(0)
  v_pk_add_f32 v[48:49], v[48:49], v[52:53]
  v_pk_add_f32 v[50:51], v[50:51], v[54:55]
  v_pk_add_f32 v[56:57], v[56:57], v[60:61]
  v_pk_add_f32 v[58:59], v[58:59], v[62:63]
  v_pk_add_f32 v[48:49], v[48:49], v[56:57]
  v_pk_add_f32 v[50:51], v[50:51], v[58:59]
  v_cvt_pk_bf16_f32 v44, v48, v49
  v_cvt_pk_bf16_f32 v45, v50, v51
  s_cmp_eq_u32 s60, 63
  s_cbranch_scc1 L_CA_F
  s_branch L_CW_O
L_CW_A:
  ds_read_b128 v[16:19], v1 offset:0
  ds_read_b128 v[20:23], v1 offset:1024
  ds_read_b128 v[24:27], v1 offset:3072
  ds_read_b128 v[28:31], v1 offset:4096
  ds_read_b128 v[32:35], v1 offset:6144
  ds_read_b128 v[36:39], v1 offset:7168
  ds_read_b128 v[40:43], v1 offset:9216
  ds_read_b128 v[44:47], v1 offset:10240
  s_cmp_eq_u32 s60, 63
  s_cbranch_scc1 L_CA_X
  s_waitcnt lgkmcnt(4)
  v_pk_add_f32 v[16:17], v[16:17], v[24:25]
  v_pk_add_f32 v[18:19], v[18:19], v[26:27]
  v_pk_add_f32 v[20:21], v[20:21], v[28:29]
  v_pk_add_f32 v[22:23], v[22:23], v[30:31]
  s_waitcnt lgkmcnt(0)
  v_pk_add_f32 v[32:33], v[32:33], v[40:41]
  v_pk_add_f32 v[34:35], v[34:35], v[42:43]
  v_pk_add_f32 v[36:37], v[36:37], v[44:45]
  v_pk_add_f32 v[38:39], v[38:39], v[46:47]
  v_pk_add_f32 v[16:17], v[16:17], v[32:33]
  v_pk_add_f32 v[18:19], v[18:19], v[34:35]
  v_pk_add_f32 v[20:21], v[20:21], v[36:37]
  v_pk_add_f32 v[22:23], v[22:23], v[38:39]
  v_cvt_pk_bf16_f32 v24, v16, v17
  v_cvt_pk_bf16_f32 v25, v18, v19
  v_cvt_pk_bf16_f32 v26, v16, v17
  v_cvt_pk_bf16_f32 v27, v18, v19
  v_cvt_pk_bf16_f32 v28, v20, v21
  v_cvt_pk_bf16_f32 v29, v22, v23
  v_mov_b32_dpp v26, v24 row_shl:8 row_mask:0xf bank_mask:0x3
  v_mov_b32_dpp v27, v25 row_shl:8 row_mask:0xf bank_mask:0x3
  v_mov_b32_dpp v24, v24 row_shr:8 row_mask:0xf bank_mask:0xc
  v_mov_b32_dpp v25, v25 row_shr:8 row_mask:0xf bank_mask:0xc
  v_mov_b32_dpp v30, v28 row_shl:8 row_mask:0xf bank_mask:0xf bound_ctrl:0
  v_mov_b32_dpp v31, v29 row_shl:8 row_mask:0xf bank_mask:0xf bound_ctrl:0
  s_waitcnt vmcnt(0)
  v_mfma_f32_16x16x32_bf16 v[36:39], v[64:67], v[24:27], 0
  v_mfma_f32_16x16x32_bf16 v[40:43], v[68:71], v[24:27], 0
  v_mfma_f32_16x16x32_bf16 v[32:35], v[28:31], v[24:27], 0
  s_nop 6
  v_cndmask_b32 v36, v36, v40, s[76:77]
  v_cndmask_b32 v37, v37, v41, s[76:77]
  v_cndmask_b32 v38, v38, v42, s[76:77]
  v_cndmask_b32 v39, v39, v43, s[76:77]
  v_cndmask_b32 v40, v32, v34, s[76:77]
  v_cndmask_b32 v41, v33, v35, s[76:77]
  s_cmp_eq_u32 s32, 0
  s_cbranch_scc1 F63
  global_store_dwordx4 v1, v[36:39], s[56:57] sc1
  global_store_dwordx2 v15, v[40:41], s[56:57] offset:1024 sc1
  s_branch E64
F63:
  global_store_dwordx4 v1, v[36:39], s[56:57]
  global_store_dwordx2 v15, v[40:41], s[56:57] offset:1024
E64:
  s_barrier
  ds_read_b128 v[48:51], v1 offset:2048
  ds_read_b128 v[52:55], v1 offset:5120
  ds_read_b128 v[56:59], v1 offset:8192
  ds_read_b128 v[60:63], v1 offset:11264
  s_waitcnt lgkmcnt(0)
  v_pk_add_f32 v[48:49], v[48:49], v[52:53]
  v_pk_add_f32 v[50:51], v[50:51], v[54:55]
  v_pk_add_f32 v[56:57], v[56:57], v[60:61]
  v_pk_add_f32 v[58:59], v[58:59], v[62:63]
  v_pk_add_f32 v[48:49], v[48:49], v[56:57]
  v_pk_add_f32 v[50:51], v[50:51], v[58:59]
  v_cvt_pk_bf16_f32 v44, v48, v49
  v_cvt_pk_bf16_f32 v45, v50, v51
  v_mov_b32 v46, v44
  v_mov_b32 v47, v45
  v_mov_b32 v48, v44
  v_mov_b32 v49, v45
  s_nop 1
  v_permlane32_swap_b32 v46, v48
  v_permlane32_swap_b32 v47, v49
  s_sleep 2
  s_mov_b32 s38, 524288
P65:
  s_sub_u32 s38, s38, 1
  s_cbranch_scc1 L_END
  global_load_dwordx4 v[80:83], v1, s[64:65] sc1
  global_load_dwordx2 v[84:85], v15, s[64:65] offset:1024 sc1
  global_load_dwordx4 v[86:89], v1, s[66:67] sc1
  global_load_dwordx2 v[90:91], v15, s[66:67] offset:1024 sc1
  global_load_dwordx4 v[92:95], v1, s[68:69] sc1
  global_load_dwordx2 v[96:97], v15, s[68:69] offset:1024 sc1
  s_waitcnt vmcnt(0)
  v_max3_u32 v16, v80, v81, v82
  v_max3_u32 v17, v89, v90, v91
  v_max3_u32 v16, v16, v83, v84
  v_max3_u32 v17, v17, v92, v93
  v_max3_u32 v16, v16, v85, v86
  v_max3_u32 v17, v17, v94, v95
  v_max3_u32 v16, v16, v87, v88
  v_max3_u32 v17, v17, v96, v97
  v_max_u32 v16, v16, v17
  v_cmp_eq_u32 vcc, -1, v16
  s_nop 0
  s_cbranch_vccnz P65
PD66:
  v_pk_add_f32 v[36:37], v[36:37], v[80:81]
  v_pk_add_f32 v[38:39], v[38:39], v[82:83]
  v_pk_add_f32 v[40:41], v[40:41], v[84:85]
  v_pk_add_f32 v[86:87], v[86:87], v[92:93]
  v_pk_add_f32 v[88:89], v[88:89], v[94:95]
  v_pk_add_f32 v[90:91], v[90:91], v[96:97]
  v_pk_add_f32 v[36:37], v[36:37], v[86:87]
  v_pk_add_f32 v[38:39], v[38:39], v[88:89]
  v_pk_add_f32 v[40:41], v[40:41], v[90:91]
  v_cndmask_b32 v40, v40, v3, s[78:79]
  v_cndmask_b32 v41, v41, v3, s[78:79]
  v_max3_f32 v16, v36, v37, v38
  v_max3_f32 v18, v39, v40, v41
  v_max_f32 v16, v16, v18
  v_mov_b32 v17, v16
  s_nop 1
  v_permlane32_swap_b32 v17, v16
  s_nop 0
  v_max_f32 v16, v16, v17
  v_mov_b32 v17, v16
  s_nop 1
  v_permlane16_swap_b32 v17, v16
  s_nop 0
  v_max_f32 v16, v16, v17
  s_nop 1
  v_max_f32_dpp v16, v16, v16 row_ror:8 row_mask:0xf bank_mask:0xf
  s_mov_b32 s39, 0x3e0293ee
  v_mul_f32 v16, s39, v16
  v_fma_f32 v36, v36, s39, -v16
  v_fma_f32 v37, v37, s39, -v16
  v_fma_f32 v38, v38, s39, -v16
  v_fma_f32 v39, v39, s39, -v16
  v_fma_f32 v40, v40, s39, -v16
  v_fma_f32 v41, v41, s39, -v16
  v_exp_f32 v36, v36
  v_exp_f32 v37, v37
  v_exp_f32 v38, v38
  v_exp_f32 v39, v39
  v_exp_f32 v40, v40
  v_exp_f32 v41, v41
  v_cvt_pk_bf16_f32 v52, v36, v37
  v_cvt_pk_bf16_f32 v53, v38, v39
  v_cvt_pk_bf16_f32 v50, v40, v41
  v_add_f32 v16, v36, v37
  v_add_f32 v18, v38, v39
  v_mov_b32_dpp v54, v52 row_shl:8 row_mask:0xf bank_mask:0xf bound_ctrl:0
  v_mov_b32_dpp v55, v53 row_shl:8 row_mask:0xf bank_mask:0xf bound_ctrl:0
  v_mov_b32_dpp v51, v50 row_shl:8 row_mask:0xf bank_mask:0xf bound_ctrl:0
  v_add_f32 v16, v16, v40
  v_add_f32 v18, v18, v41
  v_mfma_f32_16x16x32_bf16 v[20:23], v[72:75], v[52:55], 0
  v_mfma_f32_16x16x32_bf16 v[24:27], v[76:79], v[52:55], 0
  v_add_f32 v16, v16, v18
  v_mfma_f32_16x16x16_bf16 v[20:23], v[46:47], v[50:51], v[20:23]
  v_mfma_f32_16x16x16_bf16 v[24:27], v[48:49], v[50:51], v[24:27]
  v_mov_b32 v17, v16
  s_nop 1
  v_permlane32_swap_b32 v17, v16
  s_nop 0
  v_add_f32 v16, v16, v17
  v_mov_b32 v17, v16
  s_nop 1
  v_permlane16_swap_b32 v17, v16
  s_nop 0
  v_add_f32 v16, v16, v17
  s_nop 1
  v_add_f32_dpp v16, v16, v16 row_ror:8 row_mask:0xf bank_mask:0xf
  v_rcp_f32 v16, v16
  s_nop 0
  v_mul_f32 v20, v16, v20
  v_mul_f32 v21, v16, v21
  v_mul_f32 v22, v16, v22
  v_mul_f32 v23, v16, v23
  v_mul_f32 v24, v16, v24
  v_mul_f32 v25, v16, v25
  v_mul_f32 v26, v16, v26
  v_mul_f32 v27, v16, v27
  v_cvt_pk_bf16_f32 v28, v20, v21
  v_cvt_pk_bf16_f32 v29, v22, v23
  v_cvt_pk_bf16_f32 v30, v24, v25
  v_cvt_pk_bf16_f32 v31, v26, v27
  v_min_u32 v28, -2, v28
  v_min_u32 v29, -2, v29
  v_min_u32 v30, -2, v30
  v_min_u32 v31, -2, v31
  s_mov_b64 exec, s[74:75]
  s_cmp_eq_u32 s32, 0
  s_cbranch_scc1 F67
  global_store_dwordx4 v8, v[28:31], s[58:59] sc1
  s_branch E68
F67:
  global_store_dwordx4 v8, v[28:31], s[58:59]
E68:
  s_mov_b64 exec, -1
L_CW_O:
  s_cmp_eq_u32 s60, 63
  s_cbranch_scc1 L_END
  s_add_u32 s39, s60, 0
  s_and_b32 s39, s39, 3
  s_lshl_b32 s39, s39, 19
  s_add_u32 s39, s39, s73
  s_add_u32 s56, s30, s39
  s_addc_u32 s57, s31, 0
  s_add_u32 s56, s56, 84148224
  s_addc_u32 s57, s57, 0
  s_add_u32 s39, s60, 0
  s_and_b32 s39, s39, 3
  s_lshl_b32 s39, s39, 19
  s_add_u32 s39, s39, s72
  s_add_u32 s58, s30, s39
  s_addc_u32 s59, s31, 0
  s_add_u32 s58, s58, 84213760
  s_addc_u32 s59, s59, 0
  s_barrier
  s_sleep 3
  s_mov_b32 s38, 524288
P69:
  s_sub_u32 s38, s38, 1
  s_cbranch_scc1 L_END
  global_load_dwordx4 v[80:83], v9, s[56:57] offset:0 sc1
  global_load_dwordx4 v[84:87], v9, s[56:57] offset:1024 sc1
  global_load_dwordx4 v[88:91], v9, s[56:57] offset:2048 sc1
  global_load_dwordx4 v[92:95], v9, s[56:57] offset:3072 sc1
  s_waitcnt vmcnt(0)
  v_max3_u32 v16, v80, v81, v82
  v_max3_u32 v17, v88, v89, v90
  v_max3_u32 v16, v16, v83, v84
  v_max3_u32 v17, v17, v91, v92
  v_max3_u32 v16, v16, v85, v86
  v_max3_u32 v17, v17, v93, v94
  v_max_u32 v16, v16, v87
  v_max_u32 v17, v17, v95
  v_max_u32 v16, v16, v17
  v_cmp_eq_u32 vcc, -1, v16
  s_nop 0
  s_cbranch_vccnz P69
PD70:
  v_mfma_f32_16x16x32_bf16 v[20:23], a[0:3], v[80:83], 0
  v_mfma_f32_16x16x32_bf16 v[28:31], a[32:35], v[80:83], 0
  v_mfma_f32_16x16x32_bf16 v[24:27], a[4:7], v[80:83], 0
  v_mfma_f32_16x16x32_bf16 v[32:35], a[36:39], v[80:83], 0
  v_mfma_f32_16x16x32_bf16 v[20:23], a[8:11], v[84:87], v[20:23]
  v_mfma_f32_16x16x32_bf16 v[28:31], a[40:43], v[84:87], v[28:31]
  v_mfma_f32_16x16x32_bf16 v[24:27], a[12:15], v[84:87], v[24:27]
  v_mfma_f32_16x16x32_bf16 v[32:35], a[44:47], v[84:87], v[32:35]
  v_mfma_f32_16x16x32_bf16 v[20:23], a[16:19], v[88:91], v[20:23]
  v_mfma_f32_16x16x32_bf16 v[28:31], a[48:51], v[88:91], v[28:31]
  v_mfma_f32_16x16x32_bf16 v[24:27], a[20:23], v[88:91], v[24:27]
  v_mfma_f32_16x16x32_bf16 v[32:35], a[52:55], v[88:91], v[32:35]
  v_mfma_f32_16x16x32_bf16 v[20:23], a[24:27], v[92:95], v[20:23]
  v_mfma_f32_16x16x32_bf16 v[28:31], a[56:59], v[92:95], v[28:31]
  v_mfma_f32_16x16x32_bf16 v[24:27], a[28:31], v[92:95], v[24:27]
  v_mfma_f32_16x16x32_bf16 v[32:35], a[60:63], v[92:95], v[32:35]
  s_nop 6
  v_add_f32_dpp v20, v24, v20 row_shl:8 row_mask:0xf bank_mask:0x3
  v_add_f32_dpp v21, v25, v21 row_shl:8 row_mask:0xf bank_mask:0x3
  v_add_f32_dpp v22, v26, v22 row_shl:8 row_mask:0xf bank_mask:0x3
  v_add_f32_dpp v23, v27, v23 row_shl:8 row_mask:0xf bank_mask:0x3
  v_add_f32_dpp v20, v28, v32 row_shr:8 row_mask:0xf bank_mask:0xc
  v_add_f32_dpp v21, v29, v33 row_shr:8 row_mask:0xf bank_mask:0xc
  v_add_f32_dpp v22, v30, v34 row_shr:8 row_mask:0xf bank_mask:0xc
  v_add_f32_dpp v23, v31, v35 row_shr:8 row_mask:0xf bank_mask:0xc
  ds_write_b128 v10, v[20:23]
  s_waitcnt lgkmcnt(0)
  s_barrier
  s_cmp_eq_u32 s54, 1
  s_cbranch_scc1 L_CR
  s_sleep 2
  s_cmp_eq_u32 s54, 0
  s_cbranch_scc1 L_CP
  s_cmp_eq_u32 s54, 2
  s_cbranch_scc1 L_CK
  s_cmp_lg_u32 s33, 0
  s_cbranch_scc1 L_CNB
  v_mov_b32 v22, 44
  v_mov_b32 v23, 1
  s_mov_b64 exec, 1
  global_atomic_add v22, v23, s[28:29] sc1
  s_mov_b64 exec, -1
  s_branch L_CNB
L_CK:
  global_store_dwordx2 v14, v[40:41], s[64:65] sc1
  global_store_dwordx2 v13, v[44:45], s[66:67] sc1
  s_branch L_CNB
L_CP:
  s_add_u32 s39, s60, 2
  s_and_b32 s39, s39, 3
  s_lshl_b32 s39, s39, 19
  s_add_u32 s39, s39, s70
  s_add_u32 s56, s30, s39
  s_addc_u32 s57, s31, 0
  s_add_u32 s56, s56, 83886080
  s_addc_u32 s57, s57, 0
  s_add_u32 s39, s60, 2
  s_and_b32 s39, s39, 3
  s_lshl_b32 s39, s39, 19
  s_add_u32 s39, s39, s71
  s_add_u32 s58, s30, s39
  s_addc_u32 s59, s31, 0
  s_add_u32 s58, s58, 84148224
  s_addc_u32 s59, s59, 0
  s_cmp_eq_u32 s32, 0
  s_cbranch_scc1 F71
  global_store_dwordx4 v1, v[4:7], s[56:57] sc1
  global_store_dwordx4 v2, v[4:7], s[56:57] offset:1024 sc1
  global_store_dwordx4 v2, v[4:7], s[58:59] sc1
  s_branch E72
F71:
  global_store_dwordx4 v1, v[4:7], s[56:57]
  global_store_dwordx4 v2, v[4:7], s[56:57] offset:1024
  global_store_dwordx4 v2, v[4:7], s[58:59]
E72:
  s_add_u32 s61, s60, 1
  s_and_b32 s39, s61, 7
  s_cmp_lg_u32 s39, 0
  s_cbranch_scc1 K73
  s_lshr_b32 s62, s61, 1
  s_add_u32 s39, s62, 64
  v_mov_b32 v16, s39
  s_mov_b32 s38, 524288
W74:
  global_load_dword v17, v16, s[28:29] sc1
  s_waitcnt vmcnt(0)
  v_readfirstlane_b32 s39, v17
  s_cmp_ge_u32 s39, 128
  s_cbranch_scc1 WD75
  s_sleep 1
  s_sub_u32 s38, s38, 1
  s_cbranch_scc1 L_END
  s_branch W74
WD75:
K73:
  s_lshl_b32 s39, s61, 18
  s_add_u32 s43, s70, s39
  s_add_u32 s56, s30, s43
  s_addc_u32 s57, s31, 0
  s_add_u32 s56, s56, 16777216
  s_addc_u32 s57, s57, 0
  s_add_u32 s58, s30, s43
  s_addc_u32 s59, s31, 0
  s_add_u32 s58, s58, 33554432
  s_addc_u32 s59, s59, 0
  global_load_dwordx4 v[64:67], v11, s[56:57] sc1
  global_load_dwordx4 v[68:71], v11, s[56:57] offset:128 sc1
  global_load_dwordx4 v[72:75], v12, s[58:59] sc1
  global_load_dwordx4 v[76:79], v12, s[58:59] offset:256 sc1
  s_add_u32 s39, s60, 1
  s_and_b32 s39, s39, 3
  s_lshl_b32 s39, s39, 19
  s_add_u32 s39, s39, s70
  s_add_u32 s56, s30, s39
  s_addc_u32 s57, s31, 0
  s_add_u32 s56, s56, 83886080
  s_addc_u32 s57, s57, 0
  s_add_u32 s39, s60, 1
  s_and_b32 s39, s39, 3
  s_lshl_b32 s39, s39, 19
  s_add_u32 s39, s39, s71
  s_add_u32 s58, s30, s39
  s_addc_u32 s59, s31, 0
  s_add_u32 s58, s58, 84148224
  s_addc_u32 s59, s59, 0
  s_xor_b32 s43, s33, 1
  s_lshl_b32 s43, s43, 11
  s_add_u32 s39, s60, 1
  s_and_b32 s39, s39, 3
  s_lshl_b32 s39, s39, 19
  s_add_u32 s39, s39, s43
  s_add_u32 s64, s30, s39
  s_addc_u32 s65, s31, 0
  s_add_u32 s64, s64, 83886080
  s_addc_u32 s65, s65, 0
  s_xor_b32 s43, s33, 2
  s_lshl_b32 s43, s43, 11
  s_add_u32 s39, s60, 1
  s_and_b32 s39, s39, 3
  s_lshl_b32 s39, s39, 19
  s_add_u32 s39, s39, s43
  s_add_u32 s66, s30, s39
  s_addc_u32 s67, s31, 0
  s_add_u32 s66, s66, 83886080
  s_addc_u32 s67, s67, 0
  s_xor_b32 s43, s33, 3
  s_lshl_b32 s43, s43, 11
  s_add_u32 s39, s60, 1
  s_and_b32 s39, s39, 3
  s_lshl_b32 s39, s39, 19
  s_add_u32 s39, s39, s43
  s_add_u32 s68, s30, s39
  s_addc_u32 s69, s31, 0
  s_add_u32 s68, s68, 83886080
  s_addc_u32 s69, s69, 0
L_CNB:
  s_barrier
  s_branch L_CN
L_CR:
  ds_read_b128 v[16:19], v1 offset:16384
  ds_read_b128 v[20:23], v1 offset:17408
  ds_read_b128 v[24:27], v1 offset:18432
  ds_read_b128 v[28:31], v1 offset:19456
  s_waitcnt lgkmcnt(0)
  v_pk_add_f32 v[16:17], v[16:17], v[20:21]
  v_pk_add_f32 v[18:19], v[18:19], v[22:23]
  v_pk_add_f32 v[24:25], v[24:25], v[28:29]
  v_pk_add_f32 v[26:27], v[26:27], v[30:31]
  v_pk_add_f32 v[16:17], v[16:17], v[24:25]
  v_pk_add_f32 v[18:19], v[18:19], v[26:27]
  global_store_dwordx4 v1, v[16:19], s[58:59] sc1
  s_add_u32 s39, s60, 2
  s_and_b32 s39, s39, 3
  s_lshl_b32 s39, s39, 19
  s_add_u32 s39, s39, s72
  s_add_u32 s56, s30, s39
  s_addc_u32 s57, s31, 0
  s_add_u32 s56, s56, 84213760
  s_addc_u32 s57, s57, 0
  s_add_u32 s39, s60, 3
  s_and_b32 s39, s39, 3
  s_lshl_b32 s39, s39, 19
  s_add_u32 s39, s39, s71
  s_add_u32 s58, s30, s39
  s_addc_u32 s59, s31, 0
  s_add_u32 s58, s58, 84344832
  s_addc_u32 s59, s59, 0
  global_store_dwordx4 v1, v[4:7], s[56:57] sc1
  s_cmp_eq_u32 s32, 0
  s_cbranch_scc1 F76
  global_store_dwordx4 v2, v[4:7], s[58:59] sc1
  s_branch E77
F76:
  global_store_dwordx4 v2, v[4:7], s[58:59]
E77:
  s_xor_b32 s43, s33, 32
  s_lshl_b32 s43, s43, 10
  s_add_u32 s39, s60, 0
  s_and_b32 s39, s39, 3
  s_lshl_b32 s39, s39, 19
  s_add_u32 s39, s39, s43
  s_add_u32 s64, s30, s39
  s_addc_u32 s65, s31, 0
  s_add_u32 s64, s64, 84213760
  s_addc_u32 s65, s65, 0
  s_xor_b32 s43, s33, 64
  s_lshl_b32 s43, s43, 10
  s_add_u32 s39, s60, 0
  s_and_b32 s39, s39, 3
  s_lshl_b32 s39, s39, 19
  s_add_u32 s39, s39, s43
  s_add_u32 s66, s30, s39
  s_addc_u32 s67, s31, 0
  s_add_u32 s66, s66, 84213760
  s_addc_u32 s67, s67, 0
  s_xor_b32 s43, s33, 96
  s_lshl_b32 s43, s43, 10
  s_add_u32 s39, s60, 0
  s_and_b32 s39, s39, 3
  s_lshl_b32 s39, s39, 19
  s_add_u32 s39, s39, s43
  s_add_u32 s68, s30, s39
  s_addc_u32 s69, s31, 0
  s_add_u32 s68, s68, 84213760
  s_addc_u32 s69, s69, 0
  s_add_u32 s39, s60, 1
  s_and_b32 s39, s39, 3
  s_lshl_b32 s39, s39, 19
  s_add_u32 s39, s39, s71
  s_add_u32 s56, s30, s39
  s_addc_u32 s57, s31, 0
  s_add_u32 s56, s56, 84344832
  s_addc_u32 s57, s57, 0
  s_sleep 9
  s_mov_b32 s38, 524288
P78:
  s_sub_u32 s38, s38, 1
  s_cbranch_scc1 L_END
  global_load_dwordx4 v[32:35], v1, s[64:65] sc1
  global_load_dwordx4 v[36:39], v1, s[66:67] sc1
  global_load_dwordx4 v[40:43], v1, s[68:69] sc1
  s_waitcnt vmcnt(0)
  v_max3_u32 v20, v32, v33, v34
  v_max3_u32 v21, v38, v39, v40
  v_max3_u32 v20, v20, v35, v36
  v_max3_u32 v21, v21, v41, v42
  v_max_u32 v20, v20, v37
  v_max_u32 v21, v21, v43
  v_max_u32 v20, v20, v21
  v_cmp_eq_u32 vcc, -1, v20
  s_nop 0
  s_cbranch_vccnz P78
PD79:
  v_pk_add_f32 v[16:17], v[16:17], v[32:33]
  v_pk_add_f32 v[18:19], v[18:19], v[34:35]
  v_pk_add_f32 v[36:37], v[36:37], v[40:41]
  v_pk_add_f32 v[38:39], v[38:39], v[42:43]
  v_pk_add_f32 v[16:17], v[16:17], v[36:37]
  v_pk_add_f32 v[18:19], v[18:19], v[38:39]
  v_cvt_pk_bf16_f32 v20, v16, v17
  v_cvt_pk_bf16_f32 v21, v18, v19
  v_min_u32 v20, -2, v20
  v_min_u32 v21, -2, v21
  s_cmp_eq_u32 s32, 0
  s_cbranch_scc1 F80
  global_store_dwordx2 v14, v[20:21], s[56:57] sc1
  s_branch E81
F80:
  global_store_dwordx2 v14, v[20:21], s[56:57]
E81:
  s_barrier
L_CN:
  s_add_u32 s60, s60, 1
  s_branch L_CW
L_CA_X:
  s_barrier
  s_branch L_END
L_CA_F:
  global_store_dwordx2 v14, v[40:41], s[64:65] sc1
  global_store_dwordx2 v13, v[44:45], s[66:67] sc1
  s_waitcnt vmcnt(0)
  v_mov_b32 v16, 44
  v_mov_b32 v17, 1
  s_mov_b64 exec, 1
  global_atomic_add v16, v17, s[28:29] sc1
  s_mov_b64 exec, -1
  s_branch L_END
L_END:
  s_endpgm
.section .rodata,"a"
.p2align 6
.amdhsa_kernel gated_mix__memory_aug_recurrent_mem_tr__grouped_kv_mqa__prompt_kernel
  .amdhsa_next_free_vgpr 256
  .amdhsa_next_free_sgpr 102
  .amdhsa_accum_offset 128
  .amdhsa_group_segment_fixed_size 0
  .amdhsa_kernarg_size 128
  .amdhsa_user_sgpr_count 2
  .amdhsa_user_sgpr_kernarg_segment_ptr 1
  .amdhsa_system_sgpr_workgroup_id_x 1
.end_amdhsa_kernel
```
